```python
import torch

def _softmax(x, axis=-1):
    return torch.softmax(x, dim=axis)
def _gelu(x):
    return torch.nn.functional.gelu(x, approximate="tanh")
def _silu(x):
    return torch.nn.functional.silu(x)
def _sigmoid(x):
    return torch.sigmoid(x)
def _layernorm(x, axis=-1, eps=1e-5):
    m = x.mean(dim=axis, keepdim=True)
    v = x.var(dim=axis, keepdim=True, unbiased=False)
    return (x - m) / torch.sqrt(v + eps)
def _scatter_add(tgt, idx, src, axis=0):
    return tgt.clone().index_add_(axis, idx, src)
def _segment_sum(src, seg, n):
    out = torch.zeros((n,) + src.shape[1:], dtype=src.dtype)
    return out.index_add_(0, seg, src)
def _pad(x, pw):
    flat = tuple(v for pair in reversed(pw) for v in pair)
    return torch.nn.functional.pad(x, flat)

kernel_name = 'interleave_layers__grouped_kv_mqa__glu_gated_swiglu__prompt'

def setup_inputs():

    _w = (lambda a: (lambda t: t.to(torch.bfloat16) if t.is_floating_point() else t)(torch.as_tensor(a)))
    def _A_setup():
        B, S, D, H = 1, 2048, 512, 32
        Dh = D // H
        return {
            "x": _w((lambda *s: torch.randn(*s, dtype=torch.bfloat16) * 0.05)(B, S, D)),
            "wq": _w((lambda *s: torch.randn(*s, dtype=torch.bfloat16) * 0.05)(D, H * Dh)),
            "wk": _w((lambda *s: torch.randn(*s, dtype=torch.bfloat16) * 0.05)(D, Dh)),
            "wv": _w((lambda *s: torch.randn(*s, dtype=torch.bfloat16) * 0.05)(D, Dh)),
            "wo": _w((lambda *s: torch.randn(*s, dtype=torch.bfloat16) * 0.05)(H * Dh, D)),
        }
    _A_in = _A_setup()

    def _B_setup():
        B, S, D, F = 1, 2048, 512, 1792
        return {
            "x": _w((lambda *s: torch.randn(*s, dtype=torch.bfloat16) * 0.05)(B, S, D)),
            "w1": _w((lambda *s: torch.randn(*s, dtype=torch.bfloat16) * 0.4)(D, F) * (2.0 / D) ** 0.5),
            "w3": _w((lambda *s: torch.randn(*s, dtype=torch.bfloat16) * 0.4)(D, F) * (2.0 / D) ** 0.5),
            "w2": _w((lambda *s: torch.randn(*s, dtype=torch.bfloat16) * 0.4)(F, D) * (2.0 / F) ** 0.5),
        }
    _B_in = _B_setup()

    return {
        "A_x": _A_in["x"],
        "A_wq": _A_in["wq"],
        "A_wk": _A_in["wk"],
        "A_wv": _A_in["wv"],
        "A_wo": _A_in["wo"],
        "B_x": _B_in["x"],
        "B_w1": _B_in["w1"],
        "B_w3": _B_in["w3"],
        "B_w2": _B_in["w2"],
    }

def reference(A_x, A_wq, A_wk, A_wv, A_wo, B_x, B_w1, B_w3, B_w2):
    def _A_ref(x, wq, wk, wv, wo):
        B, S, D = x.shape
        H = 32
        Dh = D // H
        q = (lambda x, *d: x.permute(*d))((x @ wq).reshape(B, S, H, Dh), 0, 2, 1, 3)
        k = x @ wk
        v = x @ wv
        scores = torch.einsum("bhqd,bkd->bhqk", q, k) * (Dh ** -0.5)
        p = _softmax(scores, axis=-1)
        o = torch.einsum("bhqk,bkd->bhqd", p, v)
        return (lambda x, *d: x.permute(*d))(o, 0, 2, 1, 3).reshape(B, S, H * Dh) @ wo

    def _B_ref(x, w1, w3, w2):
        gate = torch.einsum("bsd,df->bsf", x, w1)
        up = torch.einsum("bsd,df->bsf", x, w3)
        h = _silu(gate) * up
        out = torch.einsum("bsf,fd->bsd", h, w2)
        return out

    x = A_x
    x = x + _A_ref(_layernorm(x, axis=-1), A_wq, A_wk, A_wv, A_wo)
    x = x + _B_ref(_layernorm(x, axis=-1), B_w1, B_w3, B_w2)
    x = x + _A_ref(_layernorm(x, axis=-1), A_wq, A_wk, A_wv, A_wo)
    x = x + _B_ref(_layernorm(x, axis=-1), B_w1, B_w3, B_w2)
    return x
```

```asm
; @launch grid=(256,1,1) block=(256,1,1) lds=163840
.amdgcn_target "amdgcn-amd-amdhsa--gfx950"
.text
.globl interleave_layers__grouped_kv_mqa__glu_gated_swiglu__prompt_kernel
.p2align 8
.type interleave_layers__grouped_kv_mqa__glu_gated_swiglu__prompt_kernel,@function
L_code_begin:
interleave_layers__grouped_kv_mqa__glu_gated_swiglu__prompt_kernel:
  s_load_dwordx16 s[80:95], s[0:1], 0
  s_load_dwordx2 s[96:97], s[0:1], 64
  s_load_dwordx2 s[98:99], s[0:1], 80
  s_cmp_ge_u32 s2, 256
  s_cbranch_scc1 L_exit_main
  s_load_dwordx2 s[4:5], s[0:1], 88
  s_load_dwordx2 s[8:9], s[0:1], 72
  v_and_b32 v2, 63, v0
  v_lshrrev_b32 v4, 6, v0
  v_lshlrev_b32 v1, 4, v2
  v_readfirstlane_b32 s12, v4
  v_and_b32 v3, 31, v0
  v_lshrrev_b32 v4, 5, v2
  v_add_u32 v5, 4096, v1
  v_add_u32 v6, 8192, v1
  v_add_u32 v7, 12288, v1
  v_add_u32 v8, 16384, v1
  v_add_u32 v9, 20480, v1
  v_add_u32 v10, 24576, v1
  s_and_b32 s17, s2, 7
  s_lshr_b32 s18, s2, 3
  s_lshl_b32 s15, s17, 1
  s_lshr_b32 s19, s18, 4
  s_add_u32 s15, s15, s19
  s_and_b32 s16, s18, 15
  s_and_b32 s14, s18, 7
  s_lshl_b32 s13, s17, 2
  s_lshr_b32 s19, s18, 3
  s_add_u32 s13, s13, s19
  s_mov_b32 s6, 0x2800000
  s_mov_b32 s7, 0x00020000
  s_mov_b32 s10, 2097152
  s_mov_b32 s11, 0x00020000
  s_waitcnt lgkmcnt(0)
  v_mov_b32 v21, 0
  v_mov_b32 v199, 0
  v_lshlrev_b32 v23, 7, v2
  v_lshlrev_b32 v20, 2, v2
  s_lshr_b32 s17, s12, 1
  s_and_b32 s18, s12, 1
  s_lshl_b32 s32, s14, 1
  s_add_u32 s32, s32, s17
  s_lshl_b32 s31, s13, 1
  s_add_u32 s31, s31, s18
  s_mov_b32 s3, 0
  s_mov_b32 s36, s98
  s_mov_b32 s37, s99
  s_mov_b32 s38, 256
  s_mov_b32 s39, 0x00020000
  s_or_b32 s17, s2, s12
  s_cmp_lg_u32 s17, 0
  s_cbranch_scc1 L_s_notag
  s_memrealtime s[18:19]
  s_waitcnt lgkmcnt(0)
  s_lshl_b32 s18, s18, 4
  s_or_b32 s18, s18, 1
  v_mov_b32 v24, s18
  s_mov_b64 exec, 3
  buffer_store_dword v24, v23, s[36:39], 0 offen sc1
  s_mov_b64 exec, -1
L_s_notag:
  s_getpc_b64 s[18:19]
L_s_pc:
  s_add_u32 s18, s18, L_code_begin-L_s_pc
  s_addc_u32 s19, s19, -1
  s_lshr_b32 s17, s2, 3
  s_lshl_b32 s17, s17, 11
  v_lshlrev_b32 v24, 3, v0
  v_add_u32 v24, s17, v24
  v_min_u32 v24, L_code_end-L_code_begin-8, v24
  global_load_dwordx2 v[254:255], v24, s[18:19]
  s_mov_b32 s40, s80
  s_mov_b32 s41, s81
  s_mov_b32 s42, 2097152
  s_mov_b32 s43, 0x00020000
  s_lshl_b32 s17, s31, 15
  s_lshl_b32 s18, s32, 6
  s_add_u32 s17, s17, s18
  v_lshlrev_b32 v24, 10, v3
  v_lshl_add_u32 v24, v4, 4, v24
  buffer_load_dwordx4 v[12:15], v24, s[40:43], s17 offen
  buffer_load_dwordx4 v[16:19], v24, s[40:43], s17 offen offset:32
  s_bitcmp1_b32 s14, 0
  s_cselect_b32 s40, s86, s84
  s_cselect_b32 s41, s87, s85
  s_mov_b32 s42, 16384
  s_lshl_b32 s17, s12, 12
  buffer_load_dwordx4 v[88:91], v1, s[40:43], s17 offen offset:0
  buffer_load_dwordx4 v[92:95], v1, s[40:43], s17 offen offset:1024
  buffer_load_dwordx4 v[96:99], v1, s[40:43], s17 offen offset:2048
  buffer_load_dwordx4 v[100:103], v1, s[40:43], s17 offen offset:3072
  s_mov_b32 s40, s82
  s_mov_b32 s41, s83
  s_mov_b32 s42, 524288
  v_lshrrev_b32 v234, 3, v2
  v_and_b32 v235, 7, v2
  v_lshlrev_b32 v236, 10, v234
  v_lshl_add_u32 v236, v235, 4, v236
  s_lshl_b32 s17, s12, 17
  s_lshl_b32 s18, s14, 7
  s_add_u32 s17, s17, s18
  v_mov_b32 v240, v236
  buffer_load_dwordx4 v[104:107], v240, s[40:43], s17 offen
  s_add_u32 s17, s17, 8192
  buffer_load_dwordx4 v[108:111], v240, s[40:43], s17 offen
  s_add_u32 s17, s17, 8192
  buffer_load_dwordx4 v[112:115], v240, s[40:43], s17 offen
  s_add_u32 s17, s17, 8192
  buffer_load_dwordx4 v[116:119], v240, s[40:43], s17 offen
  s_add_u32 s17, s17, 8192
  buffer_load_dwordx4 v[120:123], v240, s[40:43], s17 offen
  s_add_u32 s17, s17, 8192
  buffer_load_dwordx4 v[124:127], v240, s[40:43], s17 offen
  s_add_u32 s17, s17, 8192
  buffer_load_dwordx4 v[128:131], v240, s[40:43], s17 offen
  s_add_u32 s17, s17, 8192
  buffer_load_dwordx4 v[132:135], v240, s[40:43], s17 offen
  s_add_u32 s17, s17, 8192
  s_mov_b32 s54, s17
  s_and_b32 s18, s12, 1
  s_lshl_b32 s59, s18, 7
  buffer_load_dword v11, v21, s[36:39], s59 offen sc1
  s_mul_i32 s18, s12, 24576
  v_mul_u32_u24 v236, 192, v234
  v_lshl_add_u32 v236, v235, 4, v236
  v_add_u32 v236, s18, v236
  v_lshrrev_b32 v234, 1, v2
  v_and_b32 v235, 1, v2
  v_mul_u32_u24 v237, 192, v234
  v_lshl_add_u32 v237, v235, 4, v237
  v_add_u32 v237, s18, v237
  v_and_b32 v234, 15, v2
  v_lshrrev_b32 v235, 2, v234
  v_lshl_add_u32 v235, v4, 2, v235
  v_mul_u32_u24 v238, 192, v235
  v_and_b32 v234, 3, v234
  v_lshl_add_u32 v238, v234, 3, v238
  v_add_u32 v238, s18, v238
  v_bfe_u32 v234, v2, 4, 1
  v_lshl_add_u32 v239, v234, 5, v238
  s_lshr_b32 s18, s12, 1
  s_lshl_b32 s18, s18, 6
  v_add_u32 v234, s18, v239
  s_xor_b32 s18, s18, 64
  v_add_u32 v235, s18, v239
  s_lshr_b32 s20, s2, 3
  s_and_b32 s21, s2, 7
  v_lshrrev_b32 v25, 3, v0
  v_and_b32 v26, 7, v0
  v_mul_u32_u24 v242, 192, v25
  v_lshl_add_u32 v242, v26, 4, v242
  v_add_u32 v242, 98304, v242
  v_mov_b32 v232, v1
  s_mov_b32 s50, 0
  s_mov_b32 s24, 32768
  s_mov_b32 s25, 1024
  s_mov_b32 s46, 524288
  s_mov_b32 s56, 2
  s_mov_b32 s47, 0x00020000
  s_lshr_b32 s26, s20, 3
  s_and_b32 s17, s20, 0x17
  s_cmp_eq_u32 s17, 4
  s_cbranch_scc1 L_s_wkv
  s_cmp_eq_u32 s17, 5
  s_cbranch_scc1 L_s_wq
  s_lshl_b32 s17, s26, 2
  s_add_u32 s27, s17, s14
  s_add_u32 s18, s27, 12
  s_sub_u32 s19, s27, 8
  s_lshl_b32 s17, s26, 1
  s_add_u32 s17, s17, s14
  s_sub_u32 s17, s17, 6
  s_cmp_lt_u32 s26, 2
  s_cselect_b32 s27, s17, s19
  s_cmp_lt_u32 s14, 4
  s_cselect_b32 s27, s18, s27
  s_lshl_b32 s27, s27, 3
  s_add_u32 s27, s27, s21
  s_and_b32 s26, s27, 1
  s_cmp_lt_u32 s27, 112
  s_cbranch_scc1 L_s_w13
  s_cmp_lt_u32 s27, 168
  s_cbranch_scc1 L_s_w2
  s_cmp_lt_u32 s27, 184
  s_cbranch_scc1 L_s_wo
  s_mov_b32 s56, 0
  s_mov_b32 s55, 0xf0000000
  s_mov_b32 s44, s82
  s_mov_b32 s45, s83
  s_mov_b32 s48, 0
  s_mov_b32 s49, 0
  s_mov_b32 s52, 0
  v_mov_b32 v241, 0
  s_branch L_s_loaded
L_s_wq:
  s_mov_b32 s56, 1
  s_mov_b32 s44, s82
  s_mov_b32 s45, s83
  s_mov_b32 s28, s21
  s_mov_b32 s55, 0x0
  s_lshl_b32 s50, s28, 11
  s_lshl_b32 s17, s26, 9
  s_add_u32 s50, s50, s17
  s_add_u32 s50, s50, 0x6e0000
  s_lshl_b32 s29, s28, 5
  s_lshl_b32 s17, s26, 4
  s_add_u32 s29, s29, s17
  s_add_u32 s29, s29, 0x6be000
  s_branch L_s_qo
L_s_wo:
  s_mov_b32 s44, s88
  s_mov_b32 s45, s89
  s_sub_u32 s28, s27, 168
  s_lshr_b32 s28, s28, 1
  s_mov_b32 s55, 0x80000
L_s_qo:
  s_lshl_b32 s48, s26, 18
  s_lshl_b32 s17, s28, 7
  s_add_u32 s48, s48, s17
  s_lshl_b32 s17, s28, 16
  s_add_u32 s55, s55, s17
  s_lshl_b32 s17, s26, 14
  s_add_u32 s55, s55, s17
  s_branch L_s_go
L_s_w2:
  s_sub_u32 s27, s27, 112
  s_and_b32 s28, s27, 7
  s_lshr_b32 s27, s27, 3
  s_mov_b32 s44, s96
  s_mov_b32 s45, s97
  s_mov_b32 s46, 1835008
  s_lshl_b32 s48, s27, 18
  s_lshl_b32 s17, s28, 7
  s_add_u32 s48, s48, s17
  s_mov_b32 s24, 114688
  s_mul_i32 s55, s28, 229376
  s_lshl_b32 s17, s27, 14
  s_add_u32 s55, s55, s17
  s_add_u32 s55, s55, 0x480000
  s_branch L_s_go
L_s_w13:
  s_bfe_u32 s29, s27, 0x10001
  s_lshr_b32 s28, s27, 2
  s_cmp_eq_u32 s29, 0
  s_cselect_b32 s44, s92, s94
  s_cselect_b32 s45, s93, s95
  s_mov_b32 s46, 1835008
  s_mov_b32 s25, 3584
  s_mul_i32 s48, s26, 917504
  s_lshl_b32 s17, s28, 7
  s_add_u32 s48, s48, s17
  s_mov_b32 s24, 65536
  s_lshl_b32 s55, s28, 17
  s_lshl_b32 s17, s26, 14
  s_add_u32 s55, s55, s17
  s_lshl_b32 s17, s29, 8
  s_add_u32 s55, s55, s17
  s_add_u32 s55, s55, 0x100000
  s_lshl_b32 s50, s28, 12
  s_add_u32 s50, s50, s17
  s_lshl_b32 s17, s26, 9
  s_add_u32 s50, s50, s17
  s_add_u32 s50, s50, 0x6c0000
  v_and_b32 v232, 15, v2
  v_lshlrev_b32 v232, 4, v232
  v_lshl_add_u32 v232, v4, 9, v232
  v_bfe_u32 v243, v2, 4, 1
  v_lshl_add_u32 v232, v243, 15, v232
L_s_go:
  v_mul_lo_u32 v241, v25, s25
  v_lshl_add_u32 v241, v26, 4, v241
  s_lshl_b32 s49, s25, 5
  s_mov_b32 s52, -1
  s_lshr_b32 s17, s12, 1
  s_and_b32 s18, s12, 1
  s_mul_i32 s19, s17, s24
  s_add_u32 s55, s55, s19
  s_lshl_b32 s19, s18, 13
  s_add_u32 s55, s55, s19
  s_lshl_b32 s17, s17, 6
  s_mul_i32 s18, s18, 24576
  s_add_u32 s33, s17, s18
  v_bfe_u32 v25, v2, 4, 1
  v_lshlrev_b32 v25, 5, v25
  s_branch L_s_common
L_s_wkv:
  s_mov_b32 s56, 1
  s_cmp_eq_u32 s26, 0
  s_cselect_b32 s44, s86, s84
  s_cselect_b32 s45, s87, s85
  s_mov_b32 s46, 16384
  v_lshrrev_b32 v25, 1, v0
  v_and_b32 v26, 1, v0
  v_mul_u32_u24 v242, 192, v25
  v_lshl_add_u32 v242, v26, 4, v242
  v_add_u32 v242, 98304, v242
  v_lshlrev_b32 v241, 4, v0
  s_mov_b32 s48, 0
  s_mov_b32 s49, 4096
  s_mov_b32 s52, 0x3fff
  v_and_b32 v232, 15, v2
  v_lshlrev_b32 v232, 4, v232
  v_lshl_add_u32 v232, v4, 9, v232
  s_mul_i32 s55, s21, 0x8000
  s_lshl_b32 s17, s12, 13
  s_add_u32 s55, s55, s17
  s_lshl_b32 s17, s26, 8
  s_add_u32 s55, s55, s17
  s_add_u32 s55, s55, 0x780000
  s_lshl_b32 s29, s21, 7
  s_lshl_b32 s17, s26, 4
  s_add_u32 s29, s29, s17
  s_add_u32 s29, s29, 0x6be800
  s_lshl_b32 s33, s12, 5
  v_mov_b32 v25, 0
  s_mov_b32 s56, 3
L_s_common:
  v_and_b32 v26, 15, v2
  v_lshrrev_b32 v27, 2, v26
  v_lshl_add_u32 v27, v4, 2, v27
  v_mul_u32_u24 v243, 192, v27
  v_and_b32 v26, 3, v26
  v_lshl_add_u32 v243, v26, 3, v243
  v_add_u32 v243, v25, v243
  s_add_u32 s33, s33, 98304
  v_add_u32 v243, s33, v243
L_s_loaded:
  s_mov_b32 s51, s29
  s_waitcnt vmcnt(13)
  v_permlane32_swap_b32 v12, v14
  v_permlane32_swap_b32 v13, v15
  v_permlane32_swap_b32 v16, v18
  v_permlane32_swap_b32 v17, v19
  s_mov_b32 s34, 0x800000
  s_lshl_b32 s18, s31, 15
  s_add_u32 s34, s34, s18
  s_lshl_b32 s18, s32, 11
  s_add_u32 s34, s34, s18
  s_mov_b32 s35, 0x700000
  s_lshl_b32 s18, s31, 12
  s_add_u32 s35, s35, s18
  s_lshr_b32 s18, s32, 1
  s_lshl_b32 s18, s18, 9
  s_add_u32 s35, s35, s18
  s_and_b32 s18, s32, 1
  s_lshl_b32 s18, s18, 3
  s_add_u32 s35, s35, s18
  buffer_store_dwordx4 v[12:15], v1, s[4:7], s34 offen offset:0 sc1
  buffer_store_dwordx4 v[16:19], v1, s[4:7], s34 offen offset:1024 sc1
  v_mov_b32 v168, 0x3f803f80
  v_mov_b32 v180, 0
  v_mov_b32 v181, 0
  v_dot2_f32_bf16 v180, v12, v168, v180
  v_dot2_f32_bf16 v181, v12, v12, v181
  v_dot2_f32_bf16 v180, v13, v168, v180
  v_dot2_f32_bf16 v181, v13, v13, v181
  v_dot2_f32_bf16 v180, v14, v168, v180
  v_dot2_f32_bf16 v181, v14, v14, v181
  v_dot2_f32_bf16 v180, v15, v168, v180
  v_dot2_f32_bf16 v181, v15, v15, v181
  v_dot2_f32_bf16 v180, v16, v168, v180
  v_dot2_f32_bf16 v181, v16, v16, v181
  v_dot2_f32_bf16 v180, v17, v168, v180
  v_dot2_f32_bf16 v181, v17, v17, v181
  v_dot2_f32_bf16 v180, v18, v168, v180
  v_dot2_f32_bf16 v181, v18, v18, v181
  v_dot2_f32_bf16 v180, v19, v168, v180
  v_dot2_f32_bf16 v181, v19, v19, v181
  v_lshlrev_b32 v170, 4, v3
  s_nop 1
  v_mov_b32 v182, v180
  v_mov_b32 v183, v181
  s_nop 0
  v_permlane32_swap_b32 v180, v182
  v_permlane32_swap_b32 v181, v183
  v_add_f32 v180, v180, v182
  v_add_f32 v181, v181, v183
  s_mov_b32 exec_lo, 0xffffffff
  s_mov_b32 exec_hi, 0x0
  buffer_store_dwordx2 v[180:181], v170, s[4:7], s35 offen sc1
  s_mov_b64 exec, -1
  s_mul_i32 s58, s3, 0x1000
  s_add_u32 s58, s58, 0x6b6000
  s_lshl_b32 s17, s13, 7
  s_add_u32 s58, s58, s17
  s_lshl_b32 s17, s14, 4
  s_add_u32 s58, s58, s17
  s_lshl_b32 s17, s12, 2
  s_add_u32 s58, s58, s17
  s_waitcnt vmcnt(11)
  ds_write_b128 v237, v[88:91] offset:128
  ds_write_b128 v237, v[92:95] offset:6272
  s_waitcnt vmcnt(9)
  ds_write_b128 v237, v[96:99] offset:12416
  ds_write_b128 v237, v[100:103] offset:18560
  s_waitcnt vmcnt(7)
  ds_write_b128 v236, v[104:107] offset:0
  ds_write_b128 v236, v[108:111] offset:1536
  s_waitcnt vmcnt(5)
  ds_write_b128 v236, v[112:115] offset:3072
  ds_write_b128 v236, v[116:119] offset:4608
  s_waitcnt vmcnt(3)
  ds_write_b128 v236, v[120:123] offset:6144
  ds_write_b128 v236, v[124:127] offset:7680
  s_waitcnt vmcnt(1)
  ds_write_b128 v236, v[128:131] offset:9216
  ds_write_b128 v236, v[132:135] offset:10752
  s_waitcnt lgkmcnt(0)
  ds_read_b64_tr_b16 a[128:129], v238 offset:128
  ds_read_b64_tr_b16 a[130:131], v238 offset:1664
  ds_read_b64_tr_b16 a[132:133], v238 offset:3200
  ds_read_b64_tr_b16 a[134:135], v238 offset:4736
  ds_read_b64_tr_b16 a[136:137], v238 offset:6272
  ds_read_b64_tr_b16 a[138:139], v238 offset:7808
  ds_read_b64_tr_b16 a[140:141], v238 offset:9344
  ds_read_b64_tr_b16 a[142:143], v238 offset:10880
  ds_read_b64_tr_b16 a[144:145], v238 offset:12416
  ds_read_b64_tr_b16 a[146:147], v238 offset:13952
  ds_read_b64_tr_b16 a[148:149], v238 offset:15488
  ds_read_b64_tr_b16 a[150:151], v238 offset:17024
  ds_read_b64_tr_b16 a[152:153], v238 offset:18560
  ds_read_b64_tr_b16 a[154:155], v238 offset:20096
  ds_read_b64_tr_b16 a[156:157], v238 offset:21632
  ds_read_b64_tr_b16 a[158:159], v238 offset:23168
  s_waitcnt vmcnt(0)
L_s_tg0:
  v_cmp_ne_u32 vcc, 0, v11
  s_nop 1
  s_cbranch_vccnz L_s_tagok0
  s_sleep 2
  buffer_load_dword v11, v21, s[36:39], s59 offen sc1
  s_waitcnt vmcnt(0)
  s_branch L_s_tg0
L_s_tagok0:
  s_mov_b64 exec, 1
  buffer_store_dword v11, v21, s[4:7], s58 offen sc1
  s_mov_b64 exec, -1
  s_cmp_ge_u32 s14, 4
  s_cbranch_scc1 L_kv0_none
  v_lshlrev_b32 v169, 4, v4
  v_lshlrev_b32 v174, 2, v3
  s_mov_b32 s28, 0x800000
  s_mul_i32 s20, s12, 8192
  s_add_u32 s20, s20, s28
  s_mul_i32 s26, s31, 32768
  s_add_u32 s26, s26, s20
  s_xor_b32 s21, s31, 1
  s_mul_i32 s27, s21, 32768
  s_add_u32 s27, s27, s20
  s_mov_b32 s30, 0x700000
  s_lshl_b32 s17, s31, 12
  s_add_u32 s30, s30, s17
  s_xor_b32 s17, s12, 1
  s_mul_i32 s17, s17, 12288
  s_add_u32 s17, s17, 0
  v_add_u32 v184, s17, v1
  s_xor_b32 s17, s12, 2
  s_mul_i32 s17, s17, 12288
  s_add_u32 s17, s17, 4096
  v_add_u32 v185, s17, v1
  s_xor_b32 s17, s12, 3
  s_mul_i32 s17, s17, 12288
  s_add_u32 s17, s17, 8192
  v_add_u32 v186, s17, v1
  s_mul_i32 s17, s12, 12288
  s_add_u32 s17, s17, 0
  v_add_u32 v187, s17, v1
  s_mul_i32 s33, s3, 0x30000
  s_add_u32 s33, s33, 0x650000
  s_lshr_b32 s36, s14, 1
  s_lshl_b32 s17, s13, 1
  s_add_u32 s17, s17, s36
  s_lshl_b32 s17, s17, 15
  s_add_u32 s23, s17, s28
  s_lshl_b32 s17, s12, 13
  s_add_u32 s23, s23, s17
  s_lshl_b32 s17, s12, 12
  s_add_u32 s17, s17, 98304
  v_add_u32 v170, s17, v1
  v_add_u32 v171, 98304, v1
  s_mul_i32 s37, s3, 0x2000
  s_add_u32 s37, s37, 0x640000
  s_lshl_b32 s17, s13, 5
  s_add_u32 s37, s37, s17
  s_lshl_b32 s17, s36, 4
  s_add_u32 s37, s37, s17
  s_lshl_b32 s39, s2, 11
  s_add_u32 s39, s39, 0x1500000
  s_waitcnt lgkmcnt(0)
  v_mov_b32 v152, 0x3f803f80
  v_mov_b32 v153, 0x3f803f80
  v_mov_b32 v154, 0x3f803f80
  v_mov_b32 v155, 0x3f803f80
  s_lshl_b32 s17, s12, 11
  s_add_u32 s17, s17, 118784
  v_add_u32 v156, s17, v1
  v_add_u32 v157, 118784, v1
  s_bitcmp1_b32 s14, 0
  s_cbranch_scc1 L_qkv_c1
  v_mfma_f32_32x32x16_bf16 v[24:39], a[128:131], v[152:155], 0
  v_mfma_f32_32x32x16_bf16 v[24:39], a[132:135], v[152:155], v[24:39]
  v_mfma_f32_32x32x16_bf16 v[24:39], a[136:139], v[152:155], v[24:39]
  v_mfma_f32_32x32x16_bf16 v[24:39], a[140:143], v[152:155], v[24:39]
  v_mfma_f32_32x32x16_bf16 v[24:39], a[144:147], v[152:155], v[24:39]
  v_mfma_f32_32x32x16_bf16 v[24:39], a[148:151], v[152:155], v[24:39]
  v_mfma_f32_32x32x16_bf16 v[24:39], a[152:155], v[152:155], v[24:39]
  v_mfma_f32_32x32x16_bf16 v[24:39], a[156:159], v[152:155], v[24:39]
  s_branch L_qkv_c2
L_qkv_c1:
  v_mfma_f32_32x32x16_bf16 v[24:39], v[152:155], a[128:131], 0
  v_mfma_f32_32x32x16_bf16 v[24:39], v[152:155], a[132:135], v[24:39]
  v_mfma_f32_32x32x16_bf16 v[24:39], v[152:155], a[136:139], v[24:39]
  v_mfma_f32_32x32x16_bf16 v[24:39], v[152:155], a[140:143], v[24:39]
  v_mfma_f32_32x32x16_bf16 v[24:39], v[152:155], a[144:147], v[24:39]
  v_mfma_f32_32x32x16_bf16 v[24:39], v[152:155], a[148:151], v[24:39]
  v_mfma_f32_32x32x16_bf16 v[24:39], v[152:155], a[152:155], v[24:39]
  v_mfma_f32_32x32x16_bf16 v[24:39], v[152:155], a[156:159], v[24:39]
L_qkv_c2:
  s_nop 11
  ds_write_b128 v156, v[32:35]
  ds_write_b128 v156, v[36:39] offset:1024
  s_waitcnt lgkmcnt(0)
  s_barrier
  ds_read_b128 v[88:91], v157 offset:0
  ds_read_b128 v[92:95], v157 offset:1024
  ds_read_b128 v[96:99], v157 offset:2048
  ds_read_b128 v[100:103], v157 offset:3072
  ds_read_b128 v[104:107], v157 offset:4096
  ds_read_b128 v[108:111], v157 offset:5120
  ds_read_b128 v[112:115], v157 offset:6144
  ds_read_b128 v[116:119], v157 offset:7168
  s_waitcnt lgkmcnt(0)
  v_add_f32 v88, v88, v96
  v_add_f32 v104, v104, v112
  v_add_f32 v176, v88, v104
  v_add_f32 v89, v89, v97
  v_add_f32 v105, v105, v113
  v_add_f32 v177, v89, v105
  v_add_f32 v90, v90, v98
  v_add_f32 v106, v106, v114
  v_add_f32 v178, v90, v106
  v_add_f32 v91, v91, v99
  v_add_f32 v107, v107, v115
  v_add_f32 v179, v91, v107
  v_add_f32 v92, v92, v100
  v_add_f32 v108, v108, v116
  v_add_f32 v180, v92, v108
  v_add_f32 v93, v93, v101
  v_add_f32 v109, v109, v117
  v_add_f32 v181, v93, v109
  v_add_f32 v94, v94, v102
  v_add_f32 v110, v110, v118
  v_add_f32 v182, v94, v110
  v_add_f32 v95, v95, v103
  v_add_f32 v111, v111, v119
  v_add_f32 v183, v95, v111
  buffer_store_dwordx4 v[176:179], v1, s[4:7], s39 offen sc1
  buffer_store_dwordx4 v[180:183], v1, s[4:7], s39 offen offset:1024 sc1
  s_mul_i32 s38, s3, 0x1000
  s_add_u32 s38, s38, 0x6b6000
  s_lshl_b32 s17, s13, 7
  s_add_u32 s38, s38, s17
L_poll_1:
  buffer_load_dword v172, v174, s[4:7], s38 offen offset:0 sc1
  s_waitcnt vmcnt(0)
  v_cmp_ne_u32 vcc, v11, v172
  s_nop 1
  s_cbranch_vccnz L_poll_1
L_poll_1_out:
  v_lshlrev_b32 v168, 4, v3
  v_lshl_add_u32 v168, v4, 11, v168
  buffer_load_dwordx4 v[136:139], v168, s[4:7], s30 offen offset:0 sc1
  buffer_load_dwordx4 v[140:143], v168, s[4:7], s30 offen offset:512 sc1
  buffer_load_dwordx4 v[144:147], v168, s[4:7], s30 offen offset:1024 sc1
  buffer_load_dwordx4 v[148:151], v168, s[4:7], s30 offen offset:1536 sc1
  buffer_load_dwordx4 a[224:227], v1, s[4:7], s23 offen offset:0 sc1
  buffer_load_dwordx4 a[228:231], v1, s[4:7], s23 offen offset:1024 sc1
  buffer_load_dwordx4 a[232:235], v1, s[4:7], s23 offen offset:2048 sc1
  buffer_load_dwordx4 a[236:239], v1, s[4:7], s23 offen offset:3072 sc1
  buffer_load_dwordx4 a[240:243], v5, s[4:7], s23 offen offset:0 sc1
  buffer_load_dwordx4 a[244:247], v5, s[4:7], s23 offen offset:1024 sc1
  buffer_load_dwordx4 a[248:251], v5, s[4:7], s23 offen offset:2048 sc1
  buffer_load_dwordx4 a[252:255], v5, s[4:7], s23 offen offset:3072 sc1
  buffer_load_dwordx4 v[56:59], v240, s[40:43], s54 offen
  s_add_u32 s54, s54, 8192
  buffer_load_dwordx4 v[60:63], v240, s[40:43], s54 offen
  s_add_u32 s54, s54, 8192
  buffer_load_dwordx4 v[64:67], v240, s[40:43], s54 offen
  s_add_u32 s54, s54, 8192
  buffer_load_dwordx4 v[68:71], v240, s[40:43], s54 offen
  s_add_u32 s54, s54, 8192
  buffer_load_dwordx4 v[72:75], v240, s[40:43], s54 offen
  s_add_u32 s54, s54, 8192
  buffer_load_dwordx4 v[76:79], v240, s[40:43], s54 offen
  s_add_u32 s54, s54, 8192
  buffer_load_dwordx4 v[80:83], v240, s[40:43], s54 offen
  s_add_u32 s54, s54, 8192
  buffer_load_dwordx4 v[84:87], v240, s[40:43], s54 offen
  s_add_u32 s54, s54, 8192
  buffer_load_dwordx4 v[200:203], v241, s[44:47], s48 offen
  s_add_u32 s48, s48, s49
  s_and_b32 s48, s48, s52
  buffer_load_dwordx4 v[204:207], v241, s[44:47], s48 offen
  s_add_u32 s48, s48, s49
  s_and_b32 s48, s48, s52
  buffer_load_dwordx4 v[208:211], v241, s[44:47], s48 offen
  s_add_u32 s48, s48, s49
  s_and_b32 s48, s48, s52
  buffer_load_dwordx4 v[212:215], v241, s[44:47], s48 offen
  s_add_u32 s48, s48, s49
  s_and_b32 s48, s48, s52
  buffer_load_dwordx4 v[216:219], v241, s[44:47], s48 offen
  s_add_u32 s48, s48, s49
  s_and_b32 s48, s48, s52
  buffer_load_dwordx4 v[220:223], v241, s[44:47], s48 offen
  s_add_u32 s48, s48, s49
  s_and_b32 s48, s48, s52
  buffer_load_dwordx4 v[224:227], v241, s[44:47], s48 offen
  s_add_u32 s48, s48, s49
  s_and_b32 s48, s48, s52
  buffer_load_dwordx4 v[228:231], v241, s[44:47], s48 offen
  s_add_u32 s48, s48, s49
  s_and_b32 s48, s48, s52
  s_waitcnt vmcnt(24)
  v_add_f32 v136, v136, v144
  v_add_f32 v137, v137, v145
  v_add_f32 v138, v138, v146
  v_add_f32 v139, v139, v147
  v_add_f32 v140, v140, v148
  v_add_f32 v141, v141, v149
  v_add_f32 v142, v142, v150
  v_add_f32 v143, v143, v151
  v_add_f32 v136, v136, v140
  v_add_f32 v137, v137, v141
  v_add_f32 v138, v138, v142
  v_add_f32 v139, v139, v143
  v_add_f32 v136, v136, v138
  v_add_f32 v137, v137, v139
  v_mov_b32 v138, v136
  v_mov_b32 v139, v137
  s_nop 0
  v_permlane32_swap_b32 v136, v138
  v_permlane32_swap_b32 v137, v139
  v_add_f32 v136, v136, v138
  v_add_f32 v137, v137, v139
  v_mul_f32 v188, 0xbb000000, v136
  v_mul_f32 v137, 0x3b000000, v137
  v_fma_f32 v137, -v188, v188, v137
  v_max_f32 v137, 0, v137
  v_add_f32 v137, 0x3727c5ac, v137
  v_rsq_f32 v189, v137
  s_lshl_b32 s17, s12, 8
  s_add_u32 s17, s17, 114688
  v_add_u32 v172, s17, v174
  v_mul_f32 v173, v188, v189
  ds_write_b32 v172, v189
  ds_write_b32 v172, v173 offset:128
  s_lshr_b32 s18, s12, 1
  s_bitcmp1_b32 s14, 0
  s_cselect_b32 s18, s18, 1
  s_lshl_b32 s19, s18, 6
  s_add_u32 s17, s17, s19
  v_add_u32 v172, s17, v169
  s_lshl_b32 s19, s18, 11
  v_add_u32 v171, s19, v171
  ds_read_b128 v[40:43], v172 offset:0
  ds_read_b128 v[48:51], v172 offset:128
  ds_read_b128 v[44:47], v172 offset:32
  ds_read_b128 v[52:55], v172 offset:160
  s_lshl_b32 s17, s31, 10
  s_add_u32 s34, s33, s17
  s_bitcmp1_b32 s14, 0
  s_cbranch_scc1 L_qkv_v1_0
  s_waitcnt vmcnt(23)
  v_mfma_f32_32x32x16_bf16 v[88:103], a[128:131], a[224:227], 0
  s_waitcnt vmcnt(22)
  v_mfma_f32_32x32x16_bf16 v[88:103], a[132:135], a[228:231], v[88:103]
  s_waitcnt vmcnt(21)
  v_mfma_f32_32x32x16_bf16 v[88:103], a[136:139], a[232:235], v[88:103]
  s_waitcnt vmcnt(20)
  v_mfma_f32_32x32x16_bf16 v[88:103], a[140:143], a[236:239], v[88:103]
  s_waitcnt vmcnt(19)
  v_mfma_f32_32x32x16_bf16 v[88:103], a[144:147], a[240:243], v[88:103]
  s_waitcnt vmcnt(18)
  v_mfma_f32_32x32x16_bf16 v[88:103], a[148:151], a[244:247], v[88:103]
  s_waitcnt vmcnt(17)
  v_mfma_f32_32x32x16_bf16 v[88:103], a[152:155], a[248:251], v[88:103]
  s_waitcnt vmcnt(16)
  v_mfma_f32_32x32x16_bf16 v[88:103], a[156:159], a[252:255], v[88:103]
  v_lshlrev_b32 v172, 10, v2
  s_branch L_qkv_kvred_0
L_qkv_v1_0:
  s_waitcnt vmcnt(23)
  v_mfma_f32_32x32x16_bf16 v[88:103], a[224:227], a[128:131], 0
  s_waitcnt vmcnt(22)
  v_mfma_f32_32x32x16_bf16 v[88:103], a[228:231], a[132:135], v[88:103]
  s_waitcnt vmcnt(21)
  v_mfma_f32_32x32x16_bf16 v[88:103], a[232:235], a[136:139], v[88:103]
  s_waitcnt vmcnt(20)
  v_mfma_f32_32x32x16_bf16 v[88:103], a[236:239], a[140:143], v[88:103]
  s_waitcnt vmcnt(19)
  v_mfma_f32_32x32x16_bf16 v[88:103], a[240:243], a[144:147], v[88:103]
  s_waitcnt vmcnt(18)
  v_mfma_f32_32x32x16_bf16 v[88:103], a[244:247], a[148:151], v[88:103]
  s_waitcnt vmcnt(17)
  v_mfma_f32_32x32x16_bf16 v[88:103], a[248:251], a[152:155], v[88:103]
  s_waitcnt vmcnt(16)
  v_mfma_f32_32x32x16_bf16 v[88:103], a[252:255], a[156:159], v[88:103]
  v_lshlrev_b32 v172, 10, v2
  v_lshlrev_b32 v173, 4, v3
  v_lshl_add_u32 v173, v4, 8, v173
  s_lshl_b32 s19, s18, 9
  s_add_u32 s34, s34, s19
  s_add_u32 s34, s34, 0x10000
  s_lshl_b32 s19, s18, 2
  s_add_u32 s37, s37, s19
  s_nop 3
  ds_write_b128 v170, v[88:91] offset:0
  ds_write_b128 v170, v[92:95] offset:1024
L_qkv_kvred_0:
  s_nop 9
  ds_write_b128 v170, v[96:99] offset:2048
  ds_write_b128 v170, v[100:103] offset:3072
  s_waitcnt lgkmcnt(0)
  s_barrier
  s_and_b32 s17, s12, 1
  s_cmp_lg_u32 s17, s36
  s_cbranch_scc1 L_kv0_done
  s_and_b32 s17, s14, 1
  s_lshl_b32 s17, s17, 1
  s_add_u32 s17, s17, 1
  s_cmp_gt_u32 s12, s17
  s_cbranch_scc1 L_kv0_done
  ds_read_b128 v[104:107], v171 offset:0
  ds_read_b128 v[108:111], v171 offset:1024
  ds_read_b128 v[112:115], v171 offset:4096
  ds_read_b128 v[116:119], v171 offset:5120
  ds_read_b128 v[120:123], v171 offset:8192
  ds_read_b128 v[124:127], v171 offset:9216
  ds_read_b128 v[128:131], v171 offset:12288
  ds_read_b128 v[132:135], v171 offset:13312
  s_waitcnt lgkmcnt(4)
  v_add_f32 v104, v104, v112
  v_add_f32 v105, v105, v113
  v_add_f32 v106, v106, v114
  v_add_f32 v107, v107, v115
  v_add_f32 v108, v108, v116
  v_add_f32 v109, v109, v117
  v_add_f32 v110, v110, v118
  v_add_f32 v111, v111, v119
  s_waitcnt lgkmcnt(0)
  v_add_f32 v120, v120, v128
  v_add_f32 v121, v121, v129
  v_add_f32 v122, v122, v130
  v_add_f32 v123, v123, v131
  v_add_f32 v124, v124, v132
  v_add_f32 v125, v125, v133
  v_add_f32 v126, v126, v134
  v_add_f32 v127, v127, v135
  v_add_f32 v104, v104, v120
  v_add_f32 v105, v105, v121
  v_add_f32 v106, v106, v122
  v_add_f32 v107, v107, v123
  v_add_f32 v108, v108, v124
  v_add_f32 v109, v109, v125
  v_add_f32 v110, v110, v126
  v_add_f32 v111, v111, v127
  s_bitcmp1_b32 s14, 0
  s_cbranch_scc1 L_qkv_vfin_0
  v_fmac_f32 v104, v188, v176
  v_mul_f32 v104, v189, v104
  v_fmac_f32 v105, v188, v177
  v_mul_f32 v105, v189, v105
  v_fmac_f32 v106, v188, v178
  v_mul_f32 v106, v189, v106
  v_fmac_f32 v107, v188, v179
  v_mul_f32 v107, v189, v107
  v_fmac_f32 v108, v188, v180
  v_mul_f32 v108, v189, v108
  v_fmac_f32 v109, v188, v181
  v_mul_f32 v109, v189, v109
  v_fmac_f32 v110, v188, v182
  v_mul_f32 v110, v189, v110
  v_fmac_f32 v111, v188, v183
  v_mul_f32 v111, v189, v111
  v_cvt_pk_bf16_f32 v112, v104, v105
  v_cvt_pk_bf16_f32 v113, v106, v107
  v_cvt_pk_bf16_f32 v114, v108, v109
  v_cvt_pk_bf16_f32 v115, v110, v111
  buffer_store_dwordx4 v[112:115], v1, s[4:7], s34 offen sc1
  v_mov_b32 v116, 0
  v_dot2_f32_bf16 v116, v112, v112, v116
  v_dot2_f32_bf16 v116, v113, v113, v116
  v_dot2_f32_bf16 v116, v114, v114, v116
  v_dot2_f32_bf16 v116, v115, v115, v116
  s_nop 2
  v_mov_b32 v117, v116
  s_nop 1
  v_permlane32_swap_b32 v116, v117
  v_add_f32 v116, v116, v117
  s_nop 1
  v_max_f32_dpp v116, v116, v116 row_shr:1 row_mask:0xf bank_mask:0xf
  s_nop 1
  v_max_f32_dpp v116, v116, v116 row_shr:2 row_mask:0xf bank_mask:0xf
  s_nop 1
  v_max_f32_dpp v116, v116, v116 row_shr:4 row_mask:0xf bank_mask:0xf
  s_nop 1
  v_max_f32_dpp v116, v116, v116 row_shr:8 row_mask:0xf bank_mask:0xf
  s_nop 1
  v_max_f32_dpp v116, v116, v116 row_bcast:15 row_mask:0xa bank_mask:0xf
  s_nop 0
  v_readlane_b32 s18, v116, 31
  v_mov_b32 v118, v11
  s_nop 0
  v_mov_b32 v119, s18
  s_waitcnt vmcnt(0)
  s_mov_b64 exec, 0xff
  buffer_store_dwordx2 v[118:119], v172, s[4:7], s37 offen sc1
  s_mov_b64 exec, -1
  s_branch L_kv0_done
L_qkv_vfin_0:
  v_mul_f32 v104, v40, v104
  v_fmac_f32 v104, v48, v176
  v_mul_f32 v105, v41, v105
  v_fmac_f32 v105, v49, v176
  v_mul_f32 v106, v42, v106
  v_fmac_f32 v106, v50, v176
  v_mul_f32 v107, v43, v107
  v_fmac_f32 v107, v51, v176
  v_mul_f32 v108, v44, v108
  v_fmac_f32 v108, v52, v176
  v_mul_f32 v109, v45, v109
  v_fmac_f32 v109, v53, v176
  v_mul_f32 v110, v46, v110
  v_fmac_f32 v110, v54, v176
  v_mul_f32 v111, v47, v111
  v_fmac_f32 v111, v55, v176
  v_cvt_pk_bf16_f32 v112, v104, v105
  v_cvt_pk_bf16_f32 v113, v106, v107
  v_cvt_pk_bf16_f32 v114, v108, v109
  v_cvt_pk_bf16_f32 v115, v110, v111
  s_mov_b32 exec_lo, 0xffff
  s_mov_b32 exec_hi, 0xffff
  buffer_store_dwordx4 v[112:115], v173, s[4:7], s34 offen sc1
  s_waitcnt vmcnt(0)
  s_mov_b64 exec, 0xff
  buffer_store_dword v11, v172, s[4:7], s37 offen offset:8 sc1
  s_mov_b64 exec, -1
  s_branch L_kv0_done
L_kv0_none:
  buffer_load_dwordx4 v[56:59], v240, s[40:43], s54 offen
  s_add_u32 s54, s54, 8192
  buffer_load_dwordx4 v[60:63], v240, s[40:43], s54 offen
  s_add_u32 s54, s54, 8192
  buffer_load_dwordx4 v[64:67], v240, s[40:43], s54 offen
  s_add_u32 s54, s54, 8192
  buffer_load_dwordx4 v[68:71], v240, s[40:43], s54 offen
  s_add_u32 s54, s54, 8192
  buffer_load_dwordx4 v[72:75], v240, s[40:43], s54 offen
  s_add_u32 s54, s54, 8192
  buffer_load_dwordx4 v[76:79], v240, s[40:43], s54 offen
  s_add_u32 s54, s54, 8192
  buffer_load_dwordx4 v[80:83], v240, s[40:43], s54 offen
  s_add_u32 s54, s54, 8192
  buffer_load_dwordx4 v[84:87], v240, s[40:43], s54 offen
  s_add_u32 s54, s54, 8192
  buffer_load_dwordx4 v[200:203], v241, s[44:47], s48 offen
  s_add_u32 s48, s48, s49
  s_and_b32 s48, s48, s52
  buffer_load_dwordx4 v[204:207], v241, s[44:47], s48 offen
  s_add_u32 s48, s48, s49
  s_and_b32 s48, s48, s52
  buffer_load_dwordx4 v[208:211], v241, s[44:47], s48 offen
  s_add_u32 s48, s48, s49
  s_and_b32 s48, s48, s52
  buffer_load_dwordx4 v[212:215], v241, s[44:47], s48 offen
  s_add_u32 s48, s48, s49
  s_and_b32 s48, s48, s52
  buffer_load_dwordx4 v[216:219], v241, s[44:47], s48 offen
  s_add_u32 s48, s48, s49
  s_and_b32 s48, s48, s52
  buffer_load_dwordx4 v[220:223], v241, s[44:47], s48 offen
  s_add_u32 s48, s48, s49
  s_and_b32 s48, s48, s52
  buffer_load_dwordx4 v[224:227], v241, s[44:47], s48 offen
  s_add_u32 s48, s48, s49
  s_and_b32 s48, s48, s52
  buffer_load_dwordx4 v[228:231], v241, s[44:47], s48 offen
  s_add_u32 s48, s48, s49
  s_and_b32 s48, s48, s52
L_kv0_done:
  v_add_u32 v233, 4096, v232
  s_waitcnt vmcnt(14)
  ds_write_b128 v236, v[56:59] offset:12288
  ds_write_b128 v236, v[60:63] offset:13824
  s_waitcnt vmcnt(12)
  ds_write_b128 v236, v[64:67] offset:15360
  ds_write_b128 v236, v[68:71] offset:16896
  s_waitcnt vmcnt(10)
  ds_write_b128 v236, v[72:75] offset:18432
  ds_write_b128 v236, v[76:79] offset:19968
  s_waitcnt vmcnt(8)
  ds_write_b128 v236, v[80:83] offset:21504
  ds_write_b128 v236, v[84:87] offset:23040
  s_waitcnt lgkmcnt(0)
  ds_read_b64_tr_b16 a[160:161], v234 offset:0
  ds_read_b64_tr_b16 a[162:163], v234 offset:1536
  ds_read_b64_tr_b16 a[164:165], v234 offset:3072
  ds_read_b64_tr_b16 a[166:167], v234 offset:4608
  ds_read_b64_tr_b16 a[168:169], v234 offset:6144
  ds_read_b64_tr_b16 a[170:171], v234 offset:7680
  ds_read_b64_tr_b16 a[172:173], v234 offset:9216
  ds_read_b64_tr_b16 a[174:175], v234 offset:10752
  ds_read_b64_tr_b16 a[176:177], v234 offset:12288
  ds_read_b64_tr_b16 a[178:179], v234 offset:13824
  ds_read_b64_tr_b16 a[180:181], v234 offset:15360
  ds_read_b64_tr_b16 a[182:183], v234 offset:16896
  ds_read_b64_tr_b16 a[184:185], v234 offset:18432
  ds_read_b64_tr_b16 a[186:187], v234 offset:19968
  ds_read_b64_tr_b16 a[188:189], v234 offset:21504
  ds_read_b64_tr_b16 a[190:191], v234 offset:23040
  ds_read_b64_tr_b16 a[192:193], v235 offset:0
  ds_read_b64_tr_b16 a[194:195], v235 offset:1536
  ds_read_b64_tr_b16 a[196:197], v235 offset:3072
  ds_read_b64_tr_b16 a[198:199], v235 offset:4608
  ds_read_b64_tr_b16 a[200:201], v235 offset:6144
  ds_read_b64_tr_b16 a[202:203], v235 offset:7680
  ds_read_b64_tr_b16 a[204:205], v235 offset:9216
  ds_read_b64_tr_b16 a[206:207], v235 offset:10752
  ds_read_b64_tr_b16 a[208:209], v235 offset:12288
  ds_read_b64_tr_b16 a[210:211], v235 offset:13824
  ds_read_b64_tr_b16 a[212:213], v235 offset:15360
  ds_read_b64_tr_b16 a[214:215], v235 offset:16896
  ds_read_b64_tr_b16 a[216:217], v235 offset:18432
  ds_read_b64_tr_b16 a[218:219], v235 offset:19968
  ds_read_b64_tr_b16 a[220:221], v235 offset:21504
  ds_read_b64_tr_b16 a[222:223], v235 offset:23040
  s_cmp_eq_u32 s56, 0
  s_cbranch_scc1 L_s_xpub
  s_barrier
  s_cmp_eq_u32 s56, 3
  s_cbranch_scc1 L_s_kvw
  s_waitcnt vmcnt(7)
  ds_write_b128 v242, v[200:203] offset:0
  s_waitcnt vmcnt(6)
  ds_write_b128 v242, v[204:207] offset:6144
  s_waitcnt vmcnt(5)
  ds_write_b128 v242, v[208:211] offset:12288
  s_waitcnt vmcnt(4)
  ds_write_b128 v242, v[212:215] offset:18432
  s_waitcnt vmcnt(3)
  ds_write_b128 v242, v[216:219] offset:24576
  s_waitcnt vmcnt(2)
  ds_write_b128 v242, v[220:223] offset:30720
  s_waitcnt vmcnt(1)
  ds_write_b128 v242, v[224:227] offset:36864
  s_waitcnt vmcnt(0)
  ds_write_b128 v242, v[228:231] offset:43008
  s_branch L_s_xpub
L_s_kvw:
  s_waitcnt vmcnt(7)
  ds_write_b128 v242, v[200:203] offset:0
  s_waitcnt vmcnt(6)
  ds_write_b128 v242, v[204:207] offset:32
  s_waitcnt vmcnt(5)
  ds_write_b128 v242, v[208:211] offset:64
  s_waitcnt vmcnt(4)
  ds_write_b128 v242, v[212:215] offset:96
  s_waitcnt vmcnt(0)
L_s_xpub:
  s_cmp_eq_u32 s56, 0
  s_cbranch_scc1 L_s_done
L_s_tr:
  s_waitcnt lgkmcnt(0)
  s_barrier
  ds_read_b64_tr_b16 v[200:201], v243 offset:0
  ds_read_b64_tr_b16 v[202:203], v243 offset:1536
  ds_read_b64_tr_b16 v[204:205], v243 offset:3072
  ds_read_b64_tr_b16 v[206:207], v243 offset:4608
  ds_read_b64_tr_b16 v[208:209], v243 offset:6144
  ds_read_b64_tr_b16 v[210:211], v243 offset:7680
  ds_read_b64_tr_b16 v[212:213], v243 offset:9216
  ds_read_b64_tr_b16 v[214:215], v243 offset:10752
  ds_read_b64_tr_b16 v[216:217], v243 offset:12288
  ds_read_b64_tr_b16 v[218:219], v243 offset:13824
  ds_read_b64_tr_b16 v[220:221], v243 offset:15360
  ds_read_b64_tr_b16 v[222:223], v243 offset:16896
  ds_read_b64_tr_b16 v[224:225], v243 offset:18432
  ds_read_b64_tr_b16 v[226:227], v243 offset:19968
  ds_read_b64_tr_b16 v[228:229], v243 offset:21504
  ds_read_b64_tr_b16 v[230:231], v243 offset:23040
  s_cmp_eq_u32 s56, 2
  s_cbranch_scc1 L_s_nost
  s_waitcnt lgkmcnt(14)
  buffer_store_dwordx4 v[200:203], v232, s[4:7], s55 offen offset:0 sc1
  s_waitcnt lgkmcnt(12)
  buffer_store_dwordx4 v[204:207], v232, s[4:7], s55 offen offset:1024 sc1
  s_waitcnt lgkmcnt(10)
  buffer_store_dwordx4 v[208:211], v232, s[4:7], s55 offen offset:2048 sc1
  s_waitcnt lgkmcnt(8)
  buffer_store_dwordx4 v[212:215], v232, s[4:7], s55 offen offset:3072 sc1
  s_waitcnt lgkmcnt(6)
  buffer_store_dwordx4 v[216:219], v233, s[4:7], s55 offen offset:0 sc1
  s_waitcnt lgkmcnt(4)
  buffer_store_dwordx4 v[220:223], v233, s[4:7], s55 offen offset:1024 sc1
  s_waitcnt lgkmcnt(2)
  buffer_store_dwordx4 v[224:227], v233, s[4:7], s55 offen offset:2048 sc1
  s_waitcnt lgkmcnt(0)
  buffer_store_dwordx4 v[228:231], v233, s[4:7], s55 offen offset:3072 sc1
  s_mov_b32 s55, 0xf0000000
L_s_nost:
  s_cmp_eq_u32 s56, 3
  s_cbranch_scc1 L_s_pub
  s_cmp_eq_u32 s50, 0
  s_cbranch_scc1 L_s_done
  v_mov_b32 v32, 0x3f803f80
  v_mov_b32 v33, 0
  s_waitcnt lgkmcnt(0)
  v_dot2_f32_bf16 v33, v200, v32, v33
  v_dot2_f32_bf16 v33, v201, v32, v33
  v_dot2_f32_bf16 v33, v202, v32, v33
  v_dot2_f32_bf16 v33, v203, v32, v33
  v_dot2_f32_bf16 v33, v204, v32, v33
  v_dot2_f32_bf16 v33, v205, v32, v33
  v_dot2_f32_bf16 v33, v206, v32, v33
  v_dot2_f32_bf16 v33, v207, v32, v33
  v_dot2_f32_bf16 v33, v208, v32, v33
  v_dot2_f32_bf16 v33, v209, v32, v33
  v_dot2_f32_bf16 v33, v210, v32, v33
  v_dot2_f32_bf16 v33, v211, v32, v33
  v_dot2_f32_bf16 v33, v212, v32, v33
  v_dot2_f32_bf16 v33, v213, v32, v33
  v_dot2_f32_bf16 v33, v214, v32, v33
  v_dot2_f32_bf16 v33, v215, v32, v33
  v_dot2_f32_bf16 v33, v216, v32, v33
  v_dot2_f32_bf16 v33, v217, v32, v33
  v_dot2_f32_bf16 v33, v218, v32, v33
  v_dot2_f32_bf16 v33, v219, v32, v33
  v_dot2_f32_bf16 v33, v220, v32, v33
  v_dot2_f32_bf16 v33, v221, v32, v33
  v_dot2_f32_bf16 v33, v222, v32, v33
  v_dot2_f32_bf16 v33, v223, v32, v33
  v_dot2_f32_bf16 v33, v224, v32, v33
  v_dot2_f32_bf16 v33, v225, v32, v33
  v_dot2_f32_bf16 v33, v226, v32, v33
  v_dot2_f32_bf16 v33, v227, v32, v33
  v_dot2_f32_bf16 v33, v228, v32, v33
  v_dot2_f32_bf16 v33, v229, v32, v33
  v_dot2_f32_bf16 v33, v230, v32, v33
  v_dot2_f32_bf16 v33, v231, v32, v33
  v_lshlrev_b32 v24, 2, v0
  v_add_u32 v24, 147456, v24
  s_nop 0
  ds_write_b32 v24, v33
  s_waitcnt lgkmcnt(0)
  s_barrier
  s_and_b32 s17, s12, 2
  s_lshl_b32 s17, s17, 8
  s_add_u32 s17, s17, 147456
  v_lshlrev_b32 v24, 2, v3
  v_add_u32 v25, s17, v24
  ds_read_b32 v36, v25 offset:0
  ds_read_b32 v37, v25 offset:128
  ds_read_b32 v38, v25 offset:256
  ds_read_b32 v39, v25 offset:384
  s_waitcnt lgkmcnt(0)
  v_add_f32 v36, v36, v37
  v_add_f32 v38, v38, v39
  v_add_f32 v36, v36, v38
  v_cvt_pk_bf16_f32 v40, v36, v36
  v_and_b32 v40, 0xffff0000, v40
  v_sub_f32 v43, v36, v40
  v_cvt_pk_bf16_f32 v41, v43, v43
  v_and_b32 v41, 0xffff0000, v41
  v_sub_f32 v43, v43, v41
  v_cvt_pk_bf16_f32 v42, v43, v43
  v_and_b32 v42, 0xffff0000, v42
  v_lshrrev_b32 v37, 16, v40
  v_or_b32 v44, v37, v40
  v_lshrrev_b32 v37, 16, v41
  v_or_b32 v45, v37, v40
  v_lshrrev_b32 v37, 16, v42
  v_or_b32 v46, v37, v41
  v_mov_b32 v47, 0
  v_and_b32 v24, 15, v2
  v_lshlrev_b32 v24, 4, v24
  v_bfe_u32 v25, v2, 4, 1
  s_cmp_eq_u32 s56, 1
  s_cselect_b32 s18, 8, 10
  s_cselect_b32 s19, 10, 11
  v_lshlrev_b32 v25, s18, v25
  v_add_u32 v24, v25, v24
  s_lshr_b32 s17, s12, 1
  s_lshl_b32 s17, s17, s19
  s_add_u32 s50, s50, s17
  s_mov_b32 exec_hi, 0
  buffer_store_dwordx4 v[44:47], v24, s[4:7], s50 offen sc1
  s_mov_b32 exec_hi, -1
  s_cmp_eq_u32 s56, 2
  s_cbranch_scc1 L_s_done
L_s_pub:
  s_lshl_b32 s17, s12, 2
  s_add_u32 s51, s51, s17
  v_lshlrev_b32 v25, 8, v2
  s_cmp_eq_u32 s56, 1
  s_cselect_b32 s17, 0xff, 1
  s_waitcnt vmcnt(0)
  s_mov_b32 exec_hi, 0
  s_mov_b32 exec_lo, s17
  buffer_store_dword v11, v25, s[4:7], s51 offen sc1
  s_mov_b64 exec, -1
L_s_done:
  s_waitcnt lgkmcnt(0)
  s_barrier
  s_mul_i32 s20, s12, 8192
  s_mul_i32 s50, s32, 32768
  s_add_u32 s50, s50, s20
  s_add_u32 s50, s50, 0x0
  s_xor_b32 s21, s32, 1
  s_mul_i32 s51, s21, 32768
  s_add_u32 s51, s51, s20
  s_add_u32 s51, s51, 0x0
  s_lshl_b32 s52, s12, 13
  s_add_u32 s52, s52, 0x780000
  s_and_b32 s17, s2, 7
  s_lshl_b32 s17, s17, 15
  s_add_u32 s52, s52, s17
  s_cmp_ge_u32 s14, 4
  s_cselect_b32 s52, s50, s52
L_layer:
  v_lshlrev_b32 v169, 4, v4
  v_lshlrev_b32 v174, 2, v3
  s_mov_b32 s28, 0x800000
  s_mul_i32 s20, s12, 8192
  s_add_u32 s20, s20, s28
  s_mul_i32 s26, s31, 32768
  s_add_u32 s26, s26, s20
  s_xor_b32 s21, s31, 1
  s_mul_i32 s27, s21, 32768
  s_add_u32 s27, s27, s20
  s_mov_b32 s30, 0x700000
  s_lshl_b32 s17, s31, 12
  s_add_u32 s30, s30, s17
  s_xor_b32 s17, s12, 1
  s_mul_i32 s17, s17, 12288
  s_add_u32 s17, s17, 0
  v_add_u32 v184, s17, v1
  s_xor_b32 s17, s12, 2
  s_mul_i32 s17, s17, 12288
  s_add_u32 s17, s17, 4096
  v_add_u32 v185, s17, v1
  s_xor_b32 s17, s12, 3
  s_mul_i32 s17, s17, 12288
  s_add_u32 s17, s17, 8192
  v_add_u32 v186, s17, v1
  s_mul_i32 s17, s12, 12288
  s_add_u32 s17, s17, 0
  v_add_u32 v187, s17, v1
  s_mul_i32 s33, s3, 0x30000
  s_add_u32 s33, s33, 0x650000
  s_lshr_b32 s36, s14, 1
  s_lshl_b32 s17, s13, 1
  s_add_u32 s17, s17, s36
  s_lshl_b32 s17, s17, 15
  s_add_u32 s23, s17, s28
  s_lshl_b32 s17, s12, 13
  s_add_u32 s23, s23, s17
  s_lshl_b32 s17, s12, 12
  s_add_u32 s17, s17, 49152
  v_add_u32 v170, s17, v1
  v_add_u32 v171, 49152, v1
  s_mul_i32 s37, s3, 0x2000
  s_add_u32 s37, s37, 0x640000
  s_lshl_b32 s17, s13, 5
  s_add_u32 s37, s37, s17
  s_lshl_b32 s17, s36, 4
  s_add_u32 s37, s37, s17
  s_lshl_b32 s39, s2, 11
  s_add_u32 s39, s39, 0x1500000
  v_and_b32 v22, 28, v20
  v_bfe_u32 v198, v2, 3, 1
  s_and_b32 s19, s2, 7
  s_lshl_b32 s17, s14, 5
  s_lshl_b32 s18, s19, 8
  s_add_u32 s17, s17, s18
  s_lshl_b32 s18, s19, 7
  s_add_u32 s18, s18, 0x800
  s_sub_u32 s18, s18, s17
  v_mul_lo_u32 v198, v198, s18
  v_add_u32 v22, v22, v198
  s_add_u32 s59, s17, 0x6be000
  buffer_load_dwordx4 v[176:179], v1, s[4:7], s39 offen sc1
  buffer_load_dwordx4 v[180:183], v1, s[4:7], s39 offen offset:1024 sc1
  s_mul_i32 s38, s3, 0x1000
  s_add_u32 s38, s38, 0x6b6000
  s_lshl_b32 s17, s13, 7
  s_add_u32 s38, s38, s17
L_poll_2:
  buffer_load_dword v172, v174, s[4:7], s38 offen offset:0 sc1
  s_waitcnt vmcnt(0)
  v_cmp_ne_u32 vcc, v11, v172
  s_nop 1
  s_cbranch_vccnz L_poll_2
L_poll_2_out:
  s_cmp_ge_u32 s14, 4
  s_cbranch_scc1 L_qkv_stats
  s_cmp_eq_u32 s3, 0
  s_cbranch_scc1 L_qkv_stats
  v_lshlrev_b32 v168, 4, v3
  v_lshl_add_u32 v168, v4, 11, v168
  buffer_load_dwordx4 v[136:139], v168, s[4:7], s30 offen offset:0 sc1
  buffer_load_dwordx4 v[140:143], v168, s[4:7], s30 offen offset:512 sc1
  buffer_load_dwordx4 v[144:147], v168, s[4:7], s30 offen offset:1024 sc1
  buffer_load_dwordx4 v[148:151], v168, s[4:7], s30 offen offset:1536 sc1
  buffer_load_dwordx4 a[224:227], v1, s[4:7], s23 offen offset:0 sc1
  buffer_load_dwordx4 a[228:231], v1, s[4:7], s23 offen offset:1024 sc1
  buffer_load_dwordx4 a[232:235], v1, s[4:7], s23 offen offset:2048 sc1
  buffer_load_dwordx4 a[236:239], v1, s[4:7], s23 offen offset:3072 sc1
  buffer_load_dwordx4 a[240:243], v5, s[4:7], s23 offen offset:0 sc1
  buffer_load_dwordx4 a[244:247], v5, s[4:7], s23 offen offset:1024 sc1
  buffer_load_dwordx4 a[248:251], v5, s[4:7], s23 offen offset:2048 sc1
  buffer_load_dwordx4 a[252:255], v5, s[4:7], s23 offen offset:3072 sc1
  buffer_load_dwordx4 a[64:67], v1, s[4:7], s27 offen offset:0 sc1
  buffer_load_dwordx4 a[68:71], v1, s[4:7], s27 offen offset:1024 sc1
  buffer_load_dwordx4 a[72:75], v1, s[4:7], s27 offen offset:2048 sc1
  buffer_load_dwordx4 a[76:79], v1, s[4:7], s27 offen offset:3072 sc1
  buffer_load_dwordx4 a[80:83], v5, s[4:7], s27 offen offset:0 sc1
  buffer_load_dwordx4 a[84:87], v5, s[4:7], s27 offen offset:1024 sc1
  buffer_load_dwordx4 a[88:91], v5, s[4:7], s27 offen offset:2048 sc1
  buffer_load_dwordx4 a[92:95], v5, s[4:7], s27 offen offset:3072 sc1
  s_waitcnt vmcnt(16)
  v_add_f32 v136, v136, v144
  v_add_f32 v137, v137, v145
  v_add_f32 v138, v138, v146
  v_add_f32 v139, v139, v147
  v_add_f32 v140, v140, v148
  v_add_f32 v141, v141, v149
  v_add_f32 v142, v142, v150
  v_add_f32 v143, v143, v151
  v_add_f32 v136, v136, v140
  v_add_f32 v137, v137, v141
  v_add_f32 v138, v138, v142
  v_add_f32 v139, v139, v143
  v_add_f32 v136, v136, v138
  v_add_f32 v137, v137, v139
  v_mov_b32 v138, v136
  v_mov_b32 v139, v137
  s_nop 0
  v_permlane32_swap_b32 v136, v138
  v_permlane32_swap_b32 v137, v139
  v_add_f32 v136, v136, v138
  v_add_f32 v137, v137, v139
  v_mul_f32 v188, 0xbb000000, v136
  v_mul_f32 v137, 0x3b000000, v137
  v_fma_f32 v137, -v188, v188, v137
  v_max_f32 v137, 0, v137
  v_add_f32 v137, 0x3727c5ac, v137
  v_rsq_f32 v189, v137
  s_lshl_b32 s17, s12, 8
  s_add_u32 s17, s17, 65536
  v_add_u32 v172, s17, v174
  v_mul_f32 v173, v188, v189
  ds_write_b32 v172, v189
  ds_write_b32 v172, v173 offset:128
  s_lshr_b32 s18, s12, 1
  s_bitcmp1_b32 s14, 0
  s_cselect_b32 s18, s18, 1
  s_lshl_b32 s19, s18, 6
  s_add_u32 s17, s17, s19
  v_add_u32 v172, s17, v169
  s_lshl_b32 s19, s18, 11
  v_add_u32 v171, s19, v171
  ds_read_b128 v[40:43], v172 offset:0
  ds_read_b128 v[48:51], v172 offset:128
  ds_read_b128 v[44:47], v172 offset:32
  ds_read_b128 v[52:55], v172 offset:160
  s_lshl_b32 s17, s31, 10
  s_add_u32 s34, s33, s17
  s_bitcmp1_b32 s14, 0
  s_cbranch_scc1 L_qkv_v1
  s_waitcnt vmcnt(15)
  v_mfma_f32_32x32x16_bf16 v[88:103], a[128:131], a[224:227], 0
  s_waitcnt vmcnt(14)
  v_mfma_f32_32x32x16_bf16 v[88:103], a[132:135], a[228:231], v[88:103]
  s_waitcnt vmcnt(13)
  v_mfma_f32_32x32x16_bf16 v[88:103], a[136:139], a[232:235], v[88:103]
  s_waitcnt vmcnt(12)
  v_mfma_f32_32x32x16_bf16 v[88:103], a[140:143], a[236:239], v[88:103]
  s_waitcnt vmcnt(11)
  v_mfma_f32_32x32x16_bf16 v[88:103], a[144:147], a[240:243], v[88:103]
  s_waitcnt vmcnt(10)
  v_mfma_f32_32x32x16_bf16 v[88:103], a[148:151], a[244:247], v[88:103]
  s_waitcnt vmcnt(9)
  v_mfma_f32_32x32x16_bf16 v[88:103], a[152:155], a[248:251], v[88:103]
  s_waitcnt vmcnt(8)
  v_mfma_f32_32x32x16_bf16 v[88:103], a[156:159], a[252:255], v[88:103]
  v_lshlrev_b32 v172, 10, v2
  s_branch L_qkv_kvred
L_qkv_v1:
  s_waitcnt vmcnt(15)
  v_mfma_f32_32x32x16_bf16 v[88:103], a[224:227], a[128:131], 0
  s_waitcnt vmcnt(14)
  v_mfma_f32_32x32x16_bf16 v[88:103], a[228:231], a[132:135], v[88:103]
  s_waitcnt vmcnt(13)
  v_mfma_f32_32x32x16_bf16 v[88:103], a[232:235], a[136:139], v[88:103]
  s_waitcnt vmcnt(12)
  v_mfma_f32_32x32x16_bf16 v[88:103], a[236:239], a[140:143], v[88:103]
  s_waitcnt vmcnt(11)
  v_mfma_f32_32x32x16_bf16 v[88:103], a[240:243], a[144:147], v[88:103]
  s_waitcnt vmcnt(10)
  v_mfma_f32_32x32x16_bf16 v[88:103], a[244:247], a[148:151], v[88:103]
  s_waitcnt vmcnt(9)
  v_mfma_f32_32x32x16_bf16 v[88:103], a[248:251], a[152:155], v[88:103]
  s_waitcnt vmcnt(8)
  v_mfma_f32_32x32x16_bf16 v[88:103], a[252:255], a[156:159], v[88:103]
  v_lshlrev_b32 v172, 10, v2
  v_lshlrev_b32 v173, 4, v3
  v_lshl_add_u32 v173, v4, 8, v173
  s_lshl_b32 s19, s18, 9
  s_add_u32 s34, s34, s19
  s_add_u32 s34, s34, 0x10000
  s_lshl_b32 s19, s18, 2
  s_add_u32 s37, s37, s19
  s_nop 3
  ds_write_b128 v170, v[88:91] offset:0
  ds_write_b128 v170, v[92:95] offset:1024
L_qkv_kvred:
  s_nop 9
  ds_write_b128 v170, v[96:99] offset:2048
  ds_write_b128 v170, v[100:103] offset:3072
  s_waitcnt lgkmcnt(0)
  s_barrier
  s_and_b32 s17, s12, 1
  s_cmp_lg_u32 s17, s36
  s_cbranch_scc1 L_qkv_q
  s_and_b32 s17, s14, 1
  s_lshl_b32 s17, s17, 1
  s_add_u32 s17, s17, 1
  s_cmp_gt_u32 s12, s17
  s_cbranch_scc1 L_qkv_q
  ds_read_b128 v[104:107], v171 offset:0
  ds_read_b128 v[108:111], v171 offset:1024
  ds_read_b128 v[112:115], v171 offset:4096
  ds_read_b128 v[116:119], v171 offset:5120
  ds_read_b128 v[120:123], v171 offset:8192
  ds_read_b128 v[124:127], v171 offset:9216
  ds_read_b128 v[128:131], v171 offset:12288
  ds_read_b128 v[132:135], v171 offset:13312
  s_waitcnt lgkmcnt(4)
  v_add_f32 v104, v104, v112
  v_add_f32 v105, v105, v113
  v_add_f32 v106, v106, v114
  v_add_f32 v107, v107, v115
  v_add_f32 v108, v108, v116
  v_add_f32 v109, v109, v117
  v_add_f32 v110, v110, v118
  v_add_f32 v111, v111, v119
  s_waitcnt lgkmcnt(0)
  v_add_f32 v120, v120, v128
  v_add_f32 v121, v121, v129
  v_add_f32 v122, v122, v130
  v_add_f32 v123, v123, v131
  v_add_f32 v124, v124, v132
  v_add_f32 v125, v125, v133
  v_add_f32 v126, v126, v134
  v_add_f32 v127, v127, v135
  v_add_f32 v104, v104, v120
  v_add_f32 v105, v105, v121
  v_add_f32 v106, v106, v122
  v_add_f32 v107, v107, v123
  v_add_f32 v108, v108, v124
  v_add_f32 v109, v109, v125
  v_add_f32 v110, v110, v126
  v_add_f32 v111, v111, v127
  s_bitcmp1_b32 s14, 0
  s_cbranch_scc1 L_qkv_vfin
  v_fmac_f32 v104, v188, v176
  v_mul_f32 v104, v189, v104
  v_fmac_f32 v105, v188, v177
  v_mul_f32 v105, v189, v105
  v_fmac_f32 v106, v188, v178
  v_mul_f32 v106, v189, v106
  v_fmac_f32 v107, v188, v179
  v_mul_f32 v107, v189, v107
  v_fmac_f32 v108, v188, v180
  v_mul_f32 v108, v189, v108
  v_fmac_f32 v109, v188, v181
  v_mul_f32 v109, v189, v109
  v_fmac_f32 v110, v188, v182
  v_mul_f32 v110, v189, v110
  v_fmac_f32 v111, v188, v183
  v_mul_f32 v111, v189, v111
  v_cvt_pk_bf16_f32 v112, v104, v105
  v_cvt_pk_bf16_f32 v113, v106, v107
  v_cvt_pk_bf16_f32 v114, v108, v109
  v_cvt_pk_bf16_f32 v115, v110, v111
  buffer_store_dwordx4 v[112:115], v1, s[4:7], s34 offen sc1
  v_mov_b32 v116, 0
  v_dot2_f32_bf16 v116, v112, v112, v116
  v_dot2_f32_bf16 v116, v113, v113, v116
  v_dot2_f32_bf16 v116, v114, v114, v116
  v_dot2_f32_bf16 v116, v115, v115, v116
  s_nop 2
  v_mov_b32 v117, v116
  s_nop 1
  v_permlane32_swap_b32 v116, v117
  v_add_f32 v116, v116, v117
  s_nop 1
  v_max_f32_dpp v116, v116, v116 row_shr:1 row_mask:0xf bank_mask:0xf
  s_nop 1
  v_max_f32_dpp v116, v116, v116 row_shr:2 row_mask:0xf bank_mask:0xf
  s_nop 1
  v_max_f32_dpp v116, v116, v116 row_shr:4 row_mask:0xf bank_mask:0xf
  s_nop 1
  v_max_f32_dpp v116, v116, v116 row_shr:8 row_mask:0xf bank_mask:0xf
  s_nop 1
  v_max_f32_dpp v116, v116, v116 row_bcast:15 row_mask:0xa bank_mask:0xf
  s_nop 0
  v_readlane_b32 s18, v116, 31
  v_mov_b32 v118, v11
  s_nop 0
  v_mov_b32 v119, s18
  s_waitcnt vmcnt(0)
  s_mov_b64 exec, 0xff
  buffer_store_dwordx2 v[118:119], v172, s[4:7], s37 offen sc1
  s_mov_b64 exec, -1
  s_branch L_qkv_q
L_qkv_vfin:
  v_mul_f32 v104, v40, v104
  v_fmac_f32 v104, v48, v176
  v_mul_f32 v105, v41, v105
  v_fmac_f32 v105, v49, v176
  v_mul_f32 v106, v42, v106
  v_fmac_f32 v106, v50, v176
  v_mul_f32 v107, v43, v107
  v_fmac_f32 v107, v51, v176
  v_mul_f32 v108, v44, v108
  v_fmac_f32 v108, v52, v176
  v_mul_f32 v109, v45, v109
  v_fmac_f32 v109, v53, v176
  v_mul_f32 v110, v46, v110
  v_fmac_f32 v110, v54, v176
  v_mul_f32 v111, v47, v111
  v_fmac_f32 v111, v55, v176
  v_cvt_pk_bf16_f32 v112, v104, v105
  v_cvt_pk_bf16_f32 v113, v106, v107
  v_cvt_pk_bf16_f32 v114, v108, v109
  v_cvt_pk_bf16_f32 v115, v110, v111
  s_mov_b32 exec_lo, 0xffff
  s_mov_b32 exec_hi, 0xffff
  buffer_store_dwordx4 v[112:115], v173, s[4:7], s34 offen sc1
  s_waitcnt vmcnt(0)
  s_mov_b64 exec, 0xff
  buffer_store_dword v11, v172, s[4:7], s37 offen offset:8 sc1
  s_mov_b64 exec, -1
  s_branch L_qkv_q
L_qkv_stats:
  v_lshlrev_b32 v168, 4, v3
  v_lshl_add_u32 v168, v4, 11, v168
  buffer_load_dwordx4 v[136:139], v168, s[4:7], s30 offen offset:0 sc1
  buffer_load_dwordx4 v[140:143], v168, s[4:7], s30 offen offset:512 sc1
  buffer_load_dwordx4 v[144:147], v168, s[4:7], s30 offen offset:1024 sc1
  buffer_load_dwordx4 v[148:151], v168, s[4:7], s30 offen offset:1536 sc1
  buffer_load_dwordx4 a[64:67], v1, s[4:7], s27 offen offset:0 sc1
  buffer_load_dwordx4 a[68:71], v1, s[4:7], s27 offen offset:1024 sc1
  buffer_load_dwordx4 a[72:75], v1, s[4:7], s27 offen offset:2048 sc1
  buffer_load_dwordx4 a[76:79], v1, s[4:7], s27 offen offset:3072 sc1
  buffer_load_dwordx4 a[80:83], v5, s[4:7], s27 offen offset:0 sc1
  buffer_load_dwordx4 a[84:87], v5, s[4:7], s27 offen offset:1024 sc1
  buffer_load_dwordx4 a[88:91], v5, s[4:7], s27 offen offset:2048 sc1
  buffer_load_dwordx4 a[92:95], v5, s[4:7], s27 offen offset:3072 sc1
  s_waitcnt vmcnt(8)
  v_add_f32 v136, v136, v144
  v_add_f32 v137, v137, v145
  v_add_f32 v138, v138, v146
  v_add_f32 v139, v139, v147
  v_add_f32 v140, v140, v148
  v_add_f32 v141, v141, v149
  v_add_f32 v142, v142, v150
  v_add_f32 v143, v143, v151
  v_add_f32 v136, v136, v140
  v_add_f32 v137, v137, v141
  v_add_f32 v138, v138, v142
  v_add_f32 v139, v139, v143
  v_add_f32 v136, v136, v138
  v_add_f32 v137, v137, v139
  v_mov_b32 v138, v136
  v_mov_b32 v139, v137
  s_nop 0
  v_permlane32_swap_b32 v136, v138
  v_permlane32_swap_b32 v137, v139
  v_add_f32 v136, v136, v138
  v_add_f32 v137, v137, v139
  v_mul_f32 v188, 0xbb000000, v136
  v_mul_f32 v137, 0x3b000000, v137
  v_fma_f32 v137, -v188, v188, v137
  v_max_f32 v137, 0, v137
  v_add_f32 v137, 0x3727c5ac, v137
  v_rsq_f32 v189, v137
L_qkv_q:
  v_cvt_pk_bf16_f32 v160, v188, v188
  v_and_b32 v160, 0xffff0000, v160
  v_sub_f32 v163, v188, v160
  v_cvt_pk_bf16_f32 v161, v163, v163
  v_and_b32 v161, 0xffff0000, v161
  v_sub_f32 v163, v163, v161
  v_cvt_pk_bf16_f32 v162, v163, v163
  v_and_b32 v162, 0xffff0000, v162
  v_lshrrev_b32 v163, 16, v160
  v_or_b32 v156, v163, v161
  v_or_b32 v157, v163, v162
  v_mov_b32 v158, v156
  v_mov_b32 v159, 0
  buffer_load_dwordx4 a[96:99], v1, s[4:7], s26 offen offset:0 sc1
  buffer_load_dwordx4 a[100:103], v1, s[4:7], s26 offen offset:1024 sc1
  buffer_load_dwordx4 a[104:107], v1, s[4:7], s26 offen offset:2048 sc1
  buffer_load_dwordx4 a[108:111], v1, s[4:7], s26 offen offset:3072 sc1
  s_waitcnt vmcnt(11)
  v_mfma_f32_32x32x16_bf16 v[40:55], a[160:163], a[64:67], 0
  v_mfma_f32_32x32x16_bf16 v[72:87], a[192:195], a[64:67], 0
  buffer_load_dwordx4 a[112:115], v5, s[4:7], s26 offen offset:0 sc1
  buffer_load_dwordx4 a[116:119], v5, s[4:7], s26 offen offset:1024 sc1
  s_waitcnt vmcnt(12)
  v_mfma_f32_32x32x16_bf16 v[40:55], a[164:167], a[68:71], v[40:55]
  v_mfma_f32_32x32x16_bf16 v[72:87], a[196:199], a[68:71], v[72:87]
  buffer_load_dwordx4 a[120:123], v5, s[4:7], s26 offen offset:2048 sc1
  buffer_load_dwordx4 a[124:127], v5, s[4:7], s26 offen offset:3072 sc1
  s_waitcnt vmcnt(13)
  v_mfma_f32_32x32x16_bf16 v[40:55], a[168:171], a[72:75], v[40:55]
  v_mfma_f32_32x32x16_bf16 v[72:87], a[200:203], a[72:75], v[72:87]
  buffer_load_dword v198, v22, s[4:7], s59 offen sc1
  s_waitcnt vmcnt(13)
  v_mfma_f32_32x32x16_bf16 v[40:55], a[172:175], a[76:79], v[40:55]
  v_mfma_f32_32x32x16_bf16 v[72:87], a[204:207], a[76:79], v[72:87]
  s_waitcnt vmcnt(12)
  v_mfma_f32_32x32x16_bf16 v[40:55], a[176:179], a[80:83], v[40:55]
  v_mfma_f32_32x32x16_bf16 v[72:87], a[208:211], a[80:83], v[72:87]
  s_waitcnt vmcnt(11)
  v_mfma_f32_32x32x16_bf16 v[40:55], a[180:183], a[84:87], v[40:55]
  v_mfma_f32_32x32x16_bf16 v[72:87], a[212:215], a[84:87], v[72:87]
  s_waitcnt vmcnt(10)
  v_mfma_f32_32x32x16_bf16 v[40:55], a[184:187], a[88:91], v[40:55]
  v_mfma_f32_32x32x16_bf16 v[72:87], a[216:219], a[88:91], v[72:87]
  s_waitcnt vmcnt(9)
  v_mfma_f32_32x32x16_bf16 v[40:55], a[188:191], a[92:95], v[40:55]
  v_mfma_f32_32x32x16_bf16 v[72:87], a[220:223], a[92:95], v[72:87]
  s_waitcnt vmcnt(8)
  v_mfma_f32_32x32x16_bf16 v[56:71], a[192:195], a[96:99], 0
  v_mfma_f32_32x32x16_bf16 v[24:39], a[160:163], a[96:99], 0
  s_waitcnt vmcnt(7)
  v_mfma_f32_32x32x16_bf16 v[56:71], a[196:199], a[100:103], v[56:71]
  v_mfma_f32_32x32x16_bf16 v[24:39], a[164:167], a[100:103], v[24:39]
  s_nop 4
  ds_write_b128 v184, v[40:43] offset:0
  ds_write_b128 v184, v[44:47] offset:1024
  ds_write_b128 v184, v[48:51] offset:2048
  ds_write_b128 v184, v[52:55] offset:3072
  ds_write_b128 v186, v[72:75] offset:0
  ds_write_b128 v186, v[76:79] offset:1024
  ds_write_b128 v186, v[80:83] offset:2048
  ds_write_b128 v186, v[84:87] offset:3072
  s_waitcnt vmcnt(0)
  v_cmp_ne_u32 vcc, v11, v198
  s_nop 1
  s_cbranch_vccz L_qkv_wokq
L_poll_3:
  buffer_load_dword v198, v22, s[4:7], s59 offen offset:0 sc1
  s_waitcnt vmcnt(0)
  v_cmp_ne_u32 vcc, v11, v198
  s_nop 1
  s_cbranch_vccz L_poll_3_out
  s_sleep 1
  s_branch L_poll_3
L_poll_3_out:
L_qkv_wokq:
  s_lshl_b32 s17, s32, 10
  s_add_u32 s17, s17, 0x6e0000
  buffer_load_dwordx4 v[152:155], v1, s[4:7], s17 offen sc1
  s_waitcnt vmcnt(7)
  v_mfma_f32_32x32x16_bf16 v[56:71], a[200:203], a[104:107], v[56:71]
  v_mfma_f32_32x32x16_bf16 v[24:39], a[168:171], a[104:107], v[24:39]
  s_waitcnt vmcnt(6)
  v_mfma_f32_32x32x16_bf16 v[56:71], a[204:207], a[108:111], v[56:71]
  v_mfma_f32_32x32x16_bf16 v[24:39], a[172:175], a[108:111], v[24:39]
  s_waitcnt vmcnt(5)
  v_mfma_f32_32x32x16_bf16 v[56:71], a[208:211], a[112:115], v[56:71]
  v_mfma_f32_32x32x16_bf16 v[24:39], a[176:179], a[112:115], v[24:39]
  s_waitcnt lgkmcnt(0)
  s_barrier
  ds_read_b128 v[88:91], v187 offset:0
  ds_read_b128 v[92:95], v187 offset:1024
  ds_read_b128 v[96:99], v187 offset:2048
  ds_read_b128 v[100:103], v187 offset:3072
  ds_read_b128 v[104:107], v187 offset:8192
  ds_read_b128 v[108:111], v187 offset:9216
  ds_read_b128 v[112:115], v187 offset:10240
  ds_read_b128 v[116:119], v187 offset:11264
  s_waitcnt vmcnt(4)
  v_mfma_f32_32x32x16_bf16 v[56:71], a[212:215], a[116:119], v[56:71]
  v_mfma_f32_32x32x16_bf16 v[24:39], a[180:183], a[116:119], v[24:39]
  s_waitcnt lgkmcnt(0)
  v_add_f32 v88, v88, v104
  v_add_f32 v89, v89, v105
  v_add_f32 v90, v90, v106
  v_add_f32 v91, v91, v107
  v_add_f32 v92, v92, v108
  v_add_f32 v93, v93, v109
  v_add_f32 v94, v94, v110
  v_add_f32 v95, v95, v111
  v_add_f32 v96, v96, v112
  v_add_f32 v97, v97, v113
  s_waitcnt vmcnt(3)
  v_mfma_f32_32x32x16_bf16 v[56:71], a[216:219], a[120:123], v[56:71]
  v_mfma_f32_32x32x16_bf16 v[24:39], a[184:187], a[120:123], v[24:39]
  v_add_f32 v98, v98, v114
  v_add_f32 v99, v99, v115
  v_add_f32 v100, v100, v116
  v_add_f32 v101, v101, v117
  v_add_f32 v102, v102, v118
  v_add_f32 v103, v103, v119
  s_waitcnt vmcnt(2)
  v_mfma_f32_32x32x16_bf16 v[56:71], a[220:223], a[124:127], v[56:71]
  v_mfma_f32_32x32x16_bf16 v[24:39], a[188:191], a[124:127], v[24:39]
  s_waitcnt vmcnt(0)
  v_mfma_f32_32x32x16_bf16 v[24:39], v[152:155], v[156:159], v[24:39]
  s_waitcnt lgkmcnt(0)
  s_nop 7
  ds_write_b128 v185, v[56:59] offset:0
  ds_write_b128 v185, v[60:63] offset:1024
  ds_write_b128 v185, v[64:67] offset:2048
  ds_write_b128 v185, v[68:71] offset:3072
  v_add_f32 v24, v24, v88
  v_add_f32 v25, v25, v89
  v_add_f32 v26, v26, v90
  v_add_f32 v27, v27, v91
  v_add_f32 v28, v28, v92
  v_add_f32 v29, v29, v93
  v_add_f32 v30, v30, v94
  v_add_f32 v31, v31, v95
  v_add_f32 v32, v32, v96
  v_add_f32 v33, v33, v97
  v_add_f32 v34, v34, v98
  v_add_f32 v35, v35, v99
  v_add_f32 v36, v36, v100
  v_add_f32 v37, v37, v101
  v_add_f32 v38, v38, v102
  v_add_f32 v39, v39, v103
  buffer_store_dwordx4 v[200:203], v232, s[4:7], s55 offen offset:0 sc1
  buffer_store_dwordx4 v[204:207], v232, s[4:7], s55 offen offset:1024 sc1
  buffer_store_dwordx4 v[208:211], v232, s[4:7], s55 offen offset:2048 sc1
  buffer_store_dwordx4 v[212:215], v232, s[4:7], s55 offen offset:3072 sc1
  buffer_store_dwordx4 v[216:219], v233, s[4:7], s55 offen offset:0 sc1
  buffer_store_dwordx4 v[220:223], v233, s[4:7], s55 offen offset:1024 sc1
  buffer_store_dwordx4 v[224:227], v233, s[4:7], s55 offen offset:2048 sc1
  buffer_store_dwordx4 v[228:231], v233, s[4:7], s55 offen offset:3072 sc1
  s_waitcnt lgkmcnt(0)
  s_barrier
  ds_read_b128 v[120:123], v187 offset:4096
  ds_read_b128 v[124:127], v187 offset:5120
  ds_read_b128 v[128:131], v187 offset:6144
  ds_read_b128 v[132:135], v187 offset:7168
  s_waitcnt lgkmcnt(3)
  v_add_f32 v24, v24, v120
  v_add_f32 v25, v25, v121
  v_add_f32 v26, v26, v122
  v_add_f32 v27, v27, v123
  s_waitcnt lgkmcnt(2)
  v_add_f32 v28, v28, v124
  v_add_f32 v29, v29, v125
  v_add_f32 v30, v30, v126
  v_add_f32 v31, v31, v127
  s_waitcnt lgkmcnt(1)
  v_add_f32 v32, v32, v128
  v_add_f32 v33, v33, v129
  v_add_f32 v34, v34, v130
  v_add_f32 v35, v35, v131
  s_waitcnt lgkmcnt(0)
  v_add_f32 v36, v36, v132
  v_add_f32 v37, v37, v133
  v_add_f32 v38, v38, v134
  v_add_f32 v39, v39, v135
  v_mul_f32 v168, 0x3eb8aa3b, v189
  v_mul_f32 v24, v168, v24
  v_mul_f32 v25, v168, v25
  v_mul_f32 v26, v168, v26
  v_mul_f32 v27, v168, v27
  v_mul_f32 v28, v168, v28
  v_mul_f32 v29, v168, v29
  v_mul_f32 v30, v168, v30
  v_mul_f32 v31, v168, v31
  v_mul_f32 v32, v168, v32
  v_mul_f32 v33, v168, v33
  v_mul_f32 v34, v168, v34
  v_mul_f32 v35, v168, v35
  v_mul_f32 v36, v168, v36
  v_mul_f32 v37, v168, v37
  v_mul_f32 v38, v168, v38
  v_mul_f32 v39, v168, v39
  v_cvt_pk_bf16_f32 v190, v24, v25
  v_cvt_pk_bf16_f32 v191, v26, v27
  v_cvt_pk_bf16_f32 v192, v28, v29
  v_cvt_pk_bf16_f32 v193, v30, v31
  v_cvt_pk_bf16_f32 v194, v32, v33
  v_cvt_pk_bf16_f32 v195, v34, v35
  v_cvt_pk_bf16_f32 v196, v36, v37
  v_cvt_pk_bf16_f32 v197, v38, v39
  v_mov_b32 v168, 0x3f803f80
  v_and_b32 v169, 2, v0
  v_cmp_eq_u32 vcc, 0, v169
  s_nop 1
  v_cndmask_b32 v168, v21, v168, vcc
  v_mov_b32 v169, v168
  v_mov_b32 v170, v168
  v_mov_b32 v171, v168
  v_lshlrev_b32 v166, 4, v0
  v_add_u32 v166, 131072, v166
  ds_write_b128 v166, v[168:171]
  ds_write_b128 v166, v[168:171] offset:1024
  v_and_b32 v166, 15, v2
  v_lshlrev_b32 v166, 4, v166
  v_lshl_add_u32 v166, v4, 8, v166
  v_add_u32 v161, 65536, v166
  v_add_u32 v167, -20, v3
  v_cmp_gt_u32 vcc, 8, v167
  v_mov_b32 v166, 131072
  v_mov_b32 v167, 131136
  v_cndmask_b32 v166, v166, v167, vcc
  v_and_b32 v167, 27, v3
  v_cmp_ne_u32 vcc, 16, v167
  v_add_u32 v167, 32, v166
  s_nop 0
  v_cndmask_b32 v166, v166, v167, vcc
  v_cmp_le_u32 vcc, 16, v3
  v_mov_b32 v162, 4096
  s_nop 0
  v_cndmask_b32 v161, v161, v166, vcc
  v_cndmask_b32 v162, v162, v21, vcc
  v_mov_b32 v172, 0
  v_dot2_f32_bf16 v172, v190, v190, v172
  v_dot2_f32_bf16 v172, v191, v191, v172
  v_dot2_f32_bf16 v172, v192, v192, v172
  v_dot2_f32_bf16 v172, v193, v193, v172
  v_mov_b32 v173, 0
  v_dot2_f32_bf16 v173, v194, v194, v173
  v_dot2_f32_bf16 v173, v195, v195, v173
  v_dot2_f32_bf16 v173, v196, v196, v173
  v_dot2_f32_bf16 v173, v197, v197, v173
  v_mov_b32 v174, v172
  s_nop 1
  v_permlane32_swap_b32 v172, v174
  v_add_f32 v172, v172, v174
  v_mov_b32 v174, v173
  s_nop 1
  v_permlane32_swap_b32 v173, v174
  v_add_f32 v173, v173, v174
  s_mul_i32 s20, s12, 8192
  s_mul_i32 s24, s32, 32768
  s_add_u32 s24, s24, s20
  s_add_u32 s24, s24, 0x80000
  s_xor_b32 s21, s32, 1
  s_mul_i32 s25, s21, 32768
  s_add_u32 s25, s25, s20
  s_add_u32 s25, s25, 0x80000
  s_mul_i32 s47, s16, 229376
  s_lshl_b32 s48, s12, 13
  s_add_u32 s47, s47, s48
  s_add_u32 s47, s47, 0x100000
  s_mul_i32 s20, s12, 28672
  s_mul_i32 s26, s32, 114688
  s_add_u32 s26, s26, s20
  s_add_u32 s26, s26, 0x480000
  s_xor_b32 s21, s32, 1
  s_mul_i32 s27, s21, 114688
  s_add_u32 s27, s27, s20
  s_add_u32 s27, s27, 0x480000
  s_lshl_b32 s20, s12, 12
  s_add_u32 s21, s33, s20
  s_add_u32 s22, s21, 0x10000
  s_add_u32 s23, s20, 65536
  s_mul_i32 s38, s3, 0x2000
  s_add_u32 s38, s38, 0x640000
  s_and_b32 s17, s2, 7
  s_lshl_b32 s17, s17, 10
  s_add_u32 s38, s38, s17
  s_lshl_b32 s58, s2, 2
  s_add_u32 s58, s58, 0x64c000
  s_or_b32 s17, s12, s3
  s_cmp_lg_u32 s17, 0
  s_cselect_b32 s58, 0xf0000000, s58
  s_and_b32 s59, s2, 7
  s_lshl_b32 s59, s59, 10
  s_add_u32 s59, s59, 0x64c000
  v_lshlrev_b32 v180, 10, v2
  s_getreg_b32 s17, hwreg(HW_REG_XCC_ID)
  s_and_b32 s17, s17, 7
  s_lshl_b32 s17, s17, 1
  v_or_b32 v181, s17, v11
  v_and_b32 v182, 15, v2
  v_lshlrev_b32 v182, 5, v182
  s_and_b32 s17, s2, 0x87
  s_lshl_b32 s17, s17, 2
  v_add_u32 v182, s17, v182
  s_cmp_lg_u32 s12, 0
  s_cbranch_scc1 L_att_nopoll
L_poll_4:
  buffer_load_dwordx4 v[176:179], v1, s[4:7], s38 offen sc1
  s_waitcnt vmcnt(0)
  v_cmp_ne_u32 s[18:19], v11, v178
  s_nop 1
  v_cndmask_b32 v176, v176, v21, s[18:19]
  v_cmp_ne_u32 s[18:19], v11, v179
  s_nop 1
  v_cndmask_b32 v176, v176, v21, s[18:19]
  v_cmp_ne_u32 vcc, v11, v176
  s_nop 1
  s_cbranch_vccz L_poll_4_out
  s_sleep 2
  s_branch L_poll_4
L_poll_4_out:
  v_max_f32_dpp v177, v177, v177 row_shr:1 row_mask:0xf bank_mask:0xf
  s_nop 1
  v_max_f32_dpp v177, v177, v177 row_shr:2 row_mask:0xf bank_mask:0xf
  s_nop 1
  v_max_f32_dpp v177, v177, v177 row_shr:4 row_mask:0xf bank_mask:0xf
  s_nop 1
  v_max_f32_dpp v177, v177, v177 row_shr:8 row_mask:0xf bank_mask:0xf
  s_nop 1
  v_max_f32_dpp v177, v177, v177 row_bcast:15 row_mask:0xa bank_mask:0xf
  s_nop 1
  v_max_f32_dpp v177, v177, v177 row_bcast:31 row_mask:0xc bank_mask:0xf
  v_mov_b32 v176, 135956
  v_add_u32 v176, v20, v176
  s_mov_b32 exec_lo, 0
  s_mov_b32 exec_hi, 0x80000000
  ds_write_b32 v176, v177
  s_mov_b64 exec, -1
  s_waitcnt lgkmcnt(0)
L_att_nopoll:
  s_waitcnt vmcnt(0)
  s_barrier
  s_mov_b64 exec, 0xff
  buffer_store_dword v181, v180, s[4:7], s58 offen sc1
  s_mov_b64 exec, -1
  s_mov_b32 s55, 0xf0000000
  v_mov_b32 v176, 136208
  ds_read_b32 v165, v176
  s_add_u32 m0, s20, 0
  s_add_u32 s17, s21, 0
  buffer_load_dwordx4 v1, s[4:7], s17 offen offset:0 sc1 lds
  buffer_load_dwordx4 v1, s[4:7], s17 offen offset:1024 sc1 lds
  buffer_load_dwordx4 v1, s[4:7], s17 offen offset:2048 sc1 lds
  buffer_load_dwordx4 v1, s[4:7], s17 offen offset:3072 sc1 lds
  s_add_u32 m0, s23, 0
  s_add_u32 s17, s22, 0
  buffer_load_dwordx4 v1, s[4:7], s17 offen offset:0 sc1 lds
  buffer_load_dwordx4 v1, s[4:7], s17 offen offset:1024 sc1 lds
  buffer_load_dwordx4 v1, s[4:7], s17 offen offset:2048 sc1 lds
  buffer_load_dwordx4 v1, s[4:7], s17 offen offset:3072 sc1 lds
  s_waitcnt lgkmcnt(0)
  v_mul_f32 v172, v165, v172
  v_sqrt_f32 v172, v172
  v_mul_f32 v173, v165, v173
  v_sqrt_f32 v173, v173
  v_mul_f32 v172, 0xbf8020c5, v172
  v_mul_f32 v173, 0xbf8020c5, v173
  v_min_f32 v174, v172, v173
  v_mov_b32 v175, 0xc2200000
  v_cmp_nge_f32 vcc, v174, v175
  s_lshl_b32 s19, s12, 2
  s_add_u32 s19, s19, 136192
  v_mov_b32 v176, s19
  s_cmp_lg_u64 vcc, 0
  s_cselect_b32 s18, 1, 0
  v_mov_b32 v175, s18
  ds_write_b32 v176, v175
  v_mov_b32 v24, v172
  v_mov_b32 v25, v172
  v_mov_b32 v26, v172
  v_mov_b32 v27, v172
  v_mov_b32 v28, v172
  v_mov_b32 v29, v172
  v_mov_b32 v30, v172
  v_mov_b32 v31, v172
  v_mov_b32 v32, v172
  v_mov_b32 v33, v172
  v_mov_b32 v34, v172
  v_mov_b32 v35, v172
  v_mov_b32 v36, v172
  v_mov_b32 v37, v172
  v_mov_b32 v38, v172
  v_mov_b32 v39, v172
  v_mov_b32 v40, v173
  v_mov_b32 v41, v173
  v_mov_b32 v42, v173
  v_mov_b32 v43, v173
  v_mov_b32 v44, v173
  v_mov_b32 v45, v173
  v_mov_b32 v46, v173
  v_mov_b32 v47, v173
  v_mov_b32 v48, v173
  v_mov_b32 v49, v173
  v_mov_b32 v50, v173
  v_mov_b32 v51, v173
  v_mov_b32 v52, v173
  v_mov_b32 v53, v173
  v_mov_b32 v54, v173
  v_mov_b32 v55, v173
  s_waitcnt vmcnt(0)
  s_waitcnt lgkmcnt(0)
  s_barrier
  v_mov_b32 v176, 136192
  ds_read_b128 v[168:171], v176
  ds_read_b128 v[136:139], v1
  ds_read_b128 v[144:147], v161
  ds_read_b128 v[148:151], v161 offset:512
  ds_read_b128 v[140:143], v1 offset:1024
  s_waitcnt lgkmcnt(4)
  v_or_b32 v168, v168, v169
  v_or3_b32 v168, v168, v170, v171
  s_nop 0
  v_readfirstlane_b32 s18, v168
  s_nop 1
  s_cmp_eq_u32 s18, 0
  s_cbranch_scc1 L_att_fast
  s_add_u32 m0, s20, 16384
  s_add_u32 s17, s21, 16384
  buffer_load_dwordx4 v1, s[4:7], s17 offen offset:0 sc1 lds
  buffer_load_dwordx4 v1, s[4:7], s17 offen offset:1024 sc1 lds
  buffer_load_dwordx4 v1, s[4:7], s17 offen offset:2048 sc1 lds
  buffer_load_dwordx4 v1, s[4:7], s17 offen offset:3072 sc1 lds
  s_add_u32 m0, s23, 16384
  s_add_u32 s17, s22, 16384
  buffer_load_dwordx4 v1, s[4:7], s17 offen offset:0 sc1 lds
  buffer_load_dwordx4 v1, s[4:7], s17 offen offset:1024 sc1 lds
  buffer_load_dwordx4 v1, s[4:7], s17 offen offset:2048 sc1 lds
  buffer_load_dwordx4 v1, s[4:7], s17 offen offset:3072 sc1 lds
  s_add_u32 m0, s20, 32768
  s_add_u32 s17, s21, 32768
  buffer_load_dwordx4 v1, s[4:7], s17 offen offset:0 sc1 lds
  buffer_load_dwordx4 v1, s[4:7], s17 offen offset:1024 sc1 lds
  buffer_load_dwordx4 v1, s[4:7], s17 offen offset:2048 sc1 lds
  buffer_load_dwordx4 v1, s[4:7], s17 offen offset:3072 sc1 lds
  s_add_u32 m0, s23, 32768
  s_add_u32 s17, s22, 32768
  buffer_load_dwordx4 v1, s[4:7], s17 offen offset:0 sc1 lds
  buffer_load_dwordx4 v1, s[4:7], s17 offen offset:1024 sc1 lds
  buffer_load_dwordx4 v1, s[4:7], s17 offen offset:2048 sc1 lds
  buffer_load_dwordx4 v1, s[4:7], s17 offen offset:3072 sc1 lds
  s_add_u32 m0, s20, 49152
  s_add_u32 s17, s21, 49152
  buffer_load_dwordx4 v1, s[4:7], s17 offen offset:0 sc1 lds
  buffer_load_dwordx4 v1, s[4:7], s17 offen offset:1024 sc1 lds
  buffer_load_dwordx4 v1, s[4:7], s17 offen offset:2048 sc1 lds
  buffer_load_dwordx4 v1, s[4:7], s17 offen offset:3072 sc1 lds
  s_add_u32 m0, s23, 49152
  s_add_u32 s17, s22, 49152
  buffer_load_dwordx4 v1, s[4:7], s17 offen offset:0 sc1 lds
  buffer_load_dwordx4 v1, s[4:7], s17 offen offset:1024 sc1 lds
  buffer_load_dwordx4 v1, s[4:7], s17 offen offset:2048 sc1 lds
  buffer_load_dwordx4 v1, s[4:7], s17 offen offset:3072 sc1 lds
  s_waitcnt vmcnt(0)
  s_barrier
  v_mov_b32 v172, 0xff800000
  v_mov_b32 v173, 0xff800000
  v_mov_b32 v176, v1
  s_mov_b32 s19, 64
L_att_pre:
  ds_read_b128 v[120:123], v176
  v_add_u32 v176, 1024, v176
  s_waitcnt lgkmcnt(0)
  v_mfma_f32_32x32x16_bf16 v[88:103], v[120:123], v[190:193], 0
  v_mfma_f32_32x32x16_bf16 v[104:119], v[120:123], v[194:197], 0
  s_nop 10
  v_max3_f32 v172, v88, v89, v172
  v_max3_f32 v172, v90, v91, v172
  v_max3_f32 v172, v92, v93, v172
  v_max3_f32 v172, v94, v95, v172
  v_max3_f32 v172, v96, v97, v172
  v_max3_f32 v172, v98, v99, v172
  v_max3_f32 v172, v100, v101, v172
  v_max3_f32 v172, v102, v103, v172
  v_max3_f32 v173, v104, v105, v173
  v_max3_f32 v173, v106, v107, v173
  v_max3_f32 v173, v108, v109, v173
  v_max3_f32 v173, v110, v111, v173
  v_max3_f32 v173, v112, v113, v173
  v_max3_f32 v173, v114, v115, v173
  v_max3_f32 v173, v116, v117, v173
  v_max3_f32 v173, v118, v119, v173
  s_sub_u32 s19, s19, 1
  s_cmp_lg_u32 s19, 0
  s_cbranch_scc1 L_att_pre
  v_mov_b32 v174, v172
  s_nop 1
  v_permlane32_swap_b32 v172, v174
  v_max_f32 v172, v172, v174
  v_sub_f32 v172, 0, v172
  v_mov_b32 v24, v172
  v_mov_b32 v25, v172
  v_mov_b32 v26, v172
  v_mov_b32 v27, v172
  v_mov_b32 v28, v172
  v_mov_b32 v29, v172
  v_mov_b32 v30, v172
  v_mov_b32 v31, v172
  v_mov_b32 v32, v172
  v_mov_b32 v33, v172
  v_mov_b32 v34, v172
  v_mov_b32 v35, v172
  v_mov_b32 v36, v172
  v_mov_b32 v37, v172
  v_mov_b32 v38, v172
  v_mov_b32 v39, v172
  v_mov_b32 v174, v173
  s_nop 1
  v_permlane32_swap_b32 v173, v174
  v_max_f32 v173, v173, v174
  v_sub_f32 v173, 0, v173
  v_mov_b32 v40, v173
  v_mov_b32 v41, v173
  v_mov_b32 v42, v173
  v_mov_b32 v43, v173
  v_mov_b32 v44, v173
  v_mov_b32 v45, v173
  v_mov_b32 v46, v173
  v_mov_b32 v47, v173
  v_mov_b32 v48, v173
  v_mov_b32 v49, v173
  v_mov_b32 v50, v173
  v_mov_b32 v51, v173
  v_mov_b32 v52, v173
  v_mov_b32 v53, v173
  v_mov_b32 v54, v173
  v_mov_b32 v55, v173
L_att_fast:
  s_waitcnt lgkmcnt(0)
  v_mfma_f32_32x32x16_bf16 v[88:103], v[136:139], v[190:193], v[24:39]
  s_nop 7
  s_mul_i32 s49, s16, 229376
  s_and_b32 s18, s15, 1
  s_mul_i32 s18, s18, 81920
  s_add_u32 s49, s49, s18
  s_mul_i32 s18, s12, 20480
  s_add_u32 s49, s49, s18
  s_add_u32 s49, s49, 0x110000
  v_lshlrev_b32 v166, 6, v2
  v_mfma_f32_32x32x16_bf16 v[104:119], v[136:139], v[194:197], v[40:55]
  ds_read_b128 v[136:139], v1 offset:2048
  v_exp_f32 v88, v88
  v_exp_f32 v89, v89
  v_exp_f32 v90, v90
  v_exp_f32 v91, v91
  ds_read_b128 v[152:155], v161 offset:1024
  ds_read_b128 v[156:159], v161 offset:1536
  v_exp_f32 v92, v92
  v_exp_f32 v93, v93
  v_exp_f32 v94, v94
  v_exp_f32 v95, v95
  v_exp_f32 v96, v96
  v_cvt_pk_bf16_f32 v120, v88, v89
  v_cvt_pk_bf16_f32 v121, v90, v91
  v_cvt_pk_bf16_f32 v122, v92, v93
  v_cvt_pk_bf16_f32 v123, v94, v95
  v_exp_f32 v97, v97
  v_exp_f32 v98, v98
  v_exp_f32 v99, v99
  v_mfma_f32_32x32x16_bf16 v[56:71], v[144:147], v[120:123], 0
  s_add_u32 m0, s20, 16384
  s_add_u32 s17, s21, 16384
  buffer_load_dwordx4 v1, s[4:7], s17 offen offset:0 sc1 lds
  buffer_load_dwordx4 v1, s[4:7], s17 offen offset:1024 sc1 lds
  v_exp_f32 v100, v100
  v_exp_f32 v101, v101
  v_exp_f32 v102, v102
  v_exp_f32 v103, v103
  v_cvt_pk_bf16_f32 v124, v96, v97
  v_cvt_pk_bf16_f32 v125, v98, v99
  v_cvt_pk_bf16_f32 v126, v100, v101
  v_cvt_pk_bf16_f32 v127, v102, v103
  v_mfma_f32_32x32x16_bf16 v[88:103], v[140:143], v[190:193], v[24:39]
  v_exp_f32 v104, v104
  v_exp_f32 v105, v105
  v_exp_f32 v106, v106
  v_exp_f32 v107, v107
  v_mfma_f32_32x32x16_bf16 v[56:71], v[148:151], v[124:127], v[56:71]
  buffer_load_dwordx4 v1, s[4:7], s17 offen offset:2048 sc1 lds
  buffer_load_dwordx4 v1, s[4:7], s17 offen offset:3072 sc1 lds
  v_exp_f32 v108, v108
  v_exp_f32 v109, v109
  v_exp_f32 v110, v110
  v_exp_f32 v111, v111
  v_exp_f32 v112, v112
  v_cvt_pk_bf16_f32 v128, v104, v105
  v_cvt_pk_bf16_f32 v129, v106, v107
  v_cvt_pk_bf16_f32 v130, v108, v109
  v_cvt_pk_bf16_f32 v131, v110, v111
  v_exp_f32 v113, v113
  v_exp_f32 v114, v114
  v_exp_f32 v115, v115
  v_mfma_f32_32x32x16_bf16 v[72:87], v[144:147], v[128:131], 0
  s_waitcnt lgkmcnt(0)
  v_exp_f32 v116, v116
  v_exp_f32 v117, v117
  v_exp_f32 v118, v118
  v_exp_f32 v119, v119
  v_cvt_pk_bf16_f32 v132, v112, v113
  v_cvt_pk_bf16_f32 v133, v114, v115
  v_cvt_pk_bf16_f32 v134, v116, v117
  v_cvt_pk_bf16_f32 v135, v118, v119
  v_mfma_f32_32x32x16_bf16 v[104:119], v[140:143], v[194:197], v[40:55]
  ds_read_b128 v[140:143], v1 offset:3072
  v_exp_f32 v88, v88
  v_exp_f32 v89, v89
  v_exp_f32 v90, v90
  v_exp_f32 v91, v91
  v_mfma_f32_32x32x16_bf16 v[72:87], v[148:151], v[132:135], v[72:87]
  ds_read_b128 v[144:147], v161 offset:2048
  ds_read_b128 v[148:151], v161 offset:2560
  v_exp_f32 v92, v92
  v_exp_f32 v93, v93
  v_exp_f32 v94, v94
  v_exp_f32 v95, v95
  v_exp_f32 v96, v96
  v_cvt_pk_bf16_f32 v120, v88, v89
  v_cvt_pk_bf16_f32 v121, v90, v91
  v_cvt_pk_bf16_f32 v122, v92, v93
  v_cvt_pk_bf16_f32 v123, v94, v95
  v_exp_f32 v97, v97
  v_exp_f32 v98, v98
  v_exp_f32 v99, v99
  v_mfma_f32_32x32x16_bf16 v[56:71], v[152:155], v[120:123], v[56:71]
  s_add_u32 m0, s23, 16384
  s_add_u32 s17, s22, 16384
  buffer_load_dwordx4 v1, s[4:7], s17 offen offset:0 sc1 lds
  buffer_load_dwordx4 v1, s[4:7], s17 offen offset:1024 sc1 lds
  v_exp_f32 v100, v100
  v_exp_f32 v101, v101
  v_exp_f32 v102, v102
  v_exp_f32 v103, v103
  v_cvt_pk_bf16_f32 v124, v96, v97
  v_cvt_pk_bf16_f32 v125, v98, v99
  v_cvt_pk_bf16_f32 v126, v100, v101
  v_cvt_pk_bf16_f32 v127, v102, v103
  v_mfma_f32_32x32x16_bf16 v[88:103], v[136:139], v[190:193], v[24:39]
  v_exp_f32 v104, v104
  v_exp_f32 v105, v105
  v_exp_f32 v106, v106
  v_exp_f32 v107, v107
  v_mfma_f32_32x32x16_bf16 v[56:71], v[156:159], v[124:127], v[56:71]
  buffer_load_dwordx4 v1, s[4:7], s17 offen offset:2048 sc1 lds
  buffer_load_dwordx4 v1, s[4:7], s17 offen offset:3072 sc1 lds
  v_exp_f32 v108, v108
  v_exp_f32 v109, v109
  v_exp_f32 v110, v110
  v_exp_f32 v111, v111
  v_exp_f32 v112, v112
  v_cvt_pk_bf16_f32 v128, v104, v105
  v_cvt_pk_bf16_f32 v129, v106, v107
  v_cvt_pk_bf16_f32 v130, v108, v109
  v_cvt_pk_bf16_f32 v131, v110, v111
  v_exp_f32 v113, v113
  v_exp_f32 v114, v114
  v_exp_f32 v115, v115
  v_mfma_f32_32x32x16_bf16 v[72:87], v[152:155], v[128:131], v[72:87]
  s_waitcnt lgkmcnt(0)
  v_exp_f32 v116, v116
  v_exp_f32 v117, v117
  v_exp_f32 v118, v118
  v_exp_f32 v119, v119
  v_cvt_pk_bf16_f32 v132, v112, v113
  v_cvt_pk_bf16_f32 v133, v114, v115
  v_cvt_pk_bf16_f32 v134, v116, v117
  v_cvt_pk_bf16_f32 v135, v118, v119
  v_mfma_f32_32x32x16_bf16 v[104:119], v[136:139], v[194:197], v[40:55]
  ds_read_b128 v[136:139], v1 offset:4096
  v_exp_f32 v88, v88
  v_exp_f32 v89, v89
  v_exp_f32 v90, v90
  v_exp_f32 v91, v91
  v_mfma_f32_32x32x16_bf16 v[72:87], v[156:159], v[132:135], v[72:87]
  ds_read_b128 v[152:155], v161 offset:3072
  ds_read_b128 v[156:159], v161 offset:3584
  v_exp_f32 v92, v92
  v_exp_f32 v93, v93
  v_exp_f32 v94, v94
  v_exp_f32 v95, v95
  v_exp_f32 v96, v96
  v_cvt_pk_bf16_f32 v120, v88, v89
  v_cvt_pk_bf16_f32 v121, v90, v91
  v_cvt_pk_bf16_f32 v122, v92, v93
  v_cvt_pk_bf16_f32 v123, v94, v95
  v_exp_f32 v97, v97
  v_exp_f32 v98, v98
  v_exp_f32 v99, v99
  v_mfma_f32_32x32x16_bf16 v[56:71], v[144:147], v[120:123], v[56:71]
  s_add_u32 m0, s20, 32768
  s_add_u32 s17, s21, 32768
  buffer_load_dwordx4 v1, s[4:7], s17 offen offset:0 sc1 lds
  v_exp_f32 v100, v100
  v_exp_f32 v101, v101
  v_exp_f32 v102, v102
  v_exp_f32 v103, v103
  v_cvt_pk_bf16_f32 v124, v96, v97
  v_cvt_pk_bf16_f32 v125, v98, v99
  v_cvt_pk_bf16_f32 v126, v100, v101
  v_cvt_pk_bf16_f32 v127, v102, v103
  v_mfma_f32_32x32x16_bf16 v[88:103], v[140:143], v[190:193], v[24:39]
  v_exp_f32 v104, v104
  v_exp_f32 v105, v105
  v_exp_f32 v106, v106
  v_exp_f32 v107, v107
  v_mfma_f32_32x32x16_bf16 v[56:71], v[148:151], v[124:127], v[56:71]
  buffer_load_dwordx4 v1, s[4:7], s17 offen offset:1024 sc1 lds
  v_exp_f32 v108, v108
  v_exp_f32 v109, v109
  v_exp_f32 v110, v110
  v_exp_f32 v111, v111
  v_exp_f32 v112, v112
  v_cvt_pk_bf16_f32 v128, v104, v105
  v_cvt_pk_bf16_f32 v129, v106, v107
  v_cvt_pk_bf16_f32 v130, v108, v109
  v_cvt_pk_bf16_f32 v131, v110, v111
  v_exp_f32 v113, v113
  v_exp_f32 v114, v114
  v_exp_f32 v115, v115
  v_mfma_f32_32x32x16_bf16 v[72:87], v[144:147], v[128:131], v[72:87]
  s_waitcnt lgkmcnt(0)
  v_exp_f32 v116, v116
  v_exp_f32 v117, v117
  v_exp_f32 v118, v118
  v_exp_f32 v119, v119
  v_cvt_pk_bf16_f32 v132, v112, v113
  v_cvt_pk_bf16_f32 v133, v114, v115
  v_cvt_pk_bf16_f32 v134, v116, v117
  v_cvt_pk_bf16_f32 v135, v118, v119
  v_mfma_f32_32x32x16_bf16 v[104:119], v[140:143], v[194:197], v[40:55]
  ds_read_b128 v[140:143], v1 offset:5120
  v_exp_f32 v88, v88
  v_exp_f32 v89, v89
  v_exp_f32 v90, v90
  v_exp_f32 v91, v91
  v_mfma_f32_32x32x16_bf16 v[72:87], v[148:151], v[132:135], v[72:87]
  ds_read_b128 v[144:147], v161 offset:4096
  ds_read_b128 v[148:151], v161 offset:4608
  v_exp_f32 v92, v92
  v_exp_f32 v93, v93
  v_exp_f32 v94, v94
  v_exp_f32 v95, v95
  v_exp_f32 v96, v96
  v_cvt_pk_bf16_f32 v120, v88, v89
  v_cvt_pk_bf16_f32 v121, v90, v91
  v_cvt_pk_bf16_f32 v122, v92, v93
  v_cvt_pk_bf16_f32 v123, v94, v95
  v_exp_f32 v97, v97
  v_exp_f32 v98, v98
  v_exp_f32 v99, v99
  v_mfma_f32_32x32x16_bf16 v[56:71], v[152:155], v[120:123], v[56:71]
  buffer_load_dwordx4 v1, s[4:7], s17 offen offset:2048 sc1 lds
  v_exp_f32 v100, v100
  v_exp_f32 v101, v101
  v_exp_f32 v102, v102
  v_exp_f32 v103, v103
  v_cvt_pk_bf16_f32 v124, v96, v97
  v_cvt_pk_bf16_f32 v125, v98, v99
  v_cvt_pk_bf16_f32 v126, v100, v101
  v_cvt_pk_bf16_f32 v127, v102, v103
  v_mfma_f32_32x32x16_bf16 v[88:103], v[136:139], v[190:193], v[24:39]
  v_exp_f32 v104, v104
  v_exp_f32 v105, v105
  v_exp_f32 v106, v106
  v_exp_f32 v107, v107
  v_mfma_f32_32x32x16_bf16 v[56:71], v[156:159], v[124:127], v[56:71]
  buffer_load_dwordx4 v1, s[4:7], s17 offen offset:3072 sc1 lds
  v_exp_f32 v108, v108
  v_exp_f32 v109, v109
  v_exp_f32 v110, v110
  v_exp_f32 v111, v111
  v_exp_f32 v112, v112
  v_cvt_pk_bf16_f32 v128, v104, v105
  v_cvt_pk_bf16_f32 v129, v106, v107
  v_cvt_pk_bf16_f32 v130, v108, v109
  v_cvt_pk_bf16_f32 v131, v110, v111
  v_exp_f32 v113, v113
  v_exp_f32 v114, v114
  v_exp_f32 v115, v115
  v_mfma_f32_32x32x16_bf16 v[72:87], v[152:155], v[128:131], v[72:87]
  s_waitcnt lgkmcnt(0)
  v_exp_f32 v116, v116
  v_exp_f32 v117, v117
  v_exp_f32 v118, v118
  v_exp_f32 v119, v119
  v_add_u32 v161, v162, v161
  v_cvt_pk_bf16_f32 v132, v112, v113
  v_cvt_pk_bf16_f32 v133, v114, v115
  v_cvt_pk_bf16_f32 v134, v116, v117
  v_cvt_pk_bf16_f32 v135, v118, v119
  v_mfma_f32_32x32x16_bf16 v[104:119], v[136:139], v[194:197], v[40:55]
  ds_read_b128 v[136:139], v1 offset:6144
  v_exp_f32 v88, v88
  v_exp_f32 v89, v89
  v_exp_f32 v90, v90
  v_exp_f32 v91, v91
  v_mfma_f32_32x32x16_bf16 v[72:87], v[156:159], v[132:135], v[72:87]
  ds_read_b128 v[152:155], v161 offset:1024
  ds_read_b128 v[156:159], v161 offset:1536
  v_exp_f32 v92, v92
  v_exp_f32 v93, v93
  v_exp_f32 v94, v94
  v_exp_f32 v95, v95
  v_exp_f32 v96, v96
  v_cvt_pk_bf16_f32 v120, v88, v89
  v_cvt_pk_bf16_f32 v121, v90, v91
  v_cvt_pk_bf16_f32 v122, v92, v93
  v_cvt_pk_bf16_f32 v123, v94, v95
  v_exp_f32 v97, v97
  v_exp_f32 v98, v98
  v_exp_f32 v99, v99
  v_mfma_f32_32x32x16_bf16 v[56:71], v[144:147], v[120:123], v[56:71]
  s_add_u32 m0, s23, 32768
  s_add_u32 s17, s22, 32768
  buffer_load_dwordx4 v1, s[4:7], s17 offen offset:0 sc1 lds
  v_exp_f32 v100, v100
  v_exp_f32 v101, v101
  v_exp_f32 v102, v102
  v_exp_f32 v103, v103
  v_cvt_pk_bf16_f32 v124, v96, v97
  v_cvt_pk_bf16_f32 v125, v98, v99
  v_cvt_pk_bf16_f32 v126, v100, v101
  v_cvt_pk_bf16_f32 v127, v102, v103
  v_mfma_f32_32x32x16_bf16 v[88:103], v[140:143], v[190:193], v[24:39]
  v_exp_f32 v104, v104
  v_exp_f32 v105, v105
  v_exp_f32 v106, v106
  v_exp_f32 v107, v107
  v_mfma_f32_32x32x16_bf16 v[56:71], v[148:151], v[124:127], v[56:71]
  buffer_load_dwordx4 v1, s[4:7], s17 offen offset:1024 sc1 lds
  v_exp_f32 v108, v108
  v_exp_f32 v109, v109
  v_exp_f32 v110, v110
  v_exp_f32 v111, v111
  v_exp_f32 v112, v112
  v_cvt_pk_bf16_f32 v128, v104, v105
  v_cvt_pk_bf16_f32 v129, v106, v107
  v_cvt_pk_bf16_f32 v130, v108, v109
  v_cvt_pk_bf16_f32 v131, v110, v111
  v_exp_f32 v113, v113
  v_exp_f32 v114, v114
  v_exp_f32 v115, v115
  v_mfma_f32_32x32x16_bf16 v[72:87], v[144:147], v[128:131], v[72:87]
  s_waitcnt lgkmcnt(0)
  v_exp_f32 v116, v116
  v_exp_f32 v117, v117
  v_exp_f32 v118, v118
  v_exp_f32 v119, v119
  v_cvt_pk_bf16_f32 v132, v112, v113
  v_cvt_pk_bf16_f32 v133, v114, v115
  v_cvt_pk_bf16_f32 v134, v116, v117
  v_cvt_pk_bf16_f32 v135, v118, v119
  v_mfma_f32_32x32x16_bf16 v[104:119], v[140:143], v[194:197], v[40:55]
  ds_read_b128 v[140:143], v1 offset:7168
  v_exp_f32 v88, v88
  v_exp_f32 v89, v89
  v_exp_f32 v90, v90
  v_exp_f32 v91, v91
  v_mfma_f32_32x32x16_bf16 v[72:87], v[148:151], v[132:135], v[72:87]
  ds_read_b128 v[144:147], v161 offset:2048
  ds_read_b128 v[148:151], v161 offset:2560
  v_exp_f32 v92, v92
  v_exp_f32 v93, v93
  v_exp_f32 v94, v94
  v_exp_f32 v95, v95
  v_exp_f32 v96, v96
  v_cvt_pk_bf16_f32 v120, v88, v89
  v_cvt_pk_bf16_f32 v121, v90, v91
  v_cvt_pk_bf16_f32 v122, v92, v93
  v_cvt_pk_bf16_f32 v123, v94, v95
  v_exp_f32 v97, v97
  v_exp_f32 v98, v98
  v_exp_f32 v99, v99
  v_mfma_f32_32x32x16_bf16 v[56:71], v[152:155], v[120:123], v[56:71]
  buffer_load_dwordx4 v1, s[4:7], s17 offen offset:2048 sc1 lds
  v_exp_f32 v100, v100
  v_exp_f32 v101, v101
  v_exp_f32 v102, v102
  v_exp_f32 v103, v103
  v_cvt_pk_bf16_f32 v124, v96, v97
  v_cvt_pk_bf16_f32 v125, v98, v99
  v_cvt_pk_bf16_f32 v126, v100, v101
  v_cvt_pk_bf16_f32 v127, v102, v103
  v_mfma_f32_32x32x16_bf16 v[88:103], v[136:139], v[190:193], v[24:39]
  v_exp_f32 v104, v104
  v_exp_f32 v105, v105
  v_exp_f32 v106, v106
  v_exp_f32 v107, v107
  v_mfma_f32_32x32x16_bf16 v[56:71], v[156:159], v[124:127], v[56:71]
  buffer_load_dwordx4 v1, s[4:7], s17 offen offset:3072 sc1 lds
  v_exp_f32 v108, v108
  v_exp_f32 v109, v109
  v_exp_f32 v110, v110
  v_exp_f32 v111, v111
  v_exp_f32 v112, v112
  v_cvt_pk_bf16_f32 v128, v104, v105
  v_cvt_pk_bf16_f32 v129, v106, v107
  v_cvt_pk_bf16_f32 v130, v108, v109
  v_cvt_pk_bf16_f32 v131, v110, v111
  v_exp_f32 v113, v113
  v_exp_f32 v114, v114
  v_exp_f32 v115, v115
  v_mfma_f32_32x32x16_bf16 v[72:87], v[152:155], v[128:131], v[72:87]
  s_waitcnt lgkmcnt(0)
  v_exp_f32 v116, v116
  v_exp_f32 v117, v117
  v_exp_f32 v118, v118
  v_exp_f32 v119, v119
  v_cvt_pk_bf16_f32 v132, v112, v113
  v_cvt_pk_bf16_f32 v133, v114, v115
  v_cvt_pk_bf16_f32 v134, v116, v117
  v_cvt_pk_bf16_f32 v135, v118, v119
  v_mfma_f32_32x32x16_bf16 v[104:119], v[136:139], v[194:197], v[40:55]
  ds_read_b128 v[136:139], v1 offset:8192
  v_exp_f32 v88, v88
  v_exp_f32 v89, v89
  v_exp_f32 v90, v90
  v_exp_f32 v91, v91
  v_mfma_f32_32x32x16_bf16 v[72:87], v[156:159], v[132:135], v[72:87]
  ds_read_b128 v[152:155], v161 offset:3072
  ds_read_b128 v[156:159], v161 offset:3584
  v_exp_f32 v92, v92
  v_exp_f32 v93, v93
  v_exp_f32 v94, v94
  v_exp_f32 v95, v95
  v_exp_f32 v96, v96
  v_cvt_pk_bf16_f32 v120, v88, v89
  v_cvt_pk_bf16_f32 v121, v90, v91
  v_cvt_pk_bf16_f32 v122, v92, v93
  v_cvt_pk_bf16_f32 v123, v94, v95
  v_exp_f32 v97, v97
  v_exp_f32 v98, v98
  v_exp_f32 v99, v99
  v_mfma_f32_32x32x16_bf16 v[56:71], v[144:147], v[120:123], v[56:71]
  s_add_u32 m0, s20, 49152
  s_add_u32 s17, s21, 49152
  buffer_load_dwordx4 v1, s[4:7], s17 offen offset:0 sc1 lds
  v_exp_f32 v100, v100
  v_exp_f32 v101, v101
  v_exp_f32 v102, v102
  v_exp_f32 v103, v103
  v_cvt_pk_bf16_f32 v124, v96, v97
  v_cvt_pk_bf16_f32 v125, v98, v99
  v_cvt_pk_bf16_f32 v126, v100, v101
  v_cvt_pk_bf16_f32 v127, v102, v103
  v_mfma_f32_32x32x16_bf16 v[88:103], v[140:143], v[190:193], v[24:39]
  v_exp_f32 v104, v104
  v_exp_f32 v105, v105
  v_exp_f32 v106, v106
  v_exp_f32 v107, v107
  v_mfma_f32_32x32x16_bf16 v[56:71], v[148:151], v[124:127], v[56:71]
  buffer_load_dwordx4 v1, s[4:7], s17 offen offset:1024 sc1 lds
  v_exp_f32 v108, v108
  v_exp_f32 v109, v109
  v_exp_f32 v110, v110
  v_exp_f32 v111, v111
  v_exp_f32 v112, v112
  v_cvt_pk_bf16_f32 v128, v104, v105
  v_cvt_pk_bf16_f32 v129, v106, v107
  v_cvt_pk_bf16_f32 v130, v108, v109
  v_cvt_pk_bf16_f32 v131, v110, v111
  v_exp_f32 v113, v113
  v_exp_f32 v114, v114
  v_exp_f32 v115, v115
  v_mfma_f32_32x32x16_bf16 v[72:87], v[144:147], v[128:131], v[72:87]
  s_waitcnt lgkmcnt(0)
  v_exp_f32 v116, v116
  v_exp_f32 v117, v117
  v_exp_f32 v118, v118
  v_exp_f32 v119, v119
  v_cvt_pk_bf16_f32 v132, v112, v113
  v_cvt_pk_bf16_f32 v133, v114, v115
  v_cvt_pk_bf16_f32 v134, v116, v117
  v_cvt_pk_bf16_f32 v135, v118, v119
  v_mfma_f32_32x32x16_bf16 v[104:119], v[140:143], v[194:197], v[40:55]
  ds_read_b128 v[140:143], v1 offset:9216
  v_exp_f32 v88, v88
  v_exp_f32 v89, v89
  v_exp_f32 v90, v90
  v_exp_f32 v91, v91
  v_mfma_f32_32x32x16_bf16 v[72:87], v[148:151], v[132:135], v[72:87]
  ds_read_b128 v[144:147], v161 offset:4096
  ds_read_b128 v[148:151], v161 offset:4608
  v_exp_f32 v92, v92
  v_exp_f32 v93, v93
  v_exp_f32 v94, v94
  v_exp_f32 v95, v95
  v_exp_f32 v96, v96
  v_cvt_pk_bf16_f32 v120, v88, v89
  v_cvt_pk_bf16_f32 v121, v90, v91
  v_cvt_pk_bf16_f32 v122, v92, v93
  v_cvt_pk_bf16_f32 v123, v94, v95
  v_exp_f32 v97, v97
  v_exp_f32 v98, v98
  v_exp_f32 v99, v99
  v_mfma_f32_32x32x16_bf16 v[56:71], v[152:155], v[120:123], v[56:71]
  buffer_load_dwordx4 v1, s[4:7], s17 offen offset:2048 sc1 lds
  v_exp_f32 v100, v100
  v_exp_f32 v101, v101
  v_exp_f32 v102, v102
  v_exp_f32 v103, v103
  v_cvt_pk_bf16_f32 v124, v96, v97
  v_cvt_pk_bf16_f32 v125, v98, v99
  v_cvt_pk_bf16_f32 v126, v100, v101
  v_cvt_pk_bf16_f32 v127, v102, v103
  v_mfma_f32_32x32x16_bf16 v[88:103], v[136:139], v[190:193], v[24:39]
  v_exp_f32 v104, v104
  v_exp_f32 v105, v105
  v_exp_f32 v106, v106
  v_exp_f32 v107, v107
  v_mfma_f32_32x32x16_bf16 v[56:71], v[156:159], v[124:127], v[56:71]
  buffer_load_dwordx4 v1, s[4:7], s17 offen offset:3072 sc1 lds
  v_exp_f32 v108, v108
  v_exp_f32 v109, v109
  v_exp_f32 v110, v110
  v_exp_f32 v111, v111
  v_exp_f32 v112, v112
  v_cvt_pk_bf16_f32 v128, v104, v105
  v_cvt_pk_bf16_f32 v129, v106, v107
  v_cvt_pk_bf16_f32 v130, v108, v109
  v_cvt_pk_bf16_f32 v131, v110, v111
  v_exp_f32 v113, v113
  v_exp_f32 v114, v114
  v_exp_f32 v115, v115
  v_mfma_f32_32x32x16_bf16 v[72:87], v[152:155], v[128:131], v[72:87]
  s_waitcnt lgkmcnt(0)
  v_exp_f32 v116, v116
  v_exp_f32 v117, v117
  v_exp_f32 v118, v118
  v_exp_f32 v119, v119
  v_add_u32 v161, v162, v161
  v_cvt_pk_bf16_f32 v132, v112, v113
  v_cvt_pk_bf16_f32 v133, v114, v115
  v_cvt_pk_bf16_f32 v134, v116, v117
  v_cvt_pk_bf16_f32 v135, v118, v119
  v_mfma_f32_32x32x16_bf16 v[104:119], v[136:139], v[194:197], v[40:55]
  ds_read_b128 v[136:139], v1 offset:10240
  v_exp_f32 v88, v88
  v_exp_f32 v89, v89
  v_exp_f32 v90, v90
  v_exp_f32 v91, v91
  v_mfma_f32_32x32x16_bf16 v[72:87], v[156:159], v[132:135], v[72:87]
  ds_read_b128 v[152:155], v161 offset:1024
  ds_read_b128 v[156:159], v161 offset:1536
  v_exp_f32 v92, v92
  v_exp_f32 v93, v93
  v_exp_f32 v94, v94
  v_exp_f32 v95, v95
  v_exp_f32 v96, v96
  v_cvt_pk_bf16_f32 v120, v88, v89
  v_cvt_pk_bf16_f32 v121, v90, v91
  v_cvt_pk_bf16_f32 v122, v92, v93
  v_cvt_pk_bf16_f32 v123, v94, v95
  v_exp_f32 v97, v97
  v_exp_f32 v98, v98
  v_exp_f32 v99, v99
  v_mfma_f32_32x32x16_bf16 v[56:71], v[144:147], v[120:123], v[56:71]
  s_add_u32 m0, s23, 49152
  s_add_u32 s17, s22, 49152
  buffer_load_dwordx4 v1, s[4:7], s17 offen offset:0 sc1 lds
  v_exp_f32 v100, v100
  v_exp_f32 v101, v101
  v_exp_f32 v102, v102
  v_exp_f32 v103, v103
  v_cvt_pk_bf16_f32 v124, v96, v97
  v_cvt_pk_bf16_f32 v125, v98, v99
  v_cvt_pk_bf16_f32 v126, v100, v101
  v_cvt_pk_bf16_f32 v127, v102, v103
  v_mfma_f32_32x32x16_bf16 v[88:103], v[140:143], v[190:193], v[24:39]
  v_exp_f32 v104, v104
  v_exp_f32 v105, v105
  v_exp_f32 v106, v106
  v_exp_f32 v107, v107
  v_mfma_f32_32x32x16_bf16 v[56:71], v[148:151], v[124:127], v[56:71]
  buffer_load_dwordx4 v1, s[4:7], s17 offen offset:1024 sc1 lds
  v_exp_f32 v108, v108
  v_exp_f32 v109, v109
  v_exp_f32 v110, v110
  v_exp_f32 v111, v111
  v_exp_f32 v112, v112
  v_cvt_pk_bf16_f32 v128, v104, v105
  v_cvt_pk_bf16_f32 v129, v106, v107
  v_cvt_pk_bf16_f32 v130, v108, v109
  v_cvt_pk_bf16_f32 v131, v110, v111
  v_exp_f32 v113, v113
  v_exp_f32 v114, v114
  v_exp_f32 v115, v115
  v_mfma_f32_32x32x16_bf16 v[72:87], v[144:147], v[128:131], v[72:87]
  s_waitcnt lgkmcnt(0)
  v_exp_f32 v116, v116
  v_exp_f32 v117, v117
  v_exp_f32 v118, v118
  v_exp_f32 v119, v119
  v_cvt_pk_bf16_f32 v132, v112, v113
  v_cvt_pk_bf16_f32 v133, v114, v115
  v_cvt_pk_bf16_f32 v134, v116, v117
  v_cvt_pk_bf16_f32 v135, v118, v119
  v_mfma_f32_32x32x16_bf16 v[104:119], v[140:143], v[194:197], v[40:55]
  ds_read_b128 v[140:143], v1 offset:11264
  v_exp_f32 v88, v88
  v_exp_f32 v89, v89
  v_exp_f32 v90, v90
  v_exp_f32 v91, v91
  v_mfma_f32_32x32x16_bf16 v[72:87], v[148:151], v[132:135], v[72:87]
  ds_read_b128 v[144:147], v161 offset:2048
  ds_read_b128 v[148:151], v161 offset:2560
  v_exp_f32 v92, v92
  v_exp_f32 v93, v93
  v_exp_f32 v94, v94
  v_exp_f32 v95, v95
  v_exp_f32 v96, v96
  v_cvt_pk_bf16_f32 v120, v88, v89
  v_cvt_pk_bf16_f32 v121, v90, v91
  v_cvt_pk_bf16_f32 v122, v92, v93
  v_cvt_pk_bf16_f32 v123, v94, v95
  v_exp_f32 v97, v97
  v_exp_f32 v98, v98
  v_exp_f32 v99, v99
  v_mfma_f32_32x32x16_bf16 v[56:71], v[152:155], v[120:123], v[56:71]
  buffer_load_dwordx4 v1, s[4:7], s17 offen offset:2048 sc1 lds
  v_exp_f32 v100, v100
  v_exp_f32 v101, v101
  v_exp_f32 v102, v102
  v_exp_f32 v103, v103
  v_cvt_pk_bf16_f32 v124, v96, v97
  v_cvt_pk_bf16_f32 v125, v98, v99
  v_cvt_pk_bf16_f32 v126, v100, v101
  v_cvt_pk_bf16_f32 v127, v102, v103
  v_mfma_f32_32x32x16_bf16 v[88:103], v[136:139], v[190:193], v[24:39]
  v_exp_f32 v104, v104
  v_exp_f32 v105, v105
  v_exp_f32 v106, v106
  v_exp_f32 v107, v107
  v_mfma_f32_32x32x16_bf16 v[56:71], v[156:159], v[124:127], v[56:71]
  buffer_load_dwordx4 v1, s[4:7], s17 offen offset:3072 sc1 lds
  v_exp_f32 v108, v108
  v_exp_f32 v109, v109
  v_exp_f32 v110, v110
  v_exp_f32 v111, v111
  v_exp_f32 v112, v112
  v_cvt_pk_bf16_f32 v128, v104, v105
  v_cvt_pk_bf16_f32 v129, v106, v107
  v_cvt_pk_bf16_f32 v130, v108, v109
  v_cvt_pk_bf16_f32 v131, v110, v111
  v_exp_f32 v113, v113
  v_exp_f32 v114, v114
  v_exp_f32 v115, v115
  v_mfma_f32_32x32x16_bf16 v[72:87], v[152:155], v[128:131], v[72:87]
  s_waitcnt lgkmcnt(0)
  v_exp_f32 v116, v116
  v_exp_f32 v117, v117
  v_exp_f32 v118, v118
  v_exp_f32 v119, v119
  v_cvt_pk_bf16_f32 v132, v112, v113
  v_cvt_pk_bf16_f32 v133, v114, v115
  v_cvt_pk_bf16_f32 v134, v116, v117
  v_cvt_pk_bf16_f32 v135, v118, v119
  v_mfma_f32_32x32x16_bf16 v[104:119], v[136:139], v[194:197], v[40:55]
  ds_read_b128 v[136:139], v1 offset:12288
  v_exp_f32 v88, v88
  v_exp_f32 v89, v89
  v_exp_f32 v90, v90
  v_exp_f32 v91, v91
  v_mfma_f32_32x32x16_bf16 v[72:87], v[156:159], v[132:135], v[72:87]
  ds_read_b128 v[152:155], v161 offset:3072
  ds_read_b128 v[156:159], v161 offset:3584
  v_exp_f32 v92, v92
  v_exp_f32 v93, v93
  v_exp_f32 v94, v94
  v_exp_f32 v95, v95
  v_exp_f32 v96, v96
  v_cvt_pk_bf16_f32 v120, v88, v89
  v_cvt_pk_bf16_f32 v121, v90, v91
  v_cvt_pk_bf16_f32 v122, v92, v93
  v_cvt_pk_bf16_f32 v123, v94, v95
  v_exp_f32 v97, v97
  v_exp_f32 v98, v98
  v_exp_f32 v99, v99
  v_mfma_f32_32x32x16_bf16 v[56:71], v[144:147], v[120:123], v[56:71]
  v_exp_f32 v100, v100
  v_exp_f32 v101, v101
  v_exp_f32 v102, v102
  v_exp_f32 v103, v103
  v_cvt_pk_bf16_f32 v124, v96, v97
  v_cvt_pk_bf16_f32 v125, v98, v99
  v_cvt_pk_bf16_f32 v126, v100, v101
  v_cvt_pk_bf16_f32 v127, v102, v103
  v_mfma_f32_32x32x16_bf16 v[88:103], v[140:143], v[190:193], v[24:39]
  v_exp_f32 v104, v104
  v_exp_f32 v105, v105
  v_exp_f32 v106, v106
  v_exp_f32 v107, v107
  v_mfma_f32_32x32x16_bf16 v[56:71], v[148:151], v[124:127], v[56:71]
  buffer_load_dwordx4 v[176:179], v1, s[4:7], s59 offen sc1
  v_exp_f32 v108, v108
  v_exp_f32 v109, v109
  v_exp_f32 v110, v110
  v_exp_f32 v111, v111
  v_exp_f32 v112, v112
  v_cvt_pk_bf16_f32 v128, v104, v105
  v_cvt_pk_bf16_f32 v129, v106, v107
  v_cvt_pk_bf16_f32 v130, v108, v109
  v_cvt_pk_bf16_f32 v131, v110, v111
  v_exp_f32 v113, v113
  v_exp_f32 v114, v114
  v_exp_f32 v115, v115
  v_mfma_f32_32x32x16_bf16 v[72:87], v[144:147], v[128:131], v[72:87]
  s_waitcnt lgkmcnt(0)
  v_exp_f32 v116, v116
  v_exp_f32 v117, v117
  v_exp_f32 v118, v118
  v_exp_f32 v119, v119
  v_cvt_pk_bf16_f32 v132, v112, v113
  v_cvt_pk_bf16_f32 v133, v114, v115
  v_cvt_pk_bf16_f32 v134, v116, v117
  v_cvt_pk_bf16_f32 v135, v118, v119
  v_mfma_f32_32x32x16_bf16 v[104:119], v[140:143], v[194:197], v[40:55]
  ds_read_b128 v[140:143], v1 offset:13312
  v_exp_f32 v88, v88
  v_exp_f32 v89, v89
  v_exp_f32 v90, v90
  v_exp_f32 v91, v91
  v_mfma_f32_32x32x16_bf16 v[72:87], v[148:151], v[132:135], v[72:87]
  ds_read_b128 v[144:147], v161 offset:4096
  ds_read_b128 v[148:151], v161 offset:4608
  v_exp_f32 v92, v92
  v_exp_f32 v93, v93
  v_exp_f32 v94, v94
  v_exp_f32 v95, v95
  v_exp_f32 v96, v96
  v_cvt_pk_bf16_f32 v120, v88, v89
  v_cvt_pk_bf16_f32 v121, v90, v91
  v_cvt_pk_bf16_f32 v122, v92, v93
  v_cvt_pk_bf16_f32 v123, v94, v95
  v_exp_f32 v97, v97
  v_exp_f32 v98, v98
  v_exp_f32 v99, v99
  v_mfma_f32_32x32x16_bf16 v[56:71], v[152:155], v[120:123], v[56:71]
  v_exp_f32 v100, v100
  v_exp_f32 v101, v101
  v_exp_f32 v102, v102
  v_exp_f32 v103, v103
  v_cvt_pk_bf16_f32 v124, v96, v97
  v_cvt_pk_bf16_f32 v125, v98, v99
  v_cvt_pk_bf16_f32 v126, v100, v101
  v_cvt_pk_bf16_f32 v127, v102, v103
  v_mfma_f32_32x32x16_bf16 v[88:103], v[136:139], v[190:193], v[24:39]
  v_exp_f32 v104, v104
  v_exp_f32 v105, v105
  v_exp_f32 v106, v106
  v_exp_f32 v107, v107
  v_mfma_f32_32x32x16_bf16 v[56:71], v[156:159], v[124:127], v[56:71]
  v_exp_f32 v108, v108
  v_exp_f32 v109, v109
  v_exp_f32 v110, v110
  v_exp_f32 v111, v111
  v_exp_f32 v112, v112
  v_cvt_pk_bf16_f32 v128, v104, v105
  v_cvt_pk_bf16_f32 v129, v106, v107
  v_cvt_pk_bf16_f32 v130, v108, v109
  v_cvt_pk_bf16_f32 v131, v110, v111
  v_exp_f32 v113, v113
  v_exp_f32 v114, v114
  v_exp_f32 v115, v115
  v_mfma_f32_32x32x16_bf16 v[72:87], v[152:155], v[128:131], v[72:87]
  s_waitcnt lgkmcnt(0)
  v_exp_f32 v116, v116
  v_exp_f32 v117, v117
  v_exp_f32 v118, v118
  v_exp_f32 v119, v119
  v_add_u32 v161, v162, v161
  v_cvt_pk_bf16_f32 v132, v112, v113
  v_cvt_pk_bf16_f32 v133, v114, v115
  v_cvt_pk_bf16_f32 v134, v116, v117
  v_cvt_pk_bf16_f32 v135, v118, v119
  v_mfma_f32_32x32x16_bf16 v[104:119], v[136:139], v[194:197], v[40:55]
  ds_read_b128 v[136:139], v1 offset:14336
  v_exp_f32 v88, v88
  v_exp_f32 v89, v89
  v_exp_f32 v90, v90
  v_exp_f32 v91, v91
  v_mfma_f32_32x32x16_bf16 v[72:87], v[156:159], v[132:135], v[72:87]
  ds_read_b128 v[152:155], v161 offset:1024
  ds_read_b128 v[156:159], v161 offset:1536
  v_exp_f32 v92, v92
  v_exp_f32 v93, v93
  v_exp_f32 v94, v94
  v_exp_f32 v95, v95
  v_exp_f32 v96, v96
  v_cvt_pk_bf16_f32 v120, v88, v89
  v_cvt_pk_bf16_f32 v121, v90, v91
  v_cvt_pk_bf16_f32 v122, v92, v93
  v_cvt_pk_bf16_f32 v123, v94, v95
  v_exp_f32 v97, v97
  v_exp_f32 v98, v98
  v_exp_f32 v99, v99
  v_mfma_f32_32x32x16_bf16 v[56:71], v[144:147], v[120:123], v[56:71]
  s_waitcnt vmcnt(0)
L_att_wchk:
  v_and_b32 v176, -15, v176
  v_and_b32 v177, -15, v177
  v_and_b32 v178, -15, v178
  v_and_b32 v179, -15, v179
  v_cmp_ne_u32 vcc, v11, v176
  v_cmp_ne_u32 s[18:19], v11, v177
  s_nop 1
  s_or_b64 vcc, vcc, s[18:19]
  v_cmp_ne_u32 s[18:19], v11, v178
  s_nop 1
  s_or_b64 vcc, vcc, s[18:19]
  v_cmp_ne_u32 s[18:19], v11, v179
  s_nop 1
  s_or_b64 vcc, vcc, s[18:19]
  s_cmp_eq_u64 vcc, 0
  s_cbranch_scc1 L_att_wok
  s_sleep 4
  buffer_load_dwordx4 v[176:179], v1, s[4:7], s59 offen sc1
  s_waitcnt vmcnt(0)
  s_branch L_att_wchk
L_att_wok:
  buffer_load_dword v176, v182, s[4:7], s59 offen sc1
  v_exp_f32 v100, v100
  v_exp_f32 v101, v101
  v_exp_f32 v102, v102
  v_exp_f32 v103, v103
  v_cvt_pk_bf16_f32 v124, v96, v97
  v_cvt_pk_bf16_f32 v125, v98, v99
  v_cvt_pk_bf16_f32 v126, v100, v101
  v_cvt_pk_bf16_f32 v127, v102, v103
  v_mfma_f32_32x32x16_bf16 v[88:103], v[140:143], v[190:193], v[24:39]
  v_exp_f32 v104, v104
  v_exp_f32 v105, v105
  v_exp_f32 v106, v106
  v_exp_f32 v107, v107
  v_mfma_f32_32x32x16_bf16 v[56:71], v[148:151], v[124:127], v[56:71]
  buffer_load_dwordx4 a[0:3], v1, s[4:7], s24 offen offset:0 sc1
  v_exp_f32 v108, v108
  v_exp_f32 v109, v109
  v_exp_f32 v110, v110
  v_exp_f32 v111, v111
  v_exp_f32 v112, v112
  v_cvt_pk_bf16_f32 v128, v104, v105
  v_cvt_pk_bf16_f32 v129, v106, v107
  v_cvt_pk_bf16_f32 v130, v108, v109
  v_cvt_pk_bf16_f32 v131, v110, v111
  v_exp_f32 v113, v113
  v_exp_f32 v114, v114
  v_exp_f32 v115, v115
  v_mfma_f32_32x32x16_bf16 v[72:87], v[144:147], v[128:131], v[72:87]
  s_waitcnt lgkmcnt(0)
  v_exp_f32 v116, v116
  v_exp_f32 v117, v117
  v_exp_f32 v118, v118
  v_exp_f32 v119, v119
  v_cvt_pk_bf16_f32 v132, v112, v113
  v_cvt_pk_bf16_f32 v133, v114, v115
  v_cvt_pk_bf16_f32 v134, v116, v117
  v_cvt_pk_bf16_f32 v135, v118, v119
  v_mfma_f32_32x32x16_bf16 v[104:119], v[140:143], v[194:197], v[40:55]
  ds_read_b128 v[140:143], v1 offset:15360
  v_exp_f32 v88, v88
  v_exp_f32 v89, v89
  v_exp_f32 v90, v90
  v_exp_f32 v91, v91
  v_mfma_f32_32x32x16_bf16 v[72:87], v[148:151], v[132:135], v[72:87]
  ds_read_b128 v[144:147], v161 offset:2048
  ds_read_b128 v[148:151], v161 offset:2560
  v_exp_f32 v92, v92
  v_exp_f32 v93, v93
  v_exp_f32 v94, v94
  v_exp_f32 v95, v95
  v_exp_f32 v96, v96
  v_cvt_pk_bf16_f32 v120, v88, v89
  v_cvt_pk_bf16_f32 v121, v90, v91
  v_cvt_pk_bf16_f32 v122, v92, v93
  v_cvt_pk_bf16_f32 v123, v94, v95
  v_exp_f32 v97, v97
  v_exp_f32 v98, v98
  v_exp_f32 v99, v99
  v_mfma_f32_32x32x16_bf16 v[56:71], v[152:155], v[120:123], v[56:71]
  buffer_load_dwordx4 a[32:35], v1, s[4:7], s25 offen offset:0 sc1
  v_exp_f32 v100, v100
  v_exp_f32 v101, v101
  v_exp_f32 v102, v102
  v_exp_f32 v103, v103
  v_cvt_pk_bf16_f32 v124, v96, v97
  v_cvt_pk_bf16_f32 v125, v98, v99
  v_cvt_pk_bf16_f32 v126, v100, v101
  v_cvt_pk_bf16_f32 v127, v102, v103
  v_mfma_f32_32x32x16_bf16 v[88:103], v[136:139], v[190:193], v[24:39]
  v_exp_f32 v104, v104
  v_exp_f32 v105, v105
  v_exp_f32 v106, v106
  v_exp_f32 v107, v107
  v_mfma_f32_32x32x16_bf16 v[56:71], v[156:159], v[124:127], v[56:71]
  buffer_load_dwordx4 a[4:7], v1, s[4:7], s24 offen offset:1024 sc1
  v_exp_f32 v108, v108
  v_exp_f32 v109, v109
  v_exp_f32 v110, v110
  v_exp_f32 v111, v111
  v_exp_f32 v112, v112
  v_cvt_pk_bf16_f32 v128, v104, v105
  v_cvt_pk_bf16_f32 v129, v106, v107
  v_cvt_pk_bf16_f32 v130, v108, v109
  v_cvt_pk_bf16_f32 v131, v110, v111
  v_exp_f32 v113, v113
  v_exp_f32 v114, v114
  v_exp_f32 v115, v115
  v_mfma_f32_32x32x16_bf16 v[72:87], v[152:155], v[128:131], v[72:87]
  s_waitcnt lgkmcnt(0)
  s_barrier
  v_exp_f32 v116, v116
  v_exp_f32 v117, v117
  v_exp_f32 v118, v118
  v_exp_f32 v119, v119
  v_cvt_pk_bf16_f32 v132, v112, v113
  v_cvt_pk_bf16_f32 v133, v114, v115
  v_cvt_pk_bf16_f32 v134, v116, v117
  v_cvt_pk_bf16_f32 v135, v118, v119
  v_mfma_f32_32x32x16_bf16 v[104:119], v[136:139], v[194:197], v[40:55]
  ds_read_b128 v[136:139], v1 offset:16384
  v_exp_f32 v88, v88
  v_exp_f32 v89, v89
  v_exp_f32 v90, v90
  v_exp_f32 v91, v91
  v_mfma_f32_32x32x16_bf16 v[72:87], v[156:159], v[132:135], v[72:87]
  ds_read_b128 v[152:155], v161 offset:3072
  ds_read_b128 v[156:159], v161 offset:3584
  v_exp_f32 v92, v92
  v_exp_f32 v93, v93
  v_exp_f32 v94, v94
  v_exp_f32 v95, v95
  v_exp_f32 v96, v96
  v_cvt_pk_bf16_f32 v120, v88, v89
  v_cvt_pk_bf16_f32 v121, v90, v91
  v_cvt_pk_bf16_f32 v122, v92, v93
  v_cvt_pk_bf16_f32 v123, v94, v95
  v_exp_f32 v97, v97
  v_exp_f32 v98, v98
  v_exp_f32 v99, v99
  v_mfma_f32_32x32x16_bf16 v[56:71], v[144:147], v[120:123], v[56:71]
  buffer_load_dwordx4 a[36:39], v1, s[4:7], s25 offen offset:1024 sc1
  v_exp_f32 v100, v100
  v_exp_f32 v101, v101
  v_exp_f32 v102, v102
  v_exp_f32 v103, v103
  v_cvt_pk_bf16_f32 v124, v96, v97
  v_cvt_pk_bf16_f32 v125, v98, v99
  v_cvt_pk_bf16_f32 v126, v100, v101
  v_cvt_pk_bf16_f32 v127, v102, v103
  v_mfma_f32_32x32x16_bf16 v[88:103], v[140:143], v[190:193], v[24:39]
  v_exp_f32 v104, v104
  v_exp_f32 v105, v105
  v_exp_f32 v106, v106
  v_exp_f32 v107, v107
  v_mfma_f32_32x32x16_bf16 v[56:71], v[148:151], v[124:127], v[56:71]
  buffer_load_dwordx4 a[8:11], v1, s[4:7], s24 offen offset:2048 sc1
  v_exp_f32 v108, v108
  v_exp_f32 v109, v109
  v_exp_f32 v110, v110
  v_exp_f32 v111, v111
  v_exp_f32 v112, v112
  v_cvt_pk_bf16_f32 v128, v104, v105
  v_cvt_pk_bf16_f32 v129, v106, v107
  v_cvt_pk_bf16_f32 v130, v108, v109
  v_cvt_pk_bf16_f32 v131, v110, v111
  v_exp_f32 v113, v113
  v_exp_f32 v114, v114
  v_exp_f32 v115, v115
  v_mfma_f32_32x32x16_bf16 v[72:87], v[144:147], v[128:131], v[72:87]
  s_waitcnt lgkmcnt(0)
  v_exp_f32 v116, v116
  v_exp_f32 v117, v117
  v_exp_f32 v118, v118
  v_exp_f32 v119, v119
  v_cvt_pk_bf16_f32 v132, v112, v113
  v_cvt_pk_bf16_f32 v133, v114, v115
  v_cvt_pk_bf16_f32 v134, v116, v117
  v_cvt_pk_bf16_f32 v135, v118, v119
  v_mfma_f32_32x32x16_bf16 v[104:119], v[140:143], v[194:197], v[40:55]
  ds_read_b128 v[140:143], v1 offset:17408
  v_exp_f32 v88, v88
  v_exp_f32 v89, v89
  v_exp_f32 v90, v90
  v_exp_f32 v91, v91
  v_mfma_f32_32x32x16_bf16 v[72:87], v[148:151], v[132:135], v[72:87]
  ds_read_b128 v[144:147], v161 offset:4096
  ds_read_b128 v[148:151], v161 offset:4608
  v_exp_f32 v92, v92
  v_exp_f32 v93, v93
  v_exp_f32 v94, v94
  v_exp_f32 v95, v95
  v_exp_f32 v96, v96
  v_cvt_pk_bf16_f32 v120, v88, v89
  v_cvt_pk_bf16_f32 v121, v90, v91
  v_cvt_pk_bf16_f32 v122, v92, v93
  v_cvt_pk_bf16_f32 v123, v94, v95
  v_exp_f32 v97, v97
  v_exp_f32 v98, v98
  v_exp_f32 v99, v99
  v_mfma_f32_32x32x16_bf16 v[56:71], v[152:155], v[120:123], v[56:71]
  buffer_load_dwordx4 a[40:43], v1, s[4:7], s25 offen offset:2048 sc1
  v_exp_f32 v100, v100
  v_exp_f32 v101, v101
  v_exp_f32 v102, v102
  v_exp_f32 v103, v103
  v_cvt_pk_bf16_f32 v124, v96, v97
  v_cvt_pk_bf16_f32 v125, v98, v99
  v_cvt_pk_bf16_f32 v126, v100, v101
  v_cvt_pk_bf16_f32 v127, v102, v103
  v_mfma_f32_32x32x16_bf16 v[88:103], v[136:139], v[190:193], v[24:39]
  v_exp_f32 v104, v104
  v_exp_f32 v105, v105
  v_exp_f32 v106, v106
  v_exp_f32 v107, v107
  v_mfma_f32_32x32x16_bf16 v[56:71], v[156:159], v[124:127], v[56:71]
  buffer_load_dwordx4 a[12:15], v1, s[4:7], s24 offen offset:3072 sc1
  v_exp_f32 v108, v108
  v_exp_f32 v109, v109
  v_exp_f32 v110, v110
  v_exp_f32 v111, v111
  v_exp_f32 v112, v112
  v_cvt_pk_bf16_f32 v128, v104, v105
  v_cvt_pk_bf16_f32 v129, v106, v107
  v_cvt_pk_bf16_f32 v130, v108, v109
  v_cvt_pk_bf16_f32 v131, v110, v111
  v_exp_f32 v113, v113
  v_exp_f32 v114, v114
  v_exp_f32 v115, v115
  v_mfma_f32_32x32x16_bf16 v[72:87], v[152:155], v[128:131], v[72:87]
  s_waitcnt lgkmcnt(0)
  v_exp_f32 v116, v116
  v_exp_f32 v117, v117
  v_exp_f32 v118, v118
  v_exp_f32 v119, v119
  v_add_u32 v161, v162, v161
  v_cvt_pk_bf16_f32 v132, v112, v113
  v_cvt_pk_bf16_f32 v133, v114, v115
  v_cvt_pk_bf16_f32 v134, v116, v117
  v_cvt_pk_bf16_f32 v135, v118, v119
  v_mfma_f32_32x32x16_bf16 v[104:119], v[136:139], v[194:197], v[40:55]
  ds_read_b128 v[136:139], v1 offset:18432
  v_exp_f32 v88, v88
  v_exp_f32 v89, v89
  v_exp_f32 v90, v90
  v_exp_f32 v91, v91
  v_mfma_f32_32x32x16_bf16 v[72:87], v[156:159], v[132:135], v[72:87]
  ds_read_b128 v[152:155], v161 offset:1024
  ds_read_b128 v[156:159], v161 offset:1536
  v_exp_f32 v92, v92
  v_exp_f32 v93, v93
  v_exp_f32 v94, v94
  v_exp_f32 v95, v95
  v_exp_f32 v96, v96
  v_cvt_pk_bf16_f32 v120, v88, v89
  v_cvt_pk_bf16_f32 v121, v90, v91
  v_cvt_pk_bf16_f32 v122, v92, v93
  v_cvt_pk_bf16_f32 v123, v94, v95
  v_exp_f32 v97, v97
  v_exp_f32 v98, v98
  v_exp_f32 v99, v99
  v_mfma_f32_32x32x16_bf16 v[56:71], v[144:147], v[120:123], v[56:71]
  s_waitcnt vmcnt(7)
  v_cmp_ne_u32 vcc, v181, v176
  s_nop 1
  s_cmp_eq_u64 vcc, 0
  s_cselect_b32 s57, 1, 0
  v_exp_f32 v100, v100
  v_exp_f32 v101, v101
  v_exp_f32 v102, v102
  v_exp_f32 v103, v103
  v_cvt_pk_bf16_f32 v124, v96, v97
  v_cvt_pk_bf16_f32 v125, v98, v99
  v_cvt_pk_bf16_f32 v126, v100, v101
  v_cvt_pk_bf16_f32 v127, v102, v103
  v_mfma_f32_32x32x16_bf16 v[88:103], v[140:143], v[190:193], v[24:39]
  v_exp_f32 v104, v104
  v_exp_f32 v105, v105
  v_exp_f32 v106, v106
  v_exp_f32 v107, v107
  v_mfma_f32_32x32x16_bf16 v[56:71], v[148:151], v[124:127], v[56:71]
  buffer_load_dwordx4 a[44:47], v1, s[4:7], s25 offen offset:3072 sc1
  v_exp_f32 v108, v108
  v_exp_f32 v109, v109
  v_exp_f32 v110, v110
  v_exp_f32 v111, v111
  v_exp_f32 v112, v112
  v_cvt_pk_bf16_f32 v128, v104, v105
  v_cvt_pk_bf16_f32 v129, v106, v107
  v_cvt_pk_bf16_f32 v130, v108, v109
  v_cvt_pk_bf16_f32 v131, v110, v111
  v_exp_f32 v113, v113
  v_exp_f32 v114, v114
  v_exp_f32 v115, v115
  v_mfma_f32_32x32x16_bf16 v[72:87], v[144:147], v[128:131], v[72:87]
  s_waitcnt lgkmcnt(0)
  v_exp_f32 v116, v116
  v_exp_f32 v117, v117
  v_exp_f32 v118, v118
  v_exp_f32 v119, v119
  v_cvt_pk_bf16_f32 v132, v112, v113
  v_cvt_pk_bf16_f32 v133, v114, v115
  v_cvt_pk_bf16_f32 v134, v116, v117
  v_cvt_pk_bf16_f32 v135, v118, v119
  v_mfma_f32_32x32x16_bf16 v[104:119], v[140:143], v[194:197], v[40:55]
  ds_read_b128 v[140:143], v1 offset:19456
  v_exp_f32 v88, v88
  v_exp_f32 v89, v89
  v_exp_f32 v90, v90
  v_exp_f32 v91, v91
  v_mfma_f32_32x32x16_bf16 v[72:87], v[148:151], v[132:135], v[72:87]
  ds_read_b128 v[144:147], v161 offset:2048
  ds_read_b128 v[148:151], v161 offset:2560
  v_exp_f32 v92, v92
  v_exp_f32 v93, v93
  v_exp_f32 v94, v94
  v_exp_f32 v95, v95
  v_exp_f32 v96, v96
  v_cvt_pk_bf16_f32 v120, v88, v89
  v_cvt_pk_bf16_f32 v121, v90, v91
  v_cvt_pk_bf16_f32 v122, v92, v93
  v_cvt_pk_bf16_f32 v123, v94, v95
  v_exp_f32 v97, v97
  v_exp_f32 v98, v98
  v_exp_f32 v99, v99
  v_mfma_f32_32x32x16_bf16 v[56:71], v[152:155], v[120:123], v[56:71]
  buffer_load_dwordx4 a[16:19], v5, s[4:7], s24 offen offset:0 sc1
  v_exp_f32 v100, v100
  v_exp_f32 v101, v101
  v_exp_f32 v102, v102
  v_exp_f32 v103, v103
  v_cvt_pk_bf16_f32 v124, v96, v97
  v_cvt_pk_bf16_f32 v125, v98, v99
  v_cvt_pk_bf16_f32 v126, v100, v101
  v_cvt_pk_bf16_f32 v127, v102, v103
  v_mfma_f32_32x32x16_bf16 v[88:103], v[136:139], v[190:193], v[24:39]
  v_exp_f32 v104, v104
  v_exp_f32 v105, v105
  v_exp_f32 v106, v106
  v_exp_f32 v107, v107
  v_mfma_f32_32x32x16_bf16 v[56:71], v[156:159], v[124:127], v[56:71]
  buffer_load_dwordx4 a[48:51], v5, s[4:7], s25 offen offset:0 sc1
  v_exp_f32 v108, v108
  v_exp_f32 v109, v109
  v_exp_f32 v110, v110
  v_exp_f32 v111, v111
  v_exp_f32 v112, v112
  v_cvt_pk_bf16_f32 v128, v104, v105
  v_cvt_pk_bf16_f32 v129, v106, v107
  v_cvt_pk_bf16_f32 v130, v108, v109
  v_cvt_pk_bf16_f32 v131, v110, v111
  v_exp_f32 v113, v113
  v_exp_f32 v114, v114
  v_exp_f32 v115, v115
  v_mfma_f32_32x32x16_bf16 v[72:87], v[152:155], v[128:131], v[72:87]
  s_waitcnt lgkmcnt(0)
  v_exp_f32 v116, v116
  v_exp_f32 v117, v117
  v_exp_f32 v118, v118
  v_exp_f32 v119, v119
  v_cvt_pk_bf16_f32 v132, v112, v113
  v_cvt_pk_bf16_f32 v133, v114, v115
  v_cvt_pk_bf16_f32 v134, v116, v117
  v_cvt_pk_bf16_f32 v135, v118, v119
  v_mfma_f32_32x32x16_bf16 v[104:119], v[136:139], v[194:197], v[40:55]
  ds_read_b128 v[136:139], v1 offset:20480
  v_exp_f32 v88, v88
  v_exp_f32 v89, v89
  v_exp_f32 v90, v90
  v_exp_f32 v91, v91
  v_mfma_f32_32x32x16_bf16 v[72:87], v[156:159], v[132:135], v[72:87]
  ds_read_b128 v[152:155], v161 offset:3072
  ds_read_b128 v[156:159], v161 offset:3584
  v_exp_f32 v92, v92
  v_exp_f32 v93, v93
  v_exp_f32 v94, v94
  v_exp_f32 v95, v95
  v_exp_f32 v96, v96
  v_cvt_pk_bf16_f32 v120, v88, v89
  v_cvt_pk_bf16_f32 v121, v90, v91
  v_cvt_pk_bf16_f32 v122, v92, v93
  v_cvt_pk_bf16_f32 v123, v94, v95
  v_exp_f32 v97, v97
  v_exp_f32 v98, v98
  v_exp_f32 v99, v99
  v_mfma_f32_32x32x16_bf16 v[56:71], v[144:147], v[120:123], v[56:71]
  buffer_load_dwordx4 a[20:23], v5, s[4:7], s24 offen offset:1024 sc1
  v_exp_f32 v100, v100
  v_exp_f32 v101, v101
  v_exp_f32 v102, v102
  v_exp_f32 v103, v103
  v_cvt_pk_bf16_f32 v124, v96, v97
  v_cvt_pk_bf16_f32 v125, v98, v99
  v_cvt_pk_bf16_f32 v126, v100, v101
  v_cvt_pk_bf16_f32 v127, v102, v103
  v_mfma_f32_32x32x16_bf16 v[88:103], v[140:143], v[190:193], v[24:39]
  v_exp_f32 v104, v104
  v_exp_f32 v105, v105
  v_exp_f32 v106, v106
  v_exp_f32 v107, v107
  v_mfma_f32_32x32x16_bf16 v[56:71], v[148:151], v[124:127], v[56:71]
  buffer_load_dwordx4 a[52:55], v5, s[4:7], s25 offen offset:1024 sc1
  v_exp_f32 v108, v108
  v_exp_f32 v109, v109
  v_exp_f32 v110, v110
  v_exp_f32 v111, v111
  v_exp_f32 v112, v112
  v_cvt_pk_bf16_f32 v128, v104, v105
  v_cvt_pk_bf16_f32 v129, v106, v107
  v_cvt_pk_bf16_f32 v130, v108, v109
  v_cvt_pk_bf16_f32 v131, v110, v111
  v_exp_f32 v113, v113
  v_exp_f32 v114, v114
  v_exp_f32 v115, v115
  v_mfma_f32_32x32x16_bf16 v[72:87], v[144:147], v[128:131], v[72:87]
  s_waitcnt lgkmcnt(0)
  v_exp_f32 v116, v116
  v_exp_f32 v117, v117
  v_exp_f32 v118, v118
  v_exp_f32 v119, v119
  v_cvt_pk_bf16_f32 v132, v112, v113
  v_cvt_pk_bf16_f32 v133, v114, v115
  v_cvt_pk_bf16_f32 v134, v116, v117
  v_cvt_pk_bf16_f32 v135, v118, v119
  v_mfma_f32_32x32x16_bf16 v[104:119], v[140:143], v[194:197], v[40:55]
  ds_read_b128 v[140:143], v1 offset:21504
  v_exp_f32 v88, v88
  v_exp_f32 v89, v89
  v_exp_f32 v90, v90
  v_exp_f32 v91, v91
  v_mfma_f32_32x32x16_bf16 v[72:87], v[148:151], v[132:135], v[72:87]
  ds_read_b128 v[144:147], v161 offset:4096
  ds_read_b128 v[148:151], v161 offset:4608
  v_exp_f32 v92, v92
  v_exp_f32 v93, v93
  v_exp_f32 v94, v94
  v_exp_f32 v95, v95
  v_exp_f32 v96, v96
  v_cvt_pk_bf16_f32 v120, v88, v89
  v_cvt_pk_bf16_f32 v121, v90, v91
  v_cvt_pk_bf16_f32 v122, v92, v93
  v_cvt_pk_bf16_f32 v123, v94, v95
  v_exp_f32 v97, v97
  v_exp_f32 v98, v98
  v_exp_f32 v99, v99
  v_mfma_f32_32x32x16_bf16 v[56:71], v[152:155], v[120:123], v[56:71]
  buffer_load_dwordx4 a[24:27], v5, s[4:7], s24 offen offset:2048 sc1
  v_exp_f32 v100, v100
  v_exp_f32 v101, v101
  v_exp_f32 v102, v102
  v_exp_f32 v103, v103
  v_cvt_pk_bf16_f32 v124, v96, v97
  v_cvt_pk_bf16_f32 v125, v98, v99
  v_cvt_pk_bf16_f32 v126, v100, v101
  v_cvt_pk_bf16_f32 v127, v102, v103
  v_mfma_f32_32x32x16_bf16 v[88:103], v[136:139], v[190:193], v[24:39]
  v_exp_f32 v104, v104
  v_exp_f32 v105, v105
  v_exp_f32 v106, v106
  v_exp_f32 v107, v107
  v_mfma_f32_32x32x16_bf16 v[56:71], v[156:159], v[124:127], v[56:71]
  buffer_load_dwordx4 a[56:59], v5, s[4:7], s25 offen offset:2048 sc1
  v_exp_f32 v108, v108
  v_exp_f32 v109, v109
  v_exp_f32 v110, v110
  v_exp_f32 v111, v111
  v_exp_f32 v112, v112
  v_cvt_pk_bf16_f32 v128, v104, v105
  v_cvt_pk_bf16_f32 v129, v106, v107
  v_cvt_pk_bf16_f32 v130, v108, v109
  v_cvt_pk_bf16_f32 v131, v110, v111
  v_exp_f32 v113, v113
  v_exp_f32 v114, v114
  v_exp_f32 v115, v115
  v_mfma_f32_32x32x16_bf16 v[72:87], v[152:155], v[128:131], v[72:87]
  s_waitcnt lgkmcnt(0)
  v_exp_f32 v116, v116
  v_exp_f32 v117, v117
  v_exp_f32 v118, v118
  v_exp_f32 v119, v119
  v_add_u32 v161, v162, v161
  v_cvt_pk_bf16_f32 v132, v112, v113
  v_cvt_pk_bf16_f32 v133, v114, v115
  v_cvt_pk_bf16_f32 v134, v116, v117
  v_cvt_pk_bf16_f32 v135, v118, v119
  v_mfma_f32_32x32x16_bf16 v[104:119], v[136:139], v[194:197], v[40:55]
  ds_read_b128 v[136:139], v1 offset:22528
  v_exp_f32 v88, v88
  v_exp_f32 v89, v89
  v_exp_f32 v90, v90
  v_exp_f32 v91, v91
  v_mfma_f32_32x32x16_bf16 v[72:87], v[156:159], v[132:135], v[72:87]
  ds_read_b128 v[152:155], v161 offset:1024
  ds_read_b128 v[156:159], v161 offset:1536
  v_exp_f32 v92, v92
  v_exp_f32 v93, v93
  v_exp_f32 v94, v94
  v_exp_f32 v95, v95
  v_exp_f32 v96, v96
  v_cvt_pk_bf16_f32 v120, v88, v89
  v_cvt_pk_bf16_f32 v121, v90, v91
  v_cvt_pk_bf16_f32 v122, v92, v93
  v_cvt_pk_bf16_f32 v123, v94, v95
  v_exp_f32 v97, v97
  v_exp_f32 v98, v98
  v_exp_f32 v99, v99
  v_mfma_f32_32x32x16_bf16 v[56:71], v[144:147], v[120:123], v[56:71]
  buffer_load_dwordx4 a[28:31], v5, s[4:7], s24 offen offset:3072 sc1
  v_exp_f32 v100, v100
  v_exp_f32 v101, v101
  v_exp_f32 v102, v102
  v_exp_f32 v103, v103
  v_cvt_pk_bf16_f32 v124, v96, v97
  v_cvt_pk_bf16_f32 v125, v98, v99
  v_cvt_pk_bf16_f32 v126, v100, v101
  v_cvt_pk_bf16_f32 v127, v102, v103
  v_mfma_f32_32x32x16_bf16 v[88:103], v[140:143], v[190:193], v[24:39]
  v_exp_f32 v104, v104
  v_exp_f32 v105, v105
  v_exp_f32 v106, v106
  v_exp_f32 v107, v107
  v_mfma_f32_32x32x16_bf16 v[56:71], v[148:151], v[124:127], v[56:71]
  buffer_load_dwordx4 a[60:63], v5, s[4:7], s25 offen offset:3072 sc1
  v_exp_f32 v108, v108
  v_exp_f32 v109, v109
  v_exp_f32 v110, v110
  v_exp_f32 v111, v111
  v_exp_f32 v112, v112
  v_cvt_pk_bf16_f32 v128, v104, v105
  v_cvt_pk_bf16_f32 v129, v106, v107
  v_cvt_pk_bf16_f32 v130, v108, v109
  v_cvt_pk_bf16_f32 v131, v110, v111
  v_exp_f32 v113, v113
  v_exp_f32 v114, v114
  v_exp_f32 v115, v115
  v_mfma_f32_32x32x16_bf16 v[72:87], v[144:147], v[128:131], v[72:87]
  s_waitcnt lgkmcnt(0)
  v_exp_f32 v116, v116
  v_exp_f32 v117, v117
  v_exp_f32 v118, v118
  v_exp_f32 v119, v119
  v_cvt_pk_bf16_f32 v132, v112, v113
  v_cvt_pk_bf16_f32 v133, v114, v115
  v_cvt_pk_bf16_f32 v134, v116, v117
  v_cvt_pk_bf16_f32 v135, v118, v119
  v_mfma_f32_32x32x16_bf16 v[104:119], v[140:143], v[194:197], v[40:55]
  ds_read_b128 v[140:143], v1 offset:23552
  v_exp_f32 v88, v88
  v_exp_f32 v89, v89
  v_exp_f32 v90, v90
  v_exp_f32 v91, v91
  v_mfma_f32_32x32x16_bf16 v[72:87], v[148:151], v[132:135], v[72:87]
  ds_read_b128 v[144:147], v161 offset:2048
  ds_read_b128 v[148:151], v161 offset:2560
  v_exp_f32 v92, v92
  v_exp_f32 v93, v93
  v_exp_f32 v94, v94
  v_exp_f32 v95, v95
  v_exp_f32 v96, v96
  v_cvt_pk_bf16_f32 v120, v88, v89
  v_cvt_pk_bf16_f32 v121, v90, v91
  v_cvt_pk_bf16_f32 v122, v92, v93
  v_cvt_pk_bf16_f32 v123, v94, v95
  v_exp_f32 v97, v97
  v_exp_f32 v98, v98
  v_exp_f32 v99, v99
  v_mfma_f32_32x32x16_bf16 v[56:71], v[152:155], v[120:123], v[56:71]
  buffer_load_dwordx4 a[128:131], v1, s[4:7], s26 offen offset:0 sc1
  v_exp_f32 v100, v100
  v_exp_f32 v101, v101
  v_exp_f32 v102, v102
  v_exp_f32 v103, v103
  v_cvt_pk_bf16_f32 v124, v96, v97
  v_cvt_pk_bf16_f32 v125, v98, v99
  v_cvt_pk_bf16_f32 v126, v100, v101
  v_cvt_pk_bf16_f32 v127, v102, v103
  v_mfma_f32_32x32x16_bf16 v[88:103], v[136:139], v[190:193], v[24:39]
  v_exp_f32 v104, v104
  v_exp_f32 v105, v105
  v_exp_f32 v106, v106
  v_exp_f32 v107, v107
  v_mfma_f32_32x32x16_bf16 v[56:71], v[156:159], v[124:127], v[56:71]
  buffer_load_dwordx4 a[132:135], v1, s[4:7], s27 offen offset:0 sc1
  v_exp_f32 v108, v108
  v_exp_f32 v109, v109
  v_exp_f32 v110, v110
  v_exp_f32 v111, v111
  v_exp_f32 v112, v112
  v_cvt_pk_bf16_f32 v128, v104, v105
  v_cvt_pk_bf16_f32 v129, v106, v107
  v_cvt_pk_bf16_f32 v130, v108, v109
  v_cvt_pk_bf16_f32 v131, v110, v111
  v_exp_f32 v113, v113
  v_exp_f32 v114, v114
  v_exp_f32 v115, v115
  v_mfma_f32_32x32x16_bf16 v[72:87], v[152:155], v[128:131], v[72:87]
  s_waitcnt lgkmcnt(0)
  v_exp_f32 v116, v116
  v_exp_f32 v117, v117
  v_exp_f32 v118, v118
  v_exp_f32 v119, v119
  v_cvt_pk_bf16_f32 v132, v112, v113
  v_cvt_pk_bf16_f32 v133, v114, v115
  v_cvt_pk_bf16_f32 v134, v116, v117
  v_cvt_pk_bf16_f32 v135, v118, v119
  v_mfma_f32_32x32x16_bf16 v[104:119], v[136:139], v[194:197], v[40:55]
  ds_read_b128 v[136:139], v1 offset:24576
  v_exp_f32 v88, v88
  v_exp_f32 v89, v89
  v_exp_f32 v90, v90
  v_exp_f32 v91, v91
  v_mfma_f32_32x32x16_bf16 v[72:87], v[156:159], v[132:135], v[72:87]
  ds_read_b128 v[152:155], v161 offset:3072
  ds_read_b128 v[156:159], v161 offset:3584
  v_exp_f32 v92, v92
  v_exp_f32 v93, v93
  v_exp_f32 v94, v94
  v_exp_f32 v95, v95
  v_exp_f32 v96, v96
  v_cvt_pk_bf16_f32 v120, v88, v89
  v_cvt_pk_bf16_f32 v121, v90, v91
  v_cvt_pk_bf16_f32 v122, v92, v93
  v_cvt_pk_bf16_f32 v123, v94, v95
  v_exp_f32 v97, v97
  v_exp_f32 v98, v98
  v_exp_f32 v99, v99
  v_mfma_f32_32x32x16_bf16 v[56:71], v[144:147], v[120:123], v[56:71]
  buffer_load_dwordx4 a[136:139], v5, s[4:7], s26 offen offset:3072 sc1
  v_exp_f32 v100, v100
  v_exp_f32 v101, v101
  v_exp_f32 v102, v102
  v_exp_f32 v103, v103
  v_cvt_pk_bf16_f32 v124, v96, v97
  v_cvt_pk_bf16_f32 v125, v98, v99
  v_cvt_pk_bf16_f32 v126, v100, v101
  v_cvt_pk_bf16_f32 v127, v102, v103
  v_mfma_f32_32x32x16_bf16 v[88:103], v[140:143], v[190:193], v[24:39]
  v_exp_f32 v104, v104
  v_exp_f32 v105, v105
  v_exp_f32 v106, v106
  v_exp_f32 v107, v107
  v_mfma_f32_32x32x16_bf16 v[56:71], v[148:151], v[124:127], v[56:71]
  buffer_load_dwordx4 a[140:143], v5, s[4:7], s27 offen offset:3072 sc1
  v_exp_f32 v108, v108
  v_exp_f32 v109, v109
  v_exp_f32 v110, v110
  v_exp_f32 v111, v111
  v_exp_f32 v112, v112
  v_cvt_pk_bf16_f32 v128, v104, v105
  v_cvt_pk_bf16_f32 v129, v106, v107
  v_cvt_pk_bf16_f32 v130, v108, v109
  v_cvt_pk_bf16_f32 v131, v110, v111
  v_exp_f32 v113, v113
  v_exp_f32 v114, v114
  v_exp_f32 v115, v115
  v_mfma_f32_32x32x16_bf16 v[72:87], v[144:147], v[128:131], v[72:87]
  s_waitcnt lgkmcnt(0)
  v_exp_f32 v116, v116
  v_exp_f32 v117, v117
  v_exp_f32 v118, v118
  v_exp_f32 v119, v119
  v_cvt_pk_bf16_f32 v132, v112, v113
  v_cvt_pk_bf16_f32 v133, v114, v115
  v_cvt_pk_bf16_f32 v134, v116, v117
  v_cvt_pk_bf16_f32 v135, v118, v119
  v_mfma_f32_32x32x16_bf16 v[104:119], v[140:143], v[194:197], v[40:55]
  ds_read_b128 v[140:143], v1 offset:25600
  v_exp_f32 v88, v88
  v_exp_f32 v89, v89
  v_exp_f32 v90, v90
  v_exp_f32 v91, v91
  v_mfma_f32_32x32x16_bf16 v[72:87], v[148:151], v[132:135], v[72:87]
  ds_read_b128 v[144:147], v161 offset:4096
  ds_read_b128 v[148:151], v161 offset:4608
  v_exp_f32 v92, v92
  v_exp_f32 v93, v93
  v_exp_f32 v94, v94
  v_exp_f32 v95, v95
  v_exp_f32 v96, v96
  v_cvt_pk_bf16_f32 v120, v88, v89
  v_cvt_pk_bf16_f32 v121, v90, v91
  v_cvt_pk_bf16_f32 v122, v92, v93
  v_cvt_pk_bf16_f32 v123, v94, v95
  v_exp_f32 v97, v97
  v_exp_f32 v98, v98
  v_exp_f32 v99, v99
  v_mfma_f32_32x32x16_bf16 v[56:71], v[152:155], v[120:123], v[56:71]
  buffer_load_dwordx4 a[144:147], v7, s[4:7], s26 offen offset:2048 sc1
  v_exp_f32 v100, v100
  v_exp_f32 v101, v101
  v_exp_f32 v102, v102
  v_exp_f32 v103, v103
  v_cvt_pk_bf16_f32 v124, v96, v97
  v_cvt_pk_bf16_f32 v125, v98, v99
  v_cvt_pk_bf16_f32 v126, v100, v101
  v_cvt_pk_bf16_f32 v127, v102, v103
  v_mfma_f32_32x32x16_bf16 v[88:103], v[136:139], v[190:193], v[24:39]
  v_exp_f32 v104, v104
  v_exp_f32 v105, v105
  v_exp_f32 v106, v106
  v_exp_f32 v107, v107
  v_mfma_f32_32x32x16_bf16 v[56:71], v[156:159], v[124:127], v[56:71]
  buffer_load_dwordx4 a[148:151], v7, s[4:7], s27 offen offset:2048 sc1
  v_exp_f32 v108, v108
  v_exp_f32 v109, v109
  v_exp_f32 v110, v110
  v_exp_f32 v111, v111
  v_exp_f32 v112, v112
  v_cvt_pk_bf16_f32 v128, v104, v105
  v_cvt_pk_bf16_f32 v129, v106, v107
  v_cvt_pk_bf16_f32 v130, v108, v109
  v_cvt_pk_bf16_f32 v131, v110, v111
  v_exp_f32 v113, v113
  v_exp_f32 v114, v114
  v_exp_f32 v115, v115
  v_mfma_f32_32x32x16_bf16 v[72:87], v[152:155], v[128:131], v[72:87]
  s_waitcnt lgkmcnt(0)
  v_exp_f32 v116, v116
  v_exp_f32 v117, v117
  v_exp_f32 v118, v118
  v_exp_f32 v119, v119
  v_add_u32 v161, v162, v161
  v_cvt_pk_bf16_f32 v132, v112, v113
  v_cvt_pk_bf16_f32 v133, v114, v115
  v_cvt_pk_bf16_f32 v134, v116, v117
  v_cvt_pk_bf16_f32 v135, v118, v119
  v_mfma_f32_32x32x16_bf16 v[104:119], v[136:139], v[194:197], v[40:55]
  ds_read_b128 v[136:139], v1 offset:26624
  v_exp_f32 v88, v88
  v_exp_f32 v89, v89
  v_exp_f32 v90, v90
  v_exp_f32 v91, v91
  v_mfma_f32_32x32x16_bf16 v[72:87], v[156:159], v[132:135], v[72:87]
  ds_read_b128 v[152:155], v161 offset:1024
  ds_read_b128 v[156:159], v161 offset:1536
  v_exp_f32 v92, v92
  v_exp_f32 v93, v93
  v_exp_f32 v94, v94
  v_exp_f32 v95, v95
  v_exp_f32 v96, v96
  v_cvt_pk_bf16_f32 v120, v88, v89
  v_cvt_pk_bf16_f32 v121, v90, v91
  v_cvt_pk_bf16_f32 v122, v92, v93
  v_cvt_pk_bf16_f32 v123, v94, v95
  v_exp_f32 v97, v97
  v_exp_f32 v98, v98
  v_exp_f32 v99, v99
  v_mfma_f32_32x32x16_bf16 v[56:71], v[144:147], v[120:123], v[56:71]
  buffer_load_dwordx4 a[152:155], v9, s[4:7], s26 offen offset:1024 sc1
  v_exp_f32 v100, v100
  v_exp_f32 v101, v101
  v_exp_f32 v102, v102
  v_exp_f32 v103, v103
  v_cvt_pk_bf16_f32 v124, v96, v97
  v_cvt_pk_bf16_f32 v125, v98, v99
  v_cvt_pk_bf16_f32 v126, v100, v101
  v_cvt_pk_bf16_f32 v127, v102, v103
  v_mfma_f32_32x32x16_bf16 v[88:103], v[140:143], v[190:193], v[24:39]
  v_exp_f32 v104, v104
  v_exp_f32 v105, v105
  v_exp_f32 v106, v106
  v_exp_f32 v107, v107
  v_mfma_f32_32x32x16_bf16 v[56:71], v[148:151], v[124:127], v[56:71]
  buffer_load_dwordx4 a[156:159], v9, s[4:7], s27 offen offset:1024 sc1
  v_exp_f32 v108, v108
  v_exp_f32 v109, v109
  v_exp_f32 v110, v110
  v_exp_f32 v111, v111
  v_exp_f32 v112, v112
  v_cvt_pk_bf16_f32 v128, v104, v105
  v_cvt_pk_bf16_f32 v129, v106, v107
  v_cvt_pk_bf16_f32 v130, v108, v109
  v_cvt_pk_bf16_f32 v131, v110, v111
  v_exp_f32 v113, v113
  v_exp_f32 v114, v114
  v_exp_f32 v115, v115
  v_mfma_f32_32x32x16_bf16 v[72:87], v[144:147], v[128:131], v[72:87]
  s_waitcnt lgkmcnt(0)
  v_exp_f32 v116, v116
  v_exp_f32 v117, v117
  v_exp_f32 v118, v118
  v_exp_f32 v119, v119
  v_cvt_pk_bf16_f32 v132, v112, v113
  v_cvt_pk_bf16_f32 v133, v114, v115
  v_cvt_pk_bf16_f32 v134, v116, v117
  v_cvt_pk_bf16_f32 v135, v118, v119
  v_mfma_f32_32x32x16_bf16 v[104:119], v[140:143], v[194:197], v[40:55]
  ds_read_b128 v[140:143], v1 offset:27648
  v_exp_f32 v88, v88
  v_exp_f32 v89, v89
  v_exp_f32 v90, v90
  v_exp_f32 v91, v91
  v_mfma_f32_32x32x16_bf16 v[72:87], v[148:151], v[132:135], v[72:87]
  ds_read_b128 v[144:147], v161 offset:2048
  ds_read_b128 v[148:151], v161 offset:2560
  v_exp_f32 v92, v92
  v_exp_f32 v93, v93
  v_exp_f32 v94, v94
  v_exp_f32 v95, v95
  v_exp_f32 v96, v96
  v_cvt_pk_bf16_f32 v120, v88, v89
  v_cvt_pk_bf16_f32 v121, v90, v91
  v_cvt_pk_bf16_f32 v122, v92, v93
  v_cvt_pk_bf16_f32 v123, v94, v95
  v_exp_f32 v97, v97
  v_exp_f32 v98, v98
  v_exp_f32 v99, v99
  v_mfma_f32_32x32x16_bf16 v[56:71], v[152:155], v[120:123], v[56:71]
  buffer_load_dwordx4 a[160:163], v1, s[4:7], s26 offen offset:1024 sc1
  v_exp_f32 v100, v100
  v_exp_f32 v101, v101
  v_exp_f32 v102, v102
  v_exp_f32 v103, v103
  v_cvt_pk_bf16_f32 v124, v96, v97
  v_cvt_pk_bf16_f32 v125, v98, v99
  v_cvt_pk_bf16_f32 v126, v100, v101
  v_cvt_pk_bf16_f32 v127, v102, v103
  v_mfma_f32_32x32x16_bf16 v[88:103], v[136:139], v[190:193], v[24:39]
  v_exp_f32 v104, v104
  v_exp_f32 v105, v105
  v_exp_f32 v106, v106
  v_exp_f32 v107, v107
  v_mfma_f32_32x32x16_bf16 v[56:71], v[156:159], v[124:127], v[56:71]
  buffer_load_dwordx4 a[164:167], v1, s[4:7], s27 offen offset:1024 sc1
  v_exp_f32 v108, v108
  v_exp_f32 v109, v109
  v_exp_f32 v110, v110
  v_exp_f32 v111, v111
  v_exp_f32 v112, v112
  v_cvt_pk_bf16_f32 v128, v104, v105
  v_cvt_pk_bf16_f32 v129, v106, v107
  v_cvt_pk_bf16_f32 v130, v108, v109
  v_cvt_pk_bf16_f32 v131, v110, v111
  v_exp_f32 v113, v113
  v_exp_f32 v114, v114
  v_exp_f32 v115, v115
  v_mfma_f32_32x32x16_bf16 v[72:87], v[152:155], v[128:131], v[72:87]
  s_waitcnt lgkmcnt(0)
  v_exp_f32 v116, v116
  v_exp_f32 v117, v117
  v_exp_f32 v118, v118
  v_exp_f32 v119, v119
  v_cvt_pk_bf16_f32 v132, v112, v113
  v_cvt_pk_bf16_f32 v133, v114, v115
  v_cvt_pk_bf16_f32 v134, v116, v117
  v_cvt_pk_bf16_f32 v135, v118, v119
  v_mfma_f32_32x32x16_bf16 v[104:119], v[136:139], v[194:197], v[40:55]
  ds_read_b128 v[136:139], v1 offset:28672
  v_exp_f32 v88, v88
  v_exp_f32 v89, v89
  v_exp_f32 v90, v90
  v_exp_f32 v91, v91
  v_mfma_f32_32x32x16_bf16 v[72:87], v[156:159], v[132:135], v[72:87]
  ds_read_b128 v[152:155], v161 offset:3072
  ds_read_b128 v[156:159], v161 offset:3584
  v_exp_f32 v92, v92
  v_exp_f32 v93, v93
  v_exp_f32 v94, v94
  v_exp_f32 v95, v95
  v_exp_f32 v96, v96
  v_cvt_pk_bf16_f32 v120, v88, v89
  v_cvt_pk_bf16_f32 v121, v90, v91
  v_cvt_pk_bf16_f32 v122, v92, v93
  v_cvt_pk_bf16_f32 v123, v94, v95
  v_exp_f32 v97, v97
  v_exp_f32 v98, v98
  v_exp_f32 v99, v99
  v_mfma_f32_32x32x16_bf16 v[56:71], v[144:147], v[120:123], v[56:71]
  buffer_load_dwordx4 a[168:171], v6, s[4:7], s26 offen offset:0 sc1
  v_exp_f32 v100, v100
  v_exp_f32 v101, v101
  v_exp_f32 v102, v102
  v_exp_f32 v103, v103
  v_cvt_pk_bf16_f32 v124, v96, v97
  v_cvt_pk_bf16_f32 v125, v98, v99
  v_cvt_pk_bf16_f32 v126, v100, v101
  v_cvt_pk_bf16_f32 v127, v102, v103
  v_mfma_f32_32x32x16_bf16 v[88:103], v[140:143], v[190:193], v[24:39]
  v_exp_f32 v104, v104
  v_exp_f32 v105, v105
  v_exp_f32 v106, v106
  v_exp_f32 v107, v107
  v_mfma_f32_32x32x16_bf16 v[56:71], v[148:151], v[124:127], v[56:71]
  buffer_load_dwordx4 a[172:175], v6, s[4:7], s27 offen offset:0 sc1
  v_exp_f32 v108, v108
  v_exp_f32 v109, v109
  v_exp_f32 v110, v110
  v_exp_f32 v111, v111
  v_exp_f32 v112, v112
  v_cvt_pk_bf16_f32 v128, v104, v105
  v_cvt_pk_bf16_f32 v129, v106, v107
  v_cvt_pk_bf16_f32 v130, v108, v109
  v_cvt_pk_bf16_f32 v131, v110, v111
  v_exp_f32 v113, v113
  v_exp_f32 v114, v114
  v_exp_f32 v115, v115
  v_mfma_f32_32x32x16_bf16 v[72:87], v[144:147], v[128:131], v[72:87]
  s_waitcnt lgkmcnt(0)
  v_exp_f32 v116, v116
  v_exp_f32 v117, v117
  v_exp_f32 v118, v118
  v_exp_f32 v119, v119
  v_cvt_pk_bf16_f32 v132, v112, v113
  v_cvt_pk_bf16_f32 v133, v114, v115
  v_cvt_pk_bf16_f32 v134, v116, v117
  v_cvt_pk_bf16_f32 v135, v118, v119
  v_mfma_f32_32x32x16_bf16 v[104:119], v[140:143], v[194:197], v[40:55]
  ds_read_b128 v[140:143], v1 offset:29696
  v_exp_f32 v88, v88
  v_exp_f32 v89, v89
  v_exp_f32 v90, v90
  v_exp_f32 v91, v91
  v_mfma_f32_32x32x16_bf16 v[72:87], v[148:151], v[132:135], v[72:87]
  ds_read_b128 v[144:147], v161 offset:4096
  ds_read_b128 v[148:151], v161 offset:4608
  v_exp_f32 v92, v92
  v_exp_f32 v93, v93
  v_exp_f32 v94, v94
  v_exp_f32 v95, v95
  v_exp_f32 v96, v96
  v_cvt_pk_bf16_f32 v120, v88, v89
  v_cvt_pk_bf16_f32 v121, v90, v91
  v_cvt_pk_bf16_f32 v122, v92, v93
  v_cvt_pk_bf16_f32 v123, v94, v95
  v_exp_f32 v97, v97
  v_exp_f32 v98, v98
  v_exp_f32 v99, v99
  v_mfma_f32_32x32x16_bf16 v[56:71], v[152:155], v[120:123], v[56:71]
  buffer_load_dwordx4 a[176:179], v7, s[4:7], s26 offen offset:3072 sc1
  v_exp_f32 v100, v100
  v_exp_f32 v101, v101
  v_exp_f32 v102, v102
  v_exp_f32 v103, v103
  v_cvt_pk_bf16_f32 v124, v96, v97
  v_cvt_pk_bf16_f32 v125, v98, v99
  v_cvt_pk_bf16_f32 v126, v100, v101
  v_cvt_pk_bf16_f32 v127, v102, v103
  v_mfma_f32_32x32x16_bf16 v[88:103], v[136:139], v[190:193], v[24:39]
  v_exp_f32 v104, v104
  v_exp_f32 v105, v105
  v_exp_f32 v106, v106
  v_exp_f32 v107, v107
  v_mfma_f32_32x32x16_bf16 v[56:71], v[156:159], v[124:127], v[56:71]
  buffer_load_dwordx4 a[180:183], v7, s[4:7], s27 offen offset:3072 sc1
  v_exp_f32 v108, v108
  v_exp_f32 v109, v109
  v_exp_f32 v110, v110
  v_exp_f32 v111, v111
  v_exp_f32 v112, v112
  v_cvt_pk_bf16_f32 v128, v104, v105
  v_cvt_pk_bf16_f32 v129, v106, v107
  v_cvt_pk_bf16_f32 v130, v108, v109
  v_cvt_pk_bf16_f32 v131, v110, v111
  v_exp_f32 v113, v113
  v_exp_f32 v114, v114
  v_exp_f32 v115, v115
  v_mfma_f32_32x32x16_bf16 v[72:87], v[152:155], v[128:131], v[72:87]
  s_waitcnt lgkmcnt(0)
  v_exp_f32 v116, v116
  v_exp_f32 v117, v117
  v_exp_f32 v118, v118
  v_exp_f32 v119, v119
  v_add_u32 v161, v162, v161
  v_cvt_pk_bf16_f32 v132, v112, v113
  v_cvt_pk_bf16_f32 v133, v114, v115
  v_cvt_pk_bf16_f32 v134, v116, v117
  v_cvt_pk_bf16_f32 v135, v118, v119
  v_mfma_f32_32x32x16_bf16 v[104:119], v[136:139], v[194:197], v[40:55]
  ds_read_b128 v[136:139], v1 offset:30720
  v_exp_f32 v88, v88
  v_exp_f32 v89, v89
  v_exp_f32 v90, v90
  v_exp_f32 v91, v91
  v_mfma_f32_32x32x16_bf16 v[72:87], v[156:159], v[132:135], v[72:87]
  ds_read_b128 v[152:155], v161 offset:1024
  ds_read_b128 v[156:159], v161 offset:1536
  v_exp_f32 v92, v92
  v_exp_f32 v93, v93
  v_exp_f32 v94, v94
  v_exp_f32 v95, v95
  v_exp_f32 v96, v96
  v_cvt_pk_bf16_f32 v120, v88, v89
  v_cvt_pk_bf16_f32 v121, v90, v91
  v_cvt_pk_bf16_f32 v122, v92, v93
  v_cvt_pk_bf16_f32 v123, v94, v95
  v_exp_f32 v97, v97
  v_exp_f32 v98, v98
  v_exp_f32 v99, v99
  v_mfma_f32_32x32x16_bf16 v[56:71], v[144:147], v[120:123], v[56:71]
  buffer_load_dwordx4 a[184:187], v9, s[4:7], s26 offen offset:2048 sc1
  v_exp_f32 v100, v100
  v_exp_f32 v101, v101
  v_exp_f32 v102, v102
  v_exp_f32 v103, v103
  v_cvt_pk_bf16_f32 v124, v96, v97
  v_cvt_pk_bf16_f32 v125, v98, v99
  v_cvt_pk_bf16_f32 v126, v100, v101
  v_cvt_pk_bf16_f32 v127, v102, v103
  v_mfma_f32_32x32x16_bf16 v[88:103], v[140:143], v[190:193], v[24:39]
  v_exp_f32 v104, v104
  v_exp_f32 v105, v105
  v_exp_f32 v106, v106
  v_exp_f32 v107, v107
  v_mfma_f32_32x32x16_bf16 v[56:71], v[148:151], v[124:127], v[56:71]
  buffer_load_dwordx4 a[188:191], v9, s[4:7], s27 offen offset:2048 sc1
  v_exp_f32 v108, v108
  v_exp_f32 v109, v109
  v_exp_f32 v110, v110
  v_exp_f32 v111, v111
  v_exp_f32 v112, v112
  v_cvt_pk_bf16_f32 v128, v104, v105
  v_cvt_pk_bf16_f32 v129, v106, v107
  v_cvt_pk_bf16_f32 v130, v108, v109
  v_cvt_pk_bf16_f32 v131, v110, v111
  v_exp_f32 v113, v113
  v_exp_f32 v114, v114
  v_exp_f32 v115, v115
  v_mfma_f32_32x32x16_bf16 v[72:87], v[144:147], v[128:131], v[72:87]
  s_waitcnt lgkmcnt(0)
  v_exp_f32 v116, v116
  v_exp_f32 v117, v117
  v_exp_f32 v118, v118
  v_exp_f32 v119, v119
  v_cvt_pk_bf16_f32 v132, v112, v113
  v_cvt_pk_bf16_f32 v133, v114, v115
  v_cvt_pk_bf16_f32 v134, v116, v117
  v_cvt_pk_bf16_f32 v135, v118, v119
  v_mfma_f32_32x32x16_bf16 v[104:119], v[140:143], v[194:197], v[40:55]
  ds_read_b128 v[140:143], v1 offset:31744
  v_exp_f32 v88, v88
  v_exp_f32 v89, v89
  v_exp_f32 v90, v90
  v_exp_f32 v91, v91
  v_mfma_f32_32x32x16_bf16 v[72:87], v[148:151], v[132:135], v[72:87]
  ds_read_b128 v[144:147], v161 offset:2048
  ds_read_b128 v[148:151], v161 offset:2560
  v_exp_f32 v92, v92
  v_exp_f32 v93, v93
  v_exp_f32 v94, v94
  v_exp_f32 v95, v95
  v_exp_f32 v96, v96
  v_cvt_pk_bf16_f32 v120, v88, v89
  v_cvt_pk_bf16_f32 v121, v90, v91
  v_cvt_pk_bf16_f32 v122, v92, v93
  v_cvt_pk_bf16_f32 v123, v94, v95
  v_exp_f32 v97, v97
  v_exp_f32 v98, v98
  v_exp_f32 v99, v99
  v_mfma_f32_32x32x16_bf16 v[56:71], v[152:155], v[120:123], v[56:71]
  buffer_load_dwordx4 a[192:195], v1, s[4:7], s26 offen offset:2048 sc1
  v_exp_f32 v100, v100
  v_exp_f32 v101, v101
  v_exp_f32 v102, v102
  v_exp_f32 v103, v103
  v_cvt_pk_bf16_f32 v124, v96, v97
  v_cvt_pk_bf16_f32 v125, v98, v99
  v_cvt_pk_bf16_f32 v126, v100, v101
  v_cvt_pk_bf16_f32 v127, v102, v103
  v_mfma_f32_32x32x16_bf16 v[88:103], v[136:139], v[190:193], v[24:39]
  v_exp_f32 v104, v104
  v_exp_f32 v105, v105
  v_exp_f32 v106, v106
  v_exp_f32 v107, v107
  v_mfma_f32_32x32x16_bf16 v[56:71], v[156:159], v[124:127], v[56:71]
  buffer_load_dwordx4 a[196:199], v1, s[4:7], s27 offen offset:2048 sc1
  v_exp_f32 v108, v108
  v_exp_f32 v109, v109
  v_exp_f32 v110, v110
  v_exp_f32 v111, v111
  v_exp_f32 v112, v112
  v_cvt_pk_bf16_f32 v128, v104, v105
  v_cvt_pk_bf16_f32 v129, v106, v107
  v_cvt_pk_bf16_f32 v130, v108, v109
  v_cvt_pk_bf16_f32 v131, v110, v111
  v_exp_f32 v113, v113
  v_exp_f32 v114, v114
  v_exp_f32 v115, v115
  v_mfma_f32_32x32x16_bf16 v[72:87], v[152:155], v[128:131], v[72:87]
  s_waitcnt lgkmcnt(0)
  v_exp_f32 v116, v116
  v_exp_f32 v117, v117
  v_exp_f32 v118, v118
  v_exp_f32 v119, v119
  v_cvt_pk_bf16_f32 v132, v112, v113
  v_cvt_pk_bf16_f32 v133, v114, v115
  v_cvt_pk_bf16_f32 v134, v116, v117
  v_cvt_pk_bf16_f32 v135, v118, v119
  v_mfma_f32_32x32x16_bf16 v[104:119], v[136:139], v[194:197], v[40:55]
  ds_read_b128 v[136:139], v1 offset:32768
  v_exp_f32 v88, v88
  v_exp_f32 v89, v89
  v_exp_f32 v90, v90
  v_exp_f32 v91, v91
  v_mfma_f32_32x32x16_bf16 v[72:87], v[156:159], v[132:135], v[72:87]
  ds_read_b128 v[152:155], v161 offset:3072
  ds_read_b128 v[156:159], v161 offset:3584
  v_exp_f32 v92, v92
  v_exp_f32 v93, v93
  v_exp_f32 v94, v94
  v_exp_f32 v95, v95
  v_exp_f32 v96, v96
  v_cvt_pk_bf16_f32 v120, v88, v89
  v_cvt_pk_bf16_f32 v121, v90, v91
  v_cvt_pk_bf16_f32 v122, v92, v93
  v_cvt_pk_bf16_f32 v123, v94, v95
  v_exp_f32 v97, v97
  v_exp_f32 v98, v98
  v_exp_f32 v99, v99
  v_mfma_f32_32x32x16_bf16 v[56:71], v[144:147], v[120:123], v[56:71]
  buffer_load_dwordx4 a[200:203], v6, s[4:7], s26 offen offset:1024 sc1
  v_exp_f32 v100, v100
  v_exp_f32 v101, v101
  v_exp_f32 v102, v102
  v_exp_f32 v103, v103
  v_cvt_pk_bf16_f32 v124, v96, v97
  v_cvt_pk_bf16_f32 v125, v98, v99
  v_cvt_pk_bf16_f32 v126, v100, v101
  v_cvt_pk_bf16_f32 v127, v102, v103
  v_mfma_f32_32x32x16_bf16 v[88:103], v[140:143], v[190:193], v[24:39]
  v_exp_f32 v104, v104
  v_exp_f32 v105, v105
  v_exp_f32 v106, v106
  v_exp_f32 v107, v107
  v_mfma_f32_32x32x16_bf16 v[56:71], v[148:151], v[124:127], v[56:71]
  buffer_load_dwordx4 a[204:207], v6, s[4:7], s27 offen offset:1024 sc1
  v_exp_f32 v108, v108
  v_exp_f32 v109, v109
  v_exp_f32 v110, v110
  v_exp_f32 v111, v111
  v_exp_f32 v112, v112
  v_cvt_pk_bf16_f32 v128, v104, v105
  v_cvt_pk_bf16_f32 v129, v106, v107
  v_cvt_pk_bf16_f32 v130, v108, v109
  v_cvt_pk_bf16_f32 v131, v110, v111
  v_exp_f32 v113, v113
  v_exp_f32 v114, v114
  v_exp_f32 v115, v115
  v_mfma_f32_32x32x16_bf16 v[72:87], v[144:147], v[128:131], v[72:87]
  s_waitcnt lgkmcnt(0)
  v_exp_f32 v116, v116
  v_exp_f32 v117, v117
  v_exp_f32 v118, v118
  v_exp_f32 v119, v119
  v_cvt_pk_bf16_f32 v132, v112, v113
  v_cvt_pk_bf16_f32 v133, v114, v115
  v_cvt_pk_bf16_f32 v134, v116, v117
  v_cvt_pk_bf16_f32 v135, v118, v119
  v_mfma_f32_32x32x16_bf16 v[104:119], v[140:143], v[194:197], v[40:55]
  ds_read_b128 v[140:143], v1 offset:33792
  v_exp_f32 v88, v88
  v_exp_f32 v89, v89
  v_exp_f32 v90, v90
  v_exp_f32 v91, v91
  v_mfma_f32_32x32x16_bf16 v[72:87], v[148:151], v[132:135], v[72:87]
  ds_read_b128 v[144:147], v161 offset:4096
  ds_read_b128 v[148:151], v161 offset:4608
  v_exp_f32 v92, v92
  v_exp_f32 v93, v93
  v_exp_f32 v94, v94
  v_exp_f32 v95, v95
  v_exp_f32 v96, v96
  v_cvt_pk_bf16_f32 v120, v88, v89
  v_cvt_pk_bf16_f32 v121, v90, v91
  v_cvt_pk_bf16_f32 v122, v92, v93
  v_cvt_pk_bf16_f32 v123, v94, v95
  v_exp_f32 v97, v97
  v_exp_f32 v98, v98
  v_exp_f32 v99, v99
  v_mfma_f32_32x32x16_bf16 v[56:71], v[152:155], v[120:123], v[56:71]
  buffer_load_dwordx4 a[208:211], v8, s[4:7], s26 offen offset:0 sc1
  v_exp_f32 v100, v100
  v_exp_f32 v101, v101
  v_exp_f32 v102, v102
  v_exp_f32 v103, v103
  v_cvt_pk_bf16_f32 v124, v96, v97
  v_cvt_pk_bf16_f32 v125, v98, v99
  v_cvt_pk_bf16_f32 v126, v100, v101
  v_cvt_pk_bf16_f32 v127, v102, v103
  v_mfma_f32_32x32x16_bf16 v[88:103], v[136:139], v[190:193], v[24:39]
  v_exp_f32 v104, v104
  v_exp_f32 v105, v105
  v_exp_f32 v106, v106
  v_exp_f32 v107, v107
  v_mfma_f32_32x32x16_bf16 v[56:71], v[156:159], v[124:127], v[56:71]
  buffer_load_dwordx4 a[212:215], v8, s[4:7], s27 offen offset:0 sc1
  v_exp_f32 v108, v108
  v_exp_f32 v109, v109
  v_exp_f32 v110, v110
  v_exp_f32 v111, v111
  v_exp_f32 v112, v112
  v_cvt_pk_bf16_f32 v128, v104, v105
  v_cvt_pk_bf16_f32 v129, v106, v107
  v_cvt_pk_bf16_f32 v130, v108, v109
  v_cvt_pk_bf16_f32 v131, v110, v111
  v_exp_f32 v113, v113
  v_exp_f32 v114, v114
  v_exp_f32 v115, v115
  v_mfma_f32_32x32x16_bf16 v[72:87], v[152:155], v[128:131], v[72:87]
  s_waitcnt lgkmcnt(0)
  v_exp_f32 v116, v116
  v_exp_f32 v117, v117
  v_exp_f32 v118, v118
  v_exp_f32 v119, v119
  v_add_u32 v161, v162, v161
  v_cvt_pk_bf16_f32 v132, v112, v113
  v_cvt_pk_bf16_f32 v133, v114, v115
  v_cvt_pk_bf16_f32 v134, v116, v117
  v_cvt_pk_bf16_f32 v135, v118, v119
  v_mfma_f32_32x32x16_bf16 v[104:119], v[136:139], v[194:197], v[40:55]
  ds_read_b128 v[136:139], v1 offset:34816
  v_exp_f32 v88, v88
  v_exp_f32 v89, v89
  v_exp_f32 v90, v90
  v_exp_f32 v91, v91
  v_mfma_f32_32x32x16_bf16 v[72:87], v[156:159], v[132:135], v[72:87]
  ds_read_b128 v[152:155], v161 offset:1024
  ds_read_b128 v[156:159], v161 offset:1536
  v_exp_f32 v92, v92
  v_exp_f32 v93, v93
  v_exp_f32 v94, v94
  v_exp_f32 v95, v95
  v_exp_f32 v96, v96
  v_cvt_pk_bf16_f32 v120, v88, v89
  v_cvt_pk_bf16_f32 v121, v90, v91
  v_cvt_pk_bf16_f32 v122, v92, v93
  v_cvt_pk_bf16_f32 v123, v94, v95
  v_exp_f32 v97, v97
  v_exp_f32 v98, v98
  v_exp_f32 v99, v99
  v_mfma_f32_32x32x16_bf16 v[56:71], v[144:147], v[120:123], v[56:71]
  buffer_load_dwordx4 a[216:219], v9, s[4:7], s26 offen offset:3072 sc1
  v_exp_f32 v100, v100
  v_exp_f32 v101, v101
  v_exp_f32 v102, v102
  v_exp_f32 v103, v103
  v_cvt_pk_bf16_f32 v124, v96, v97
  v_cvt_pk_bf16_f32 v125, v98, v99
  v_cvt_pk_bf16_f32 v126, v100, v101
  v_cvt_pk_bf16_f32 v127, v102, v103
  v_mfma_f32_32x32x16_bf16 v[88:103], v[140:143], v[190:193], v[24:39]
  v_exp_f32 v104, v104
  v_exp_f32 v105, v105
  v_exp_f32 v106, v106
  v_exp_f32 v107, v107
  v_mfma_f32_32x32x16_bf16 v[56:71], v[148:151], v[124:127], v[56:71]
  buffer_load_dwordx4 a[220:223], v9, s[4:7], s27 offen offset:3072 sc1
  v_exp_f32 v108, v108
  v_exp_f32 v109, v109
  v_exp_f32 v110, v110
  v_exp_f32 v111, v111
  v_exp_f32 v112, v112
  v_cvt_pk_bf16_f32 v128, v104, v105
  v_cvt_pk_bf16_f32 v129, v106, v107
  v_cvt_pk_bf16_f32 v130, v108, v109
  v_cvt_pk_bf16_f32 v131, v110, v111
  v_exp_f32 v113, v113
  v_exp_f32 v114, v114
  v_exp_f32 v115, v115
  v_mfma_f32_32x32x16_bf16 v[72:87], v[144:147], v[128:131], v[72:87]
  s_waitcnt lgkmcnt(0)
  v_exp_f32 v116, v116
  v_exp_f32 v117, v117
  v_exp_f32 v118, v118
  v_exp_f32 v119, v119
  v_cvt_pk_bf16_f32 v132, v112, v113
  v_cvt_pk_bf16_f32 v133, v114, v115
  v_cvt_pk_bf16_f32 v134, v116, v117
  v_cvt_pk_bf16_f32 v135, v118, v119
  v_mfma_f32_32x32x16_bf16 v[104:119], v[140:143], v[194:197], v[40:55]
  ds_read_b128 v[140:143], v1 offset:35840
  v_exp_f32 v88, v88
  v_exp_f32 v89, v89
  v_exp_f32 v90, v90
  v_exp_f32 v91, v91
  v_mfma_f32_32x32x16_bf16 v[72:87], v[148:151], v[132:135], v[72:87]
  ds_read_b128 v[144:147], v161 offset:2048
  ds_read_b128 v[148:151], v161 offset:2560
  v_exp_f32 v92, v92
  v_exp_f32 v93, v93
  v_exp_f32 v94, v94
  v_exp_f32 v95, v95
  v_exp_f32 v96, v96
  v_cvt_pk_bf16_f32 v120, v88, v89
  v_cvt_pk_bf16_f32 v121, v90, v91
  v_cvt_pk_bf16_f32 v122, v92, v93
  v_cvt_pk_bf16_f32 v123, v94, v95
  v_exp_f32 v97, v97
  v_exp_f32 v98, v98
  v_exp_f32 v99, v99
  v_mfma_f32_32x32x16_bf16 v[56:71], v[152:155], v[120:123], v[56:71]
  buffer_load_dwordx4 a[224:227], v1, s[4:7], s26 offen offset:3072 sc1
  v_exp_f32 v100, v100
  v_exp_f32 v101, v101
  v_exp_f32 v102, v102
  v_exp_f32 v103, v103
  v_cvt_pk_bf16_f32 v124, v96, v97
  v_cvt_pk_bf16_f32 v125, v98, v99
  v_cvt_pk_bf16_f32 v126, v100, v101
  v_cvt_pk_bf16_f32 v127, v102, v103
  v_mfma_f32_32x32x16_bf16 v[88:103], v[136:139], v[190:193], v[24:39]
  v_exp_f32 v104, v104
  v_exp_f32 v105, v105
  v_exp_f32 v106, v106
  v_exp_f32 v107, v107
  v_mfma_f32_32x32x16_bf16 v[56:71], v[156:159], v[124:127], v[56:71]
  buffer_load_dwordx4 a[228:231], v1, s[4:7], s27 offen offset:3072 sc1
  v_exp_f32 v108, v108
  v_exp_f32 v109, v109
  v_exp_f32 v110, v110
  v_exp_f32 v111, v111
  v_exp_f32 v112, v112
  v_cvt_pk_bf16_f32 v128, v104, v105
  v_cvt_pk_bf16_f32 v129, v106, v107
  v_cvt_pk_bf16_f32 v130, v108, v109
  v_cvt_pk_bf16_f32 v131, v110, v111
  v_exp_f32 v113, v113
  v_exp_f32 v114, v114
  v_exp_f32 v115, v115
  v_mfma_f32_32x32x16_bf16 v[72:87], v[152:155], v[128:131], v[72:87]
  s_waitcnt lgkmcnt(0)
  s_barrier
  v_exp_f32 v116, v116
  v_exp_f32 v117, v117
  v_exp_f32 v118, v118
  v_exp_f32 v119, v119
  v_cvt_pk_bf16_f32 v132, v112, v113
  v_cvt_pk_bf16_f32 v133, v114, v115
  v_cvt_pk_bf16_f32 v134, v116, v117
  v_cvt_pk_bf16_f32 v135, v118, v119
  v_mfma_f32_32x32x16_bf16 v[104:119], v[136:139], v[194:197], v[40:55]
  ds_read_b128 v[136:139], v1 offset:36864
  v_exp_f32 v88, v88
  v_exp_f32 v89, v89
  v_exp_f32 v90, v90
  v_exp_f32 v91, v91
  v_mfma_f32_32x32x16_bf16 v[72:87], v[156:159], v[132:135], v[72:87]
  ds_read_b128 v[152:155], v161 offset:3072
  ds_read_b128 v[156:159], v161 offset:3584
  v_exp_f32 v92, v92
  v_exp_f32 v93, v93
  v_exp_f32 v94, v94
  v_exp_f32 v95, v95
  v_exp_f32 v96, v96
  v_cvt_pk_bf16_f32 v120, v88, v89
  v_cvt_pk_bf16_f32 v121, v90, v91
  v_cvt_pk_bf16_f32 v122, v92, v93
  v_cvt_pk_bf16_f32 v123, v94, v95
  v_exp_f32 v97, v97
  v_exp_f32 v98, v98
  v_exp_f32 v99, v99
  v_mfma_f32_32x32x16_bf16 v[56:71], v[144:147], v[120:123], v[56:71]
  s_add_u32 m0, s48, 0
  s_add_u32 s29, s47, 0
  buffer_load_dwordx4 v1, s[4:7], s29 offen offset:0 sc1 lds
  v_exp_f32 v100, v100
  v_exp_f32 v101, v101
  v_exp_f32 v102, v102
  v_exp_f32 v103, v103
  v_cvt_pk_bf16_f32 v124, v96, v97
  v_cvt_pk_bf16_f32 v125, v98, v99
  v_cvt_pk_bf16_f32 v126, v100, v101
  v_cvt_pk_bf16_f32 v127, v102, v103
  v_mfma_f32_32x32x16_bf16 v[88:103], v[140:143], v[190:193], v[24:39]
  v_exp_f32 v104, v104
  v_exp_f32 v105, v105
  v_exp_f32 v106, v106
  v_exp_f32 v107, v107
  v_mfma_f32_32x32x16_bf16 v[56:71], v[148:151], v[124:127], v[56:71]
  buffer_load_dwordx4 v1, s[4:7], s29 offen offset:1024 sc1 lds
  v_exp_f32 v108, v108
  v_exp_f32 v109, v109
  v_exp_f32 v110, v110
  v_exp_f32 v111, v111
  v_exp_f32 v112, v112
  v_cvt_pk_bf16_f32 v128, v104, v105
  v_cvt_pk_bf16_f32 v129, v106, v107
  v_cvt_pk_bf16_f32 v130, v108, v109
  v_cvt_pk_bf16_f32 v131, v110, v111
  v_exp_f32 v113, v113
  v_exp_f32 v114, v114
  v_exp_f32 v115, v115
  v_mfma_f32_32x32x16_bf16 v[72:87], v[144:147], v[128:131], v[72:87]
  s_waitcnt lgkmcnt(0)
  v_exp_f32 v116, v116
  v_exp_f32 v117, v117
  v_exp_f32 v118, v118
  v_exp_f32 v119, v119
  v_cvt_pk_bf16_f32 v132, v112, v113
  v_cvt_pk_bf16_f32 v133, v114, v115
  v_cvt_pk_bf16_f32 v134, v116, v117
  v_cvt_pk_bf16_f32 v135, v118, v119
  v_mfma_f32_32x32x16_bf16 v[104:119], v[140:143], v[194:197], v[40:55]
  ds_read_b128 v[140:143], v1 offset:37888
  v_exp_f32 v88, v88
  v_exp_f32 v89, v89
  v_exp_f32 v90, v90
  v_exp_f32 v91, v91
  v_mfma_f32_32x32x16_bf16 v[72:87], v[148:151], v[132:135], v[72:87]
  ds_read_b128 v[144:147], v161 offset:4096
  ds_read_b128 v[148:151], v161 offset:4608
  v_exp_f32 v92, v92
  v_exp_f32 v93, v93
  v_exp_f32 v94, v94
  v_exp_f32 v95, v95
  v_exp_f32 v96, v96
  v_cvt_pk_bf16_f32 v120, v88, v89
  v_cvt_pk_bf16_f32 v121, v90, v91
  v_cvt_pk_bf16_f32 v122, v92, v93
  v_cvt_pk_bf16_f32 v123, v94, v95
  v_exp_f32 v97, v97
  v_exp_f32 v98, v98
  v_exp_f32 v99, v99
  v_mfma_f32_32x32x16_bf16 v[56:71], v[152:155], v[120:123], v[56:71]
  buffer_load_dwordx4 v1, s[4:7], s29 offen offset:2048 sc1 lds
  v_exp_f32 v100, v100
  v_exp_f32 v101, v101
  v_exp_f32 v102, v102
  v_exp_f32 v103, v103
  v_cvt_pk_bf16_f32 v124, v96, v97
  v_cvt_pk_bf16_f32 v125, v98, v99
  v_cvt_pk_bf16_f32 v126, v100, v101
  v_cvt_pk_bf16_f32 v127, v102, v103
  v_mfma_f32_32x32x16_bf16 v[88:103], v[136:139], v[190:193], v[24:39]
  v_exp_f32 v104, v104
  v_exp_f32 v105, v105
  v_exp_f32 v106, v106
  v_exp_f32 v107, v107
  v_mfma_f32_32x32x16_bf16 v[56:71], v[156:159], v[124:127], v[56:71]
  buffer_load_dwordx4 v1, s[4:7], s29 offen offset:3072 sc1 lds
  v_exp_f32 v108, v108
  v_exp_f32 v109, v109
  v_exp_f32 v110, v110
  v_exp_f32 v111, v111
  v_exp_f32 v112, v112
  v_cvt_pk_bf16_f32 v128, v104, v105
  v_cvt_pk_bf16_f32 v129, v106, v107
  v_cvt_pk_bf16_f32 v130, v108, v109
  v_cvt_pk_bf16_f32 v131, v110, v111
  v_exp_f32 v113, v113
  v_exp_f32 v114, v114
  v_exp_f32 v115, v115
  v_mfma_f32_32x32x16_bf16 v[72:87], v[152:155], v[128:131], v[72:87]
  s_waitcnt lgkmcnt(0)
  v_exp_f32 v116, v116
  v_exp_f32 v117, v117
  v_exp_f32 v118, v118
  v_exp_f32 v119, v119
  v_add_u32 v161, v162, v161
  v_cvt_pk_bf16_f32 v132, v112, v113
  v_cvt_pk_bf16_f32 v133, v114, v115
  v_cvt_pk_bf16_f32 v134, v116, v117
  v_cvt_pk_bf16_f32 v135, v118, v119
  v_mfma_f32_32x32x16_bf16 v[104:119], v[136:139], v[194:197], v[40:55]
  ds_read_b128 v[136:139], v1 offset:38912
  v_exp_f32 v88, v88
  v_exp_f32 v89, v89
  v_exp_f32 v90, v90
  v_exp_f32 v91, v91
  v_mfma_f32_32x32x16_bf16 v[72:87], v[156:159], v[132:135], v[72:87]
  ds_read_b128 v[152:155], v161 offset:1024
  ds_read_b128 v[156:159], v161 offset:1536
  v_exp_f32 v92, v92
  v_exp_f32 v93, v93
  v_exp_f32 v94, v94
  v_exp_f32 v95, v95
  v_exp_f32 v96, v96
  v_cvt_pk_bf16_f32 v120, v88, v89
  v_cvt_pk_bf16_f32 v121, v90, v91
  v_cvt_pk_bf16_f32 v122, v92, v93
  v_cvt_pk_bf16_f32 v123, v94, v95
  v_exp_f32 v97, v97
  v_exp_f32 v98, v98
  v_exp_f32 v99, v99
  v_mfma_f32_32x32x16_bf16 v[56:71], v[144:147], v[120:123], v[56:71]
  s_add_u32 m0, s48, 4096
  s_add_u32 s29, s47, 4096
  buffer_load_dwordx4 v1, s[4:7], s29 offen offset:0 sc1 lds
  v_exp_f32 v100, v100
  v_exp_f32 v101, v101
  v_exp_f32 v102, v102
  v_exp_f32 v103, v103
  v_cvt_pk_bf16_f32 v124, v96, v97
  v_cvt_pk_bf16_f32 v125, v98, v99
  v_cvt_pk_bf16_f32 v126, v100, v101
  v_cvt_pk_bf16_f32 v127, v102, v103
  v_mfma_f32_32x32x16_bf16 v[88:103], v[140:143], v[190:193], v[24:39]
  v_exp_f32 v104, v104
  v_exp_f32 v105, v105
  v_exp_f32 v106, v106
  v_exp_f32 v107, v107
  v_mfma_f32_32x32x16_bf16 v[56:71], v[148:151], v[124:127], v[56:71]
  buffer_load_dwordx4 v1, s[4:7], s29 offen offset:1024 sc1 lds
  v_exp_f32 v108, v108
  v_exp_f32 v109, v109
  v_exp_f32 v110, v110
  v_exp_f32 v111, v111
  v_exp_f32 v112, v112
  v_cvt_pk_bf16_f32 v128, v104, v105
  v_cvt_pk_bf16_f32 v129, v106, v107
  v_cvt_pk_bf16_f32 v130, v108, v109
  v_cvt_pk_bf16_f32 v131, v110, v111
  v_exp_f32 v113, v113
  v_exp_f32 v114, v114
  v_exp_f32 v115, v115
  v_mfma_f32_32x32x16_bf16 v[72:87], v[144:147], v[128:131], v[72:87]
  s_waitcnt lgkmcnt(0)
  v_exp_f32 v116, v116
  v_exp_f32 v117, v117
  v_exp_f32 v118, v118
  v_exp_f32 v119, v119
  v_cvt_pk_bf16_f32 v132, v112, v113
  v_cvt_pk_bf16_f32 v133, v114, v115
  v_cvt_pk_bf16_f32 v134, v116, v117
  v_cvt_pk_bf16_f32 v135, v118, v119
  v_mfma_f32_32x32x16_bf16 v[104:119], v[140:143], v[194:197], v[40:55]
  ds_read_b128 v[140:143], v1 offset:39936
  v_exp_f32 v88, v88
  v_exp_f32 v89, v89
  v_exp_f32 v90, v90
  v_exp_f32 v91, v91
  v_mfma_f32_32x32x16_bf16 v[72:87], v[148:151], v[132:135], v[72:87]
  ds_read_b128 v[144:147], v161 offset:2048
  ds_read_b128 v[148:151], v161 offset:2560
  v_exp_f32 v92, v92
  v_exp_f32 v93, v93
  v_exp_f32 v94, v94
  v_exp_f32 v95, v95
  v_exp_f32 v96, v96
  v_cvt_pk_bf16_f32 v120, v88, v89
  v_cvt_pk_bf16_f32 v121, v90, v91
  v_cvt_pk_bf16_f32 v122, v92, v93
  v_cvt_pk_bf16_f32 v123, v94, v95
  v_exp_f32 v97, v97
  v_exp_f32 v98, v98
  v_exp_f32 v99, v99
  v_mfma_f32_32x32x16_bf16 v[56:71], v[152:155], v[120:123], v[56:71]
  buffer_load_dwordx4 v1, s[4:7], s29 offen offset:2048 sc1 lds
  v_exp_f32 v100, v100
  v_exp_f32 v101, v101
  v_exp_f32 v102, v102
  v_exp_f32 v103, v103
  v_cvt_pk_bf16_f32 v124, v96, v97
  v_cvt_pk_bf16_f32 v125, v98, v99
  v_cvt_pk_bf16_f32 v126, v100, v101
  v_cvt_pk_bf16_f32 v127, v102, v103
  v_mfma_f32_32x32x16_bf16 v[88:103], v[136:139], v[190:193], v[24:39]
  v_exp_f32 v104, v104
  v_exp_f32 v105, v105
  v_exp_f32 v106, v106
  v_exp_f32 v107, v107
  v_mfma_f32_32x32x16_bf16 v[56:71], v[156:159], v[124:127], v[56:71]
  buffer_load_dwordx4 v1, s[4:7], s29 offen offset:3072 sc1 lds
  v_exp_f32 v108, v108
  v_exp_f32 v109, v109
  v_exp_f32 v110, v110
  v_exp_f32 v111, v111
  v_exp_f32 v112, v112
  v_cvt_pk_bf16_f32 v128, v104, v105
  v_cvt_pk_bf16_f32 v129, v106, v107
  v_cvt_pk_bf16_f32 v130, v108, v109
  v_cvt_pk_bf16_f32 v131, v110, v111
  v_exp_f32 v113, v113
  v_exp_f32 v114, v114
  v_exp_f32 v115, v115
  v_mfma_f32_32x32x16_bf16 v[72:87], v[152:155], v[128:131], v[72:87]
  s_waitcnt lgkmcnt(0)
  v_exp_f32 v116, v116
  v_exp_f32 v117, v117
  v_exp_f32 v118, v118
  v_exp_f32 v119, v119
  v_cvt_pk_bf16_f32 v132, v112, v113
  v_cvt_pk_bf16_f32 v133, v114, v115
  v_cvt_pk_bf16_f32 v134, v116, v117
  v_cvt_pk_bf16_f32 v135, v118, v119
  v_mfma_f32_32x32x16_bf16 v[104:119], v[136:139], v[194:197], v[40:55]
  ds_read_b128 v[136:139], v1 offset:40960
  v_exp_f32 v88, v88
  v_exp_f32 v89, v89
  v_exp_f32 v90, v90
  v_exp_f32 v91, v91
  v_mfma_f32_32x32x16_bf16 v[72:87], v[156:159], v[132:135], v[72:87]
  ds_read_b128 v[152:155], v161 offset:3072
  ds_read_b128 v[156:159], v161 offset:3584
  v_exp_f32 v92, v92
  v_exp_f32 v93, v93
  v_exp_f32 v94, v94
  v_exp_f32 v95, v95
  v_exp_f32 v96, v96
  v_cvt_pk_bf16_f32 v120, v88, v89
  v_cvt_pk_bf16_f32 v121, v90, v91
  v_cvt_pk_bf16_f32 v122, v92, v93
  v_cvt_pk_bf16_f32 v123, v94, v95
  v_exp_f32 v97, v97
  v_exp_f32 v98, v98
  v_exp_f32 v99, v99
  v_mfma_f32_32x32x16_bf16 v[56:71], v[144:147], v[120:123], v[56:71]
  s_add_u32 m0, s48, 65536
  s_add_u32 s29, s47, 32768
  buffer_load_dwordx4 v1, s[4:7], s29 offen offset:0 sc1 lds
  v_exp_f32 v100, v100
  v_exp_f32 v101, v101
  v_exp_f32 v102, v102
  v_exp_f32 v103, v103
  v_cvt_pk_bf16_f32 v124, v96, v97
  v_cvt_pk_bf16_f32 v125, v98, v99
  v_cvt_pk_bf16_f32 v126, v100, v101
  v_cvt_pk_bf16_f32 v127, v102, v103
  v_mfma_f32_32x32x16_bf16 v[88:103], v[140:143], v[190:193], v[24:39]
  v_exp_f32 v104, v104
  v_exp_f32 v105, v105
  v_exp_f32 v106, v106
  v_exp_f32 v107, v107
  v_mfma_f32_32x32x16_bf16 v[56:71], v[148:151], v[124:127], v[56:71]
  buffer_load_dwordx4 v1, s[4:7], s29 offen offset:1024 sc1 lds
  v_exp_f32 v108, v108
  v_exp_f32 v109, v109
  v_exp_f32 v110, v110
  v_exp_f32 v111, v111
  v_exp_f32 v112, v112
  v_cvt_pk_bf16_f32 v128, v104, v105
  v_cvt_pk_bf16_f32 v129, v106, v107
  v_cvt_pk_bf16_f32 v130, v108, v109
  v_cvt_pk_bf16_f32 v131, v110, v111
  v_exp_f32 v113, v113
  v_exp_f32 v114, v114
  v_exp_f32 v115, v115
  v_mfma_f32_32x32x16_bf16 v[72:87], v[144:147], v[128:131], v[72:87]
  s_waitcnt lgkmcnt(0)
  v_exp_f32 v116, v116
  v_exp_f32 v117, v117
  v_exp_f32 v118, v118
  v_exp_f32 v119, v119
  v_cvt_pk_bf16_f32 v132, v112, v113
  v_cvt_pk_bf16_f32 v133, v114, v115
  v_cvt_pk_bf16_f32 v134, v116, v117
  v_cvt_pk_bf16_f32 v135, v118, v119
  v_mfma_f32_32x32x16_bf16 v[104:119], v[140:143], v[194:197], v[40:55]
  ds_read_b128 v[140:143], v1 offset:41984
  v_exp_f32 v88, v88
  v_exp_f32 v89, v89
  v_exp_f32 v90, v90
  v_exp_f32 v91, v91
  v_mfma_f32_32x32x16_bf16 v[72:87], v[148:151], v[132:135], v[72:87]
  ds_read_b128 v[144:147], v161 offset:4096
  ds_read_b128 v[148:151], v161 offset:4608
  v_exp_f32 v92, v92
  v_exp_f32 v93, v93
  v_exp_f32 v94, v94
  v_exp_f32 v95, v95
  v_exp_f32 v96, v96
  v_cvt_pk_bf16_f32 v120, v88, v89
  v_cvt_pk_bf16_f32 v121, v90, v91
  v_cvt_pk_bf16_f32 v122, v92, v93
  v_cvt_pk_bf16_f32 v123, v94, v95
  v_exp_f32 v97, v97
  v_exp_f32 v98, v98
  v_exp_f32 v99, v99
  v_mfma_f32_32x32x16_bf16 v[56:71], v[152:155], v[120:123], v[56:71]
  buffer_load_dwordx4 v1, s[4:7], s29 offen offset:2048 sc1 lds
  v_exp_f32 v100, v100
  v_exp_f32 v101, v101
  v_exp_f32 v102, v102
  v_exp_f32 v103, v103
  v_cvt_pk_bf16_f32 v124, v96, v97
  v_cvt_pk_bf16_f32 v125, v98, v99
  v_cvt_pk_bf16_f32 v126, v100, v101
  v_cvt_pk_bf16_f32 v127, v102, v103
  v_mfma_f32_32x32x16_bf16 v[88:103], v[136:139], v[190:193], v[24:39]
  v_exp_f32 v104, v104
  v_exp_f32 v105, v105
  v_exp_f32 v106, v106
  v_exp_f32 v107, v107
  v_mfma_f32_32x32x16_bf16 v[56:71], v[156:159], v[124:127], v[56:71]
  buffer_load_dwordx4 v1, s[4:7], s29 offen offset:3072 sc1 lds
  v_exp_f32 v108, v108
  v_exp_f32 v109, v109
  v_exp_f32 v110, v110
  v_exp_f32 v111, v111
  v_exp_f32 v112, v112
  v_cvt_pk_bf16_f32 v128, v104, v105
  v_cvt_pk_bf16_f32 v129, v106, v107
  v_cvt_pk_bf16_f32 v130, v108, v109
  v_cvt_pk_bf16_f32 v131, v110, v111
  v_exp_f32 v113, v113
  v_exp_f32 v114, v114
  v_exp_f32 v115, v115
  v_mfma_f32_32x32x16_bf16 v[72:87], v[152:155], v[128:131], v[72:87]
  s_waitcnt lgkmcnt(0)
  v_exp_f32 v116, v116
  v_exp_f32 v117, v117
  v_exp_f32 v118, v118
  v_exp_f32 v119, v119
  v_add_u32 v161, v162, v161
  v_cvt_pk_bf16_f32 v132, v112, v113
  v_cvt_pk_bf16_f32 v133, v114, v115
  v_cvt_pk_bf16_f32 v134, v116, v117
  v_cvt_pk_bf16_f32 v135, v118, v119
  v_mfma_f32_32x32x16_bf16 v[104:119], v[136:139], v[194:197], v[40:55]
  ds_read_b128 v[136:139], v1 offset:43008
  v_exp_f32 v88, v88
  v_exp_f32 v89, v89
  v_exp_f32 v90, v90
  v_exp_f32 v91, v91
  v_mfma_f32_32x32x16_bf16 v[72:87], v[156:159], v[132:135], v[72:87]
  ds_read_b128 v[152:155], v161 offset:1024
  ds_read_b128 v[156:159], v161 offset:1536
  v_exp_f32 v92, v92
  v_exp_f32 v93, v93
  v_exp_f32 v94, v94
  v_exp_f32 v95, v95
  v_exp_f32 v96, v96
  v_cvt_pk_bf16_f32 v120, v88, v89
  v_cvt_pk_bf16_f32 v121, v90, v91
  v_cvt_pk_bf16_f32 v122, v92, v93
  v_cvt_pk_bf16_f32 v123, v94, v95
  v_exp_f32 v97, v97
  v_exp_f32 v98, v98
  v_exp_f32 v99, v99
  v_mfma_f32_32x32x16_bf16 v[56:71], v[144:147], v[120:123], v[56:71]
  s_add_u32 m0, s48, 69632
  s_add_u32 s29, s47, 36864
  buffer_load_dwordx4 v1, s[4:7], s29 offen offset:0 sc1 lds
  v_exp_f32 v100, v100
  v_exp_f32 v101, v101
  v_exp_f32 v102, v102
  v_exp_f32 v103, v103
  v_cvt_pk_bf16_f32 v124, v96, v97
  v_cvt_pk_bf16_f32 v125, v98, v99
  v_cvt_pk_bf16_f32 v126, v100, v101
  v_cvt_pk_bf16_f32 v127, v102, v103
  v_mfma_f32_32x32x16_bf16 v[88:103], v[140:143], v[190:193], v[24:39]
  v_exp_f32 v104, v104
  v_exp_f32 v105, v105
  v_exp_f32 v106, v106
  v_exp_f32 v107, v107
  v_mfma_f32_32x32x16_bf16 v[56:71], v[148:151], v[124:127], v[56:71]
  buffer_load_dwordx4 v1, s[4:7], s29 offen offset:1024 sc1 lds
  v_exp_f32 v108, v108
  v_exp_f32 v109, v109
  v_exp_f32 v110, v110
  v_exp_f32 v111, v111
  v_exp_f32 v112, v112
  v_cvt_pk_bf16_f32 v128, v104, v105
  v_cvt_pk_bf16_f32 v129, v106, v107
  v_cvt_pk_bf16_f32 v130, v108, v109
  v_cvt_pk_bf16_f32 v131, v110, v111
  v_exp_f32 v113, v113
  v_exp_f32 v114, v114
  v_exp_f32 v115, v115
  v_mfma_f32_32x32x16_bf16 v[72:87], v[144:147], v[128:131], v[72:87]
  s_waitcnt lgkmcnt(0)
  v_exp_f32 v116, v116
  v_exp_f32 v117, v117
  v_exp_f32 v118, v118
  v_exp_f32 v119, v119
  v_cvt_pk_bf16_f32 v132, v112, v113
  v_cvt_pk_bf16_f32 v133, v114, v115
  v_cvt_pk_bf16_f32 v134, v116, v117
  v_cvt_pk_bf16_f32 v135, v118, v119
  v_mfma_f32_32x32x16_bf16 v[104:119], v[140:143], v[194:197], v[40:55]
  ds_read_b128 v[140:143], v1 offset:44032
  v_exp_f32 v88, v88
  v_exp_f32 v89, v89
  v_exp_f32 v90, v90
  v_exp_f32 v91, v91
  v_mfma_f32_32x32x16_bf16 v[72:87], v[148:151], v[132:135], v[72:87]
  ds_read_b128 v[144:147], v161 offset:2048
  ds_read_b128 v[148:151], v161 offset:2560
  v_exp_f32 v92, v92
  v_exp_f32 v93, v93
  v_exp_f32 v94, v94
  v_exp_f32 v95, v95
  v_exp_f32 v96, v96
  v_cvt_pk_bf16_f32 v120, v88, v89
  v_cvt_pk_bf16_f32 v121, v90, v91
  v_cvt_pk_bf16_f32 v122, v92, v93
  v_cvt_pk_bf16_f32 v123, v94, v95
  v_exp_f32 v97, v97
  v_exp_f32 v98, v98
  v_exp_f32 v99, v99
  v_mfma_f32_32x32x16_bf16 v[56:71], v[152:155], v[120:123], v[56:71]
  buffer_load_dwordx4 v1, s[4:7], s29 offen offset:2048 sc1 lds
  v_exp_f32 v100, v100
  v_exp_f32 v101, v101
  v_exp_f32 v102, v102
  v_exp_f32 v103, v103
  v_cvt_pk_bf16_f32 v124, v96, v97
  v_cvt_pk_bf16_f32 v125, v98, v99
  v_cvt_pk_bf16_f32 v126, v100, v101
  v_cvt_pk_bf16_f32 v127, v102, v103
  v_mfma_f32_32x32x16_bf16 v[88:103], v[136:139], v[190:193], v[24:39]
  v_exp_f32 v104, v104
  v_exp_f32 v105, v105
  v_exp_f32 v106, v106
  v_exp_f32 v107, v107
  v_mfma_f32_32x32x16_bf16 v[56:71], v[156:159], v[124:127], v[56:71]
  buffer_load_dwordx4 v1, s[4:7], s29 offen offset:3072 sc1 lds
  v_exp_f32 v108, v108
  v_exp_f32 v109, v109
  v_exp_f32 v110, v110
  v_exp_f32 v111, v111
  v_exp_f32 v112, v112
  v_cvt_pk_bf16_f32 v128, v104, v105
  v_cvt_pk_bf16_f32 v129, v106, v107
  v_cvt_pk_bf16_f32 v130, v108, v109
  v_cvt_pk_bf16_f32 v131, v110, v111
  v_exp_f32 v113, v113
  v_exp_f32 v114, v114
  v_exp_f32 v115, v115
  v_mfma_f32_32x32x16_bf16 v[72:87], v[152:155], v[128:131], v[72:87]
  s_waitcnt lgkmcnt(0)
  v_exp_f32 v116, v116
  v_exp_f32 v117, v117
  v_exp_f32 v118, v118
  v_exp_f32 v119, v119
  v_cvt_pk_bf16_f32 v132, v112, v113
  v_cvt_pk_bf16_f32 v133, v114, v115
  v_cvt_pk_bf16_f32 v134, v116, v117
  v_cvt_pk_bf16_f32 v135, v118, v119
  v_mfma_f32_32x32x16_bf16 v[104:119], v[136:139], v[194:197], v[40:55]
  ds_read_b128 v[136:139], v1 offset:45056
  v_exp_f32 v88, v88
  v_exp_f32 v89, v89
  v_exp_f32 v90, v90
  v_exp_f32 v91, v91
  v_mfma_f32_32x32x16_bf16 v[72:87], v[156:159], v[132:135], v[72:87]
  ds_read_b128 v[152:155], v161 offset:3072
  ds_read_b128 v[156:159], v161 offset:3584
  v_exp_f32 v92, v92
  v_exp_f32 v93, v93
  v_exp_f32 v94, v94
  v_exp_f32 v95, v95
  v_exp_f32 v96, v96
  v_cvt_pk_bf16_f32 v120, v88, v89
  v_cvt_pk_bf16_f32 v121, v90, v91
  v_cvt_pk_bf16_f32 v122, v92, v93
  v_cvt_pk_bf16_f32 v123, v94, v95
  v_exp_f32 v97, v97
  v_exp_f32 v98, v98
  v_exp_f32 v99, v99
  v_mfma_f32_32x32x16_bf16 v[56:71], v[144:147], v[120:123], v[56:71]
  buffer_load_dwordx4 a[232:235], v6, s[4:7], s26 offen offset:2048 sc1
  v_exp_f32 v100, v100
  v_exp_f32 v101, v101
  v_exp_f32 v102, v102
  v_exp_f32 v103, v103
  v_cvt_pk_bf16_f32 v124, v96, v97
  v_cvt_pk_bf16_f32 v125, v98, v99
  v_cvt_pk_bf16_f32 v126, v100, v101
  v_cvt_pk_bf16_f32 v127, v102, v103
  v_mfma_f32_32x32x16_bf16 v[88:103], v[140:143], v[190:193], v[24:39]
  v_exp_f32 v104, v104
  v_exp_f32 v105, v105
  v_exp_f32 v106, v106
  v_exp_f32 v107, v107
  v_mfma_f32_32x32x16_bf16 v[56:71], v[148:151], v[124:127], v[56:71]
  buffer_load_dwordx4 a[236:239], v6, s[4:7], s27 offen offset:2048 sc1
  v_exp_f32 v108, v108
  v_exp_f32 v109, v109
  v_exp_f32 v110, v110
  v_exp_f32 v111, v111
  v_exp_f32 v112, v112
  v_cvt_pk_bf16_f32 v128, v104, v105
  v_cvt_pk_bf16_f32 v129, v106, v107
  v_cvt_pk_bf16_f32 v130, v108, v109
  v_cvt_pk_bf16_f32 v131, v110, v111
  v_exp_f32 v113, v113
  v_exp_f32 v114, v114
  v_exp_f32 v115, v115
  v_mfma_f32_32x32x16_bf16 v[72:87], v[144:147], v[128:131], v[72:87]
  s_waitcnt lgkmcnt(0)
  v_exp_f32 v116, v116
  v_exp_f32 v117, v117
  v_exp_f32 v118, v118
  v_exp_f32 v119, v119
  v_cvt_pk_bf16_f32 v132, v112, v113
  v_cvt_pk_bf16_f32 v133, v114, v115
  v_cvt_pk_bf16_f32 v134, v116, v117
  v_cvt_pk_bf16_f32 v135, v118, v119
  v_mfma_f32_32x32x16_bf16 v[104:119], v[140:143], v[194:197], v[40:55]
  ds_read_b128 v[140:143], v1 offset:46080
  v_exp_f32 v88, v88
  v_exp_f32 v89, v89
  v_exp_f32 v90, v90
  v_exp_f32 v91, v91
  v_mfma_f32_32x32x16_bf16 v[72:87], v[148:151], v[132:135], v[72:87]
  ds_read_b128 v[144:147], v161 offset:4096
  ds_read_b128 v[148:151], v161 offset:4608
  v_exp_f32 v92, v92
  v_exp_f32 v93, v93
  v_exp_f32 v94, v94
  v_exp_f32 v95, v95
  v_exp_f32 v96, v96
  v_cvt_pk_bf16_f32 v120, v88, v89
  v_cvt_pk_bf16_f32 v121, v90, v91
  v_cvt_pk_bf16_f32 v122, v92, v93
  v_cvt_pk_bf16_f32 v123, v94, v95
  v_exp_f32 v97, v97
  v_exp_f32 v98, v98
  v_exp_f32 v99, v99
  v_mfma_f32_32x32x16_bf16 v[56:71], v[152:155], v[120:123], v[56:71]
  buffer_load_dwordx4 a[240:243], v8, s[4:7], s26 offen offset:1024 sc1
  v_exp_f32 v100, v100
  v_exp_f32 v101, v101
  v_exp_f32 v102, v102
  v_exp_f32 v103, v103
  v_cvt_pk_bf16_f32 v124, v96, v97
  v_cvt_pk_bf16_f32 v125, v98, v99
  v_cvt_pk_bf16_f32 v126, v100, v101
  v_cvt_pk_bf16_f32 v127, v102, v103
  v_mfma_f32_32x32x16_bf16 v[88:103], v[136:139], v[190:193], v[24:39]
  v_exp_f32 v104, v104
  v_exp_f32 v105, v105
  v_exp_f32 v106, v106
  v_exp_f32 v107, v107
  v_mfma_f32_32x32x16_bf16 v[56:71], v[156:159], v[124:127], v[56:71]
  buffer_load_dwordx4 a[244:247], v8, s[4:7], s27 offen offset:1024 sc1
  v_exp_f32 v108, v108
  v_exp_f32 v109, v109
  v_exp_f32 v110, v110
  v_exp_f32 v111, v111
  v_exp_f32 v112, v112
  v_cvt_pk_bf16_f32 v128, v104, v105
  v_cvt_pk_bf16_f32 v129, v106, v107
  v_cvt_pk_bf16_f32 v130, v108, v109
  v_cvt_pk_bf16_f32 v131, v110, v111
  v_exp_f32 v113, v113
  v_exp_f32 v114, v114
  v_exp_f32 v115, v115
  v_mfma_f32_32x32x16_bf16 v[72:87], v[152:155], v[128:131], v[72:87]
  s_waitcnt lgkmcnt(0)
  v_exp_f32 v116, v116
  v_exp_f32 v117, v117
  v_exp_f32 v118, v118
  v_exp_f32 v119, v119
  v_add_u32 v161, v162, v161
  v_cvt_pk_bf16_f32 v132, v112, v113
  v_cvt_pk_bf16_f32 v133, v114, v115
  v_cvt_pk_bf16_f32 v134, v116, v117
  v_cvt_pk_bf16_f32 v135, v118, v119
  v_mfma_f32_32x32x16_bf16 v[104:119], v[136:139], v[194:197], v[40:55]
  ds_read_b128 v[136:139], v1 offset:47104
  v_exp_f32 v88, v88
  v_exp_f32 v89, v89
  v_exp_f32 v90, v90
  v_exp_f32 v91, v91
  v_mfma_f32_32x32x16_bf16 v[72:87], v[156:159], v[132:135], v[72:87]
  ds_read_b128 v[152:155], v161 offset:1024
  ds_read_b128 v[156:159], v161 offset:1536
  v_exp_f32 v92, v92
  v_exp_f32 v93, v93
  v_exp_f32 v94, v94
  v_exp_f32 v95, v95
  v_exp_f32 v96, v96
  v_cvt_pk_bf16_f32 v120, v88, v89
  v_cvt_pk_bf16_f32 v121, v90, v91
  v_cvt_pk_bf16_f32 v122, v92, v93
  v_cvt_pk_bf16_f32 v123, v94, v95
  v_exp_f32 v97, v97
  v_exp_f32 v98, v98
  v_exp_f32 v99, v99
  v_mfma_f32_32x32x16_bf16 v[56:71], v[144:147], v[120:123], v[56:71]
  buffer_load_dwordx4 a[248:251], v10, s[4:7], s26 offen offset:0 sc1
  v_exp_f32 v100, v100
  v_exp_f32 v101, v101
  v_exp_f32 v102, v102
  v_exp_f32 v103, v103
  v_cvt_pk_bf16_f32 v124, v96, v97
  v_cvt_pk_bf16_f32 v125, v98, v99
  v_cvt_pk_bf16_f32 v126, v100, v101
  v_cvt_pk_bf16_f32 v127, v102, v103
  v_mfma_f32_32x32x16_bf16 v[88:103], v[140:143], v[190:193], v[24:39]
  v_exp_f32 v104, v104
  v_exp_f32 v105, v105
  v_exp_f32 v106, v106
  v_exp_f32 v107, v107
  v_mfma_f32_32x32x16_bf16 v[56:71], v[148:151], v[124:127], v[56:71]
  buffer_load_dwordx4 a[252:255], v10, s[4:7], s27 offen offset:0 sc1
  v_exp_f32 v108, v108
  v_exp_f32 v109, v109
  v_exp_f32 v110, v110
  v_exp_f32 v111, v111
  v_exp_f32 v112, v112
  v_cvt_pk_bf16_f32 v128, v104, v105
  v_cvt_pk_bf16_f32 v129, v106, v107
  v_cvt_pk_bf16_f32 v130, v108, v109
  v_cvt_pk_bf16_f32 v131, v110, v111
  v_exp_f32 v113, v113
  v_exp_f32 v114, v114
  v_exp_f32 v115, v115
  v_mfma_f32_32x32x16_bf16 v[72:87], v[144:147], v[128:131], v[72:87]
  s_waitcnt lgkmcnt(0)
  v_exp_f32 v116, v116
  v_exp_f32 v117, v117
  v_exp_f32 v118, v118
  v_exp_f32 v119, v119
  v_cvt_pk_bf16_f32 v132, v112, v113
  v_cvt_pk_bf16_f32 v133, v114, v115
  v_cvt_pk_bf16_f32 v134, v116, v117
  v_cvt_pk_bf16_f32 v135, v118, v119
  v_mfma_f32_32x32x16_bf16 v[104:119], v[140:143], v[194:197], v[40:55]
  ds_read_b128 v[140:143], v1 offset:48128
  v_exp_f32 v88, v88
  v_exp_f32 v89, v89
  v_exp_f32 v90, v90
  v_exp_f32 v91, v91
  v_mfma_f32_32x32x16_bf16 v[72:87], v[148:151], v[132:135], v[72:87]
  ds_read_b128 v[144:147], v161 offset:2048
  ds_read_b128 v[148:151], v161 offset:2560
  v_exp_f32 v92, v92
  v_exp_f32 v93, v93
  v_exp_f32 v94, v94
  v_exp_f32 v95, v95
  v_exp_f32 v96, v96
  v_cvt_pk_bf16_f32 v120, v88, v89
  v_cvt_pk_bf16_f32 v121, v90, v91
  v_cvt_pk_bf16_f32 v122, v92, v93
  v_cvt_pk_bf16_f32 v123, v94, v95
  v_exp_f32 v97, v97
  v_exp_f32 v98, v98
  v_exp_f32 v99, v99
  v_mfma_f32_32x32x16_bf16 v[56:71], v[152:155], v[120:123], v[56:71]
  buffer_load_dwordx4 v[200:203], v5, s[4:7], s26 offen offset:0 sc1
  v_exp_f32 v100, v100
  v_exp_f32 v101, v101
  v_exp_f32 v102, v102
  v_exp_f32 v103, v103
  v_cvt_pk_bf16_f32 v124, v96, v97
  v_cvt_pk_bf16_f32 v125, v98, v99
  v_cvt_pk_bf16_f32 v126, v100, v101
  v_cvt_pk_bf16_f32 v127, v102, v103
  v_mfma_f32_32x32x16_bf16 v[88:103], v[136:139], v[190:193], v[24:39]
  v_exp_f32 v104, v104
  v_exp_f32 v105, v105
  v_exp_f32 v106, v106
  v_exp_f32 v107, v107
  v_mfma_f32_32x32x16_bf16 v[56:71], v[156:159], v[124:127], v[56:71]
  buffer_load_dwordx4 v[204:207], v5, s[4:7], s27 offen offset:0 sc1
  v_exp_f32 v108, v108
  v_exp_f32 v109, v109
  v_exp_f32 v110, v110
  v_exp_f32 v111, v111
  v_exp_f32 v112, v112
  v_cvt_pk_bf16_f32 v128, v104, v105
  v_cvt_pk_bf16_f32 v129, v106, v107
  v_cvt_pk_bf16_f32 v130, v108, v109
  v_cvt_pk_bf16_f32 v131, v110, v111
  v_exp_f32 v113, v113
  v_exp_f32 v114, v114
  v_exp_f32 v115, v115
  v_mfma_f32_32x32x16_bf16 v[72:87], v[152:155], v[128:131], v[72:87]
  s_waitcnt lgkmcnt(0)
  v_exp_f32 v116, v116
  v_exp_f32 v117, v117
  v_exp_f32 v118, v118
  v_exp_f32 v119, v119
  v_cvt_pk_bf16_f32 v132, v112, v113
  v_cvt_pk_bf16_f32 v133, v114, v115
  v_cvt_pk_bf16_f32 v134, v116, v117
  v_cvt_pk_bf16_f32 v135, v118, v119
  v_mfma_f32_32x32x16_bf16 v[104:119], v[136:139], v[194:197], v[40:55]
  ds_read_b128 v[136:139], v1 offset:49152
  v_exp_f32 v88, v88
  v_exp_f32 v89, v89
  v_exp_f32 v90, v90
  v_exp_f32 v91, v91
  v_mfma_f32_32x32x16_bf16 v[72:87], v[156:159], v[132:135], v[72:87]
  ds_read_b128 v[152:155], v161 offset:3072
  ds_read_b128 v[156:159], v161 offset:3584
  v_exp_f32 v92, v92
  v_exp_f32 v93, v93
  v_exp_f32 v94, v94
  v_exp_f32 v95, v95
  v_exp_f32 v96, v96
  v_cvt_pk_bf16_f32 v120, v88, v89
  v_cvt_pk_bf16_f32 v121, v90, v91
  v_cvt_pk_bf16_f32 v122, v92, v93
  v_cvt_pk_bf16_f32 v123, v94, v95
  v_exp_f32 v97, v97
  v_exp_f32 v98, v98
  v_exp_f32 v99, v99
  v_mfma_f32_32x32x16_bf16 v[56:71], v[144:147], v[120:123], v[56:71]
  buffer_load_dwordx4 v[208:211], v6, s[4:7], s26 offen offset:3072 sc1
  v_exp_f32 v100, v100
  v_exp_f32 v101, v101
  v_exp_f32 v102, v102
  v_exp_f32 v103, v103
  v_cvt_pk_bf16_f32 v124, v96, v97
  v_cvt_pk_bf16_f32 v125, v98, v99
  v_cvt_pk_bf16_f32 v126, v100, v101
  v_cvt_pk_bf16_f32 v127, v102, v103
  v_mfma_f32_32x32x16_bf16 v[88:103], v[140:143], v[190:193], v[24:39]
  v_exp_f32 v104, v104
  v_exp_f32 v105, v105
  v_exp_f32 v106, v106
  v_exp_f32 v107, v107
  v_mfma_f32_32x32x16_bf16 v[56:71], v[148:151], v[124:127], v[56:71]
  buffer_load_dwordx4 v[212:215], v6, s[4:7], s27 offen offset:3072 sc1
  v_exp_f32 v108, v108
  v_exp_f32 v109, v109
  v_exp_f32 v110, v110
  v_exp_f32 v111, v111
  v_exp_f32 v112, v112
  v_cvt_pk_bf16_f32 v128, v104, v105
  v_cvt_pk_bf16_f32 v129, v106, v107
  v_cvt_pk_bf16_f32 v130, v108, v109
  v_cvt_pk_bf16_f32 v131, v110, v111
  v_exp_f32 v113, v113
  v_exp_f32 v114, v114
  v_exp_f32 v115, v115
  v_mfma_f32_32x32x16_bf16 v[72:87], v[144:147], v[128:131], v[72:87]
  s_waitcnt lgkmcnt(0)
  v_exp_f32 v116, v116
  v_exp_f32 v117, v117
  v_exp_f32 v118, v118
  v_exp_f32 v119, v119
  v_cvt_pk_bf16_f32 v132, v112, v113
  v_cvt_pk_bf16_f32 v133, v114, v115
  v_cvt_pk_bf16_f32 v134, v116, v117
  v_cvt_pk_bf16_f32 v135, v118, v119
  v_mfma_f32_32x32x16_bf16 v[104:119], v[140:143], v[194:197], v[40:55]
  ds_read_b128 v[140:143], v1 offset:50176
  v_exp_f32 v88, v88
  v_exp_f32 v89, v89
  v_exp_f32 v90, v90
  v_exp_f32 v91, v91
  v_mfma_f32_32x32x16_bf16 v[72:87], v[148:151], v[132:135], v[72:87]
  ds_read_b128 v[144:147], v161 offset:4096
  ds_read_b128 v[148:151], v161 offset:4608
  v_exp_f32 v92, v92
  v_exp_f32 v93, v93
  v_exp_f32 v94, v94
  v_exp_f32 v95, v95
  v_exp_f32 v96, v96
  v_cvt_pk_bf16_f32 v120, v88, v89
  v_cvt_pk_bf16_f32 v121, v90, v91
  v_cvt_pk_bf16_f32 v122, v92, v93
  v_cvt_pk_bf16_f32 v123, v94, v95
  v_exp_f32 v97, v97
  v_exp_f32 v98, v98
  v_exp_f32 v99, v99
  v_mfma_f32_32x32x16_bf16 v[56:71], v[152:155], v[120:123], v[56:71]
  buffer_load_dwordx4 v[216:219], v8, s[4:7], s26 offen offset:2048 sc1
  v_exp_f32 v100, v100
  v_exp_f32 v101, v101
  v_exp_f32 v102, v102
  v_exp_f32 v103, v103
  v_cvt_pk_bf16_f32 v124, v96, v97
  v_cvt_pk_bf16_f32 v125, v98, v99
  v_cvt_pk_bf16_f32 v126, v100, v101
  v_cvt_pk_bf16_f32 v127, v102, v103
  v_mfma_f32_32x32x16_bf16 v[88:103], v[136:139], v[190:193], v[24:39]
  v_exp_f32 v104, v104
  v_exp_f32 v105, v105
  v_exp_f32 v106, v106
  v_exp_f32 v107, v107
  v_mfma_f32_32x32x16_bf16 v[56:71], v[156:159], v[124:127], v[56:71]
  buffer_load_dwordx4 v[220:223], v8, s[4:7], s27 offen offset:2048 sc1
  v_exp_f32 v108, v108
  v_exp_f32 v109, v109
  v_exp_f32 v110, v110
  v_exp_f32 v111, v111
  v_exp_f32 v112, v112
  v_cvt_pk_bf16_f32 v128, v104, v105
  v_cvt_pk_bf16_f32 v129, v106, v107
  v_cvt_pk_bf16_f32 v130, v108, v109
  v_cvt_pk_bf16_f32 v131, v110, v111
  v_exp_f32 v113, v113
  v_exp_f32 v114, v114
  v_exp_f32 v115, v115
  v_mfma_f32_32x32x16_bf16 v[72:87], v[152:155], v[128:131], v[72:87]
  s_waitcnt lgkmcnt(0)
  v_exp_f32 v116, v116
  v_exp_f32 v117, v117
  v_exp_f32 v118, v118
  v_exp_f32 v119, v119
  v_add_u32 v161, v162, v161
  v_cvt_pk_bf16_f32 v132, v112, v113
  v_cvt_pk_bf16_f32 v133, v114, v115
  v_cvt_pk_bf16_f32 v134, v116, v117
  v_cvt_pk_bf16_f32 v135, v118, v119
  v_mfma_f32_32x32x16_bf16 v[104:119], v[136:139], v[194:197], v[40:55]
  ds_read_b128 v[136:139], v1 offset:51200
  v_exp_f32 v88, v88
  v_exp_f32 v89, v89
  v_exp_f32 v90, v90
  v_exp_f32 v91, v91
  v_mfma_f32_32x32x16_bf16 v[72:87], v[156:159], v[132:135], v[72:87]
  ds_read_b128 v[152:155], v161 offset:1024
  ds_read_b128 v[156:159], v161 offset:1536
  v_exp_f32 v92, v92
  v_exp_f32 v93, v93
  v_exp_f32 v94, v94
  v_exp_f32 v95, v95
  v_exp_f32 v96, v96
  v_cvt_pk_bf16_f32 v120, v88, v89
  v_cvt_pk_bf16_f32 v121, v90, v91
  v_cvt_pk_bf16_f32 v122, v92, v93
  v_cvt_pk_bf16_f32 v123, v94, v95
  v_exp_f32 v97, v97
  v_exp_f32 v98, v98
  v_exp_f32 v99, v99
  v_mfma_f32_32x32x16_bf16 v[56:71], v[144:147], v[120:123], v[56:71]
  buffer_load_dwordx4 v[224:227], v10, s[4:7], s26 offen offset:1024 sc1
  v_exp_f32 v100, v100
  v_exp_f32 v101, v101
  v_exp_f32 v102, v102
  v_exp_f32 v103, v103
  v_cvt_pk_bf16_f32 v124, v96, v97
  v_cvt_pk_bf16_f32 v125, v98, v99
  v_cvt_pk_bf16_f32 v126, v100, v101
  v_cvt_pk_bf16_f32 v127, v102, v103
  v_mfma_f32_32x32x16_bf16 v[88:103], v[140:143], v[190:193], v[24:39]
  v_exp_f32 v104, v104
  v_exp_f32 v105, v105
  v_exp_f32 v106, v106
  v_exp_f32 v107, v107
  v_mfma_f32_32x32x16_bf16 v[56:71], v[148:151], v[124:127], v[56:71]
  buffer_load_dwordx4 v[228:231], v10, s[4:7], s27 offen offset:1024 sc1
  v_exp_f32 v108, v108
  v_exp_f32 v109, v109
  v_exp_f32 v110, v110
  v_exp_f32 v111, v111
  v_exp_f32 v112, v112
  v_cvt_pk_bf16_f32 v128, v104, v105
  v_cvt_pk_bf16_f32 v129, v106, v107
  v_cvt_pk_bf16_f32 v130, v108, v109
  v_cvt_pk_bf16_f32 v131, v110, v111
  v_exp_f32 v113, v113
  v_exp_f32 v114, v114
  v_exp_f32 v115, v115
  v_mfma_f32_32x32x16_bf16 v[72:87], v[144:147], v[128:131], v[72:87]
  s_waitcnt lgkmcnt(0)
  v_exp_f32 v116, v116
  v_exp_f32 v117, v117
  v_exp_f32 v118, v118
  v_exp_f32 v119, v119
  v_cvt_pk_bf16_f32 v132, v112, v113
  v_cvt_pk_bf16_f32 v133, v114, v115
  v_cvt_pk_bf16_f32 v134, v116, v117
  v_cvt_pk_bf16_f32 v135, v118, v119
  v_mfma_f32_32x32x16_bf16 v[104:119], v[140:143], v[194:197], v[40:55]
  ds_read_b128 v[140:143], v1 offset:52224
  v_exp_f32 v88, v88
  v_exp_f32 v89, v89
  v_exp_f32 v90, v90
  v_exp_f32 v91, v91
  v_mfma_f32_32x32x16_bf16 v[72:87], v[148:151], v[132:135], v[72:87]
  ds_read_b128 v[144:147], v161 offset:2048
  ds_read_b128 v[148:151], v161 offset:2560
  v_exp_f32 v92, v92
  v_exp_f32 v93, v93
  v_exp_f32 v94, v94
  v_exp_f32 v95, v95
  v_exp_f32 v96, v96
  v_cvt_pk_bf16_f32 v120, v88, v89
  v_cvt_pk_bf16_f32 v121, v90, v91
  v_cvt_pk_bf16_f32 v122, v92, v93
  v_cvt_pk_bf16_f32 v123, v94, v95
  v_exp_f32 v97, v97
  v_exp_f32 v98, v98
  v_exp_f32 v99, v99
  v_mfma_f32_32x32x16_bf16 v[56:71], v[152:155], v[120:123], v[56:71]
  buffer_load_dwordx4 v[232:235], v5, s[4:7], s26 offen offset:1024 sc1
  v_exp_f32 v100, v100
  v_exp_f32 v101, v101
  v_exp_f32 v102, v102
  v_exp_f32 v103, v103
  v_cvt_pk_bf16_f32 v124, v96, v97
  v_cvt_pk_bf16_f32 v125, v98, v99
  v_cvt_pk_bf16_f32 v126, v100, v101
  v_cvt_pk_bf16_f32 v127, v102, v103
  v_mfma_f32_32x32x16_bf16 v[88:103], v[136:139], v[190:193], v[24:39]
  v_exp_f32 v104, v104
  v_exp_f32 v105, v105
  v_exp_f32 v106, v106
  v_exp_f32 v107, v107
  v_mfma_f32_32x32x16_bf16 v[56:71], v[156:159], v[124:127], v[56:71]
  buffer_load_dwordx4 v[236:239], v5, s[4:7], s27 offen offset:1024 sc1
  v_exp_f32 v108, v108
  v_exp_f32 v109, v109
  v_exp_f32 v110, v110
  v_exp_f32 v111, v111
  v_exp_f32 v112, v112
  v_cvt_pk_bf16_f32 v128, v104, v105
  v_cvt_pk_bf16_f32 v129, v106, v107
  v_cvt_pk_bf16_f32 v130, v108, v109
  v_cvt_pk_bf16_f32 v131, v110, v111
  v_exp_f32 v113, v113
  v_exp_f32 v114, v114
  v_exp_f32 v115, v115
  v_mfma_f32_32x32x16_bf16 v[72:87], v[152:155], v[128:131], v[72:87]
  s_waitcnt lgkmcnt(0)
  v_exp_f32 v116, v116
  v_exp_f32 v117, v117
  v_exp_f32 v118, v118
  v_exp_f32 v119, v119
  v_cvt_pk_bf16_f32 v132, v112, v113
  v_cvt_pk_bf16_f32 v133, v114, v115
  v_cvt_pk_bf16_f32 v134, v116, v117
  v_cvt_pk_bf16_f32 v135, v118, v119
  v_mfma_f32_32x32x16_bf16 v[104:119], v[136:139], v[194:197], v[40:55]
  ds_read_b128 v[136:139], v1 offset:53248
  v_exp_f32 v88, v88
  v_exp_f32 v89, v89
  v_exp_f32 v90, v90
  v_exp_f32 v91, v91
  v_mfma_f32_32x32x16_bf16 v[72:87], v[156:159], v[132:135], v[72:87]
  ds_read_b128 v[152:155], v161 offset:3072
  ds_read_b128 v[156:159], v161 offset:3584
  v_exp_f32 v92, v92
  v_exp_f32 v93, v93
  v_exp_f32 v94, v94
  v_exp_f32 v95, v95
  v_exp_f32 v96, v96
  v_cvt_pk_bf16_f32 v120, v88, v89
  v_cvt_pk_bf16_f32 v121, v90, v91
  v_cvt_pk_bf16_f32 v122, v92, v93
  v_cvt_pk_bf16_f32 v123, v94, v95
  v_exp_f32 v97, v97
  v_exp_f32 v98, v98
  v_exp_f32 v99, v99
  v_mfma_f32_32x32x16_bf16 v[56:71], v[144:147], v[120:123], v[56:71]
  buffer_load_dwordx4 v[240:243], v7, s[4:7], s26 offen offset:0 sc1
  v_exp_f32 v100, v100
  v_exp_f32 v101, v101
  v_exp_f32 v102, v102
  v_exp_f32 v103, v103
  v_cvt_pk_bf16_f32 v124, v96, v97
  v_cvt_pk_bf16_f32 v125, v98, v99
  v_cvt_pk_bf16_f32 v126, v100, v101
  v_cvt_pk_bf16_f32 v127, v102, v103
  v_mfma_f32_32x32x16_bf16 v[88:103], v[140:143], v[190:193], v[24:39]
  v_exp_f32 v104, v104
  v_exp_f32 v105, v105
  v_exp_f32 v106, v106
  v_exp_f32 v107, v107
  v_mfma_f32_32x32x16_bf16 v[56:71], v[148:151], v[124:127], v[56:71]
  s_add_u32 s17, s49, 0
  buffer_load_dword v167, v166, s[4:7], s17 offen sc1
  v_exp_f32 v108, v108
  v_exp_f32 v109, v109
  v_exp_f32 v110, v110
  v_exp_f32 v111, v111
  v_exp_f32 v112, v112
  v_cvt_pk_bf16_f32 v128, v104, v105
  v_cvt_pk_bf16_f32 v129, v106, v107
  v_cvt_pk_bf16_f32 v130, v108, v109
  v_cvt_pk_bf16_f32 v131, v110, v111
  v_exp_f32 v113, v113
  v_exp_f32 v114, v114
  v_exp_f32 v115, v115
  v_mfma_f32_32x32x16_bf16 v[72:87], v[144:147], v[128:131], v[72:87]
  s_waitcnt lgkmcnt(0)
  v_exp_f32 v116, v116
  v_exp_f32 v117, v117
  v_exp_f32 v118, v118
  v_exp_f32 v119, v119
  v_cvt_pk_bf16_f32 v132, v112, v113
  v_cvt_pk_bf16_f32 v133, v114, v115
  v_cvt_pk_bf16_f32 v134, v116, v117
  v_cvt_pk_bf16_f32 v135, v118, v119
  v_mfma_f32_32x32x16_bf16 v[104:119], v[140:143], v[194:197], v[40:55]
  ds_read_b128 v[140:143], v1 offset:54272
  v_exp_f32 v88, v88
  v_exp_f32 v89, v89
  v_exp_f32 v90, v90
  v_exp_f32 v91, v91
  v_mfma_f32_32x32x16_bf16 v[72:87], v[148:151], v[132:135], v[72:87]
  ds_read_b128 v[144:147], v161 offset:4096
  ds_read_b128 v[148:151], v161 offset:4608
  v_exp_f32 v92, v92
  v_exp_f32 v93, v93
  v_exp_f32 v94, v94
  v_exp_f32 v95, v95
  v_exp_f32 v96, v96
  v_cvt_pk_bf16_f32 v120, v88, v89
  v_cvt_pk_bf16_f32 v121, v90, v91
  v_cvt_pk_bf16_f32 v122, v92, v93
  v_cvt_pk_bf16_f32 v123, v94, v95
  v_exp_f32 v97, v97
  v_exp_f32 v98, v98
  v_exp_f32 v99, v99
  v_mfma_f32_32x32x16_bf16 v[56:71], v[152:155], v[120:123], v[56:71]
  buffer_load_dwordx4 v[244:247], v7, s[4:7], s27 offen offset:0 sc1
  v_exp_f32 v100, v100
  v_exp_f32 v101, v101
  v_exp_f32 v102, v102
  v_exp_f32 v103, v103
  v_cvt_pk_bf16_f32 v124, v96, v97
  v_cvt_pk_bf16_f32 v125, v98, v99
  v_cvt_pk_bf16_f32 v126, v100, v101
  v_cvt_pk_bf16_f32 v127, v102, v103
  v_mfma_f32_32x32x16_bf16 v[88:103], v[136:139], v[190:193], v[24:39]
  v_exp_f32 v104, v104
  v_exp_f32 v105, v105
  v_exp_f32 v106, v106
  v_exp_f32 v107, v107
  v_mfma_f32_32x32x16_bf16 v[56:71], v[156:159], v[124:127], v[56:71]
  buffer_load_dwordx4 v[248:251], v8, s[4:7], s26 offen offset:3072 sc1
  v_exp_f32 v108, v108
  v_exp_f32 v109, v109
  v_exp_f32 v110, v110
  v_exp_f32 v111, v111
  v_exp_f32 v112, v112
  v_cvt_pk_bf16_f32 v128, v104, v105
  v_cvt_pk_bf16_f32 v129, v106, v107
  v_cvt_pk_bf16_f32 v130, v108, v109
  v_cvt_pk_bf16_f32 v131, v110, v111
  v_exp_f32 v113, v113
  v_exp_f32 v114, v114
  v_exp_f32 v115, v115
  v_mfma_f32_32x32x16_bf16 v[72:87], v[152:155], v[128:131], v[72:87]
  s_waitcnt lgkmcnt(0)
  v_exp_f32 v116, v116
  v_exp_f32 v117, v117
  v_exp_f32 v118, v118
  v_exp_f32 v119, v119
  v_add_u32 v161, v162, v161
  v_cvt_pk_bf16_f32 v132, v112, v113
  v_cvt_pk_bf16_f32 v133, v114, v115
  v_cvt_pk_bf16_f32 v134, v116, v117
  v_cvt_pk_bf16_f32 v135, v118, v119
  v_mfma_f32_32x32x16_bf16 v[104:119], v[136:139], v[194:197], v[40:55]
  ds_read_b128 v[136:139], v1 offset:55296
  v_exp_f32 v88, v88
  v_exp_f32 v89, v89
  v_exp_f32 v90, v90
  v_exp_f32 v91, v91
  v_mfma_f32_32x32x16_bf16 v[72:87], v[156:159], v[132:135], v[72:87]
  ds_read_b128 v[152:155], v161 offset:1024
  ds_read_b128 v[156:159], v161 offset:1536
  v_exp_f32 v92, v92
  v_exp_f32 v93, v93
  v_exp_f32 v94, v94
  v_exp_f32 v95, v95
  v_exp_f32 v96, v96
  v_cvt_pk_bf16_f32 v120, v88, v89
  v_cvt_pk_bf16_f32 v121, v90, v91
  v_cvt_pk_bf16_f32 v122, v92, v93
  v_cvt_pk_bf16_f32 v123, v94, v95
  v_exp_f32 v97, v97
  v_exp_f32 v98, v98
  v_exp_f32 v99, v99
  v_mfma_f32_32x32x16_bf16 v[56:71], v[144:147], v[120:123], v[56:71]
  buffer_load_dwordx4 v[252:255], v8, s[4:7], s27 offen offset:3072 sc1
  v_exp_f32 v100, v100
  v_exp_f32 v101, v101
  v_exp_f32 v102, v102
  v_exp_f32 v103, v103
  v_cvt_pk_bf16_f32 v124, v96, v97
  v_cvt_pk_bf16_f32 v125, v98, v99
  v_cvt_pk_bf16_f32 v126, v100, v101
  v_cvt_pk_bf16_f32 v127, v102, v103
  v_mfma_f32_32x32x16_bf16 v[88:103], v[140:143], v[190:193], v[24:39]
  v_exp_f32 v104, v104
  v_exp_f32 v105, v105
  v_exp_f32 v106, v106
  v_exp_f32 v107, v107
  v_mfma_f32_32x32x16_bf16 v[56:71], v[148:151], v[124:127], v[56:71]
  s_add_u32 s17, s49, 4096
  buffer_load_dword v167, v166, s[4:7], s17 offen sc1
  v_exp_f32 v108, v108
  v_exp_f32 v109, v109
  v_exp_f32 v110, v110
  v_exp_f32 v111, v111
  v_exp_f32 v112, v112
  v_cvt_pk_bf16_f32 v128, v104, v105
  v_cvt_pk_bf16_f32 v129, v106, v107
  v_cvt_pk_bf16_f32 v130, v108, v109
  v_cvt_pk_bf16_f32 v131, v110, v111
  v_exp_f32 v113, v113
  v_exp_f32 v114, v114
  v_exp_f32 v115, v115
  v_mfma_f32_32x32x16_bf16 v[72:87], v[144:147], v[128:131], v[72:87]
  s_waitcnt lgkmcnt(0)
  v_exp_f32 v116, v116
  v_exp_f32 v117, v117
  v_exp_f32 v118, v118
  v_exp_f32 v119, v119
  v_cvt_pk_bf16_f32 v132, v112, v113
  v_cvt_pk_bf16_f32 v133, v114, v115
  v_cvt_pk_bf16_f32 v134, v116, v117
  v_cvt_pk_bf16_f32 v135, v118, v119
  v_mfma_f32_32x32x16_bf16 v[104:119], v[140:143], v[194:197], v[40:55]
  ds_read_b128 v[140:143], v1 offset:56320
  v_exp_f32 v88, v88
  v_exp_f32 v89, v89
  v_exp_f32 v90, v90
  v_exp_f32 v91, v91
  v_mfma_f32_32x32x16_bf16 v[72:87], v[148:151], v[132:135], v[72:87]
  ds_read_b128 v[144:147], v161 offset:2048
  ds_read_b128 v[148:151], v161 offset:2560
  v_exp_f32 v92, v92
  v_exp_f32 v93, v93
  v_exp_f32 v94, v94
  v_exp_f32 v95, v95
  v_exp_f32 v96, v96
  v_cvt_pk_bf16_f32 v120, v88, v89
  v_cvt_pk_bf16_f32 v121, v90, v91
  v_cvt_pk_bf16_f32 v122, v92, v93
  v_cvt_pk_bf16_f32 v123, v94, v95
  v_exp_f32 v97, v97
  v_exp_f32 v98, v98
  v_exp_f32 v99, v99
  v_mfma_f32_32x32x16_bf16 v[56:71], v[152:155], v[120:123], v[56:71]
  v_exp_f32 v100, v100
  v_exp_f32 v101, v101
  v_exp_f32 v102, v102
  v_exp_f32 v103, v103
  v_cvt_pk_bf16_f32 v124, v96, v97
  v_cvt_pk_bf16_f32 v125, v98, v99
  v_cvt_pk_bf16_f32 v126, v100, v101
  v_cvt_pk_bf16_f32 v127, v102, v103
  v_mfma_f32_32x32x16_bf16 v[88:103], v[136:139], v[190:193], v[24:39]
  v_exp_f32 v104, v104
  v_exp_f32 v105, v105
  v_exp_f32 v106, v106
  v_exp_f32 v107, v107
  v_mfma_f32_32x32x16_bf16 v[56:71], v[156:159], v[124:127], v[56:71]
  v_exp_f32 v108, v108
  v_exp_f32 v109, v109
  v_exp_f32 v110, v110
  v_exp_f32 v111, v111
  v_exp_f32 v112, v112
  v_cvt_pk_bf16_f32 v128, v104, v105
  v_cvt_pk_bf16_f32 v129, v106, v107
  v_cvt_pk_bf16_f32 v130, v108, v109
  v_cvt_pk_bf16_f32 v131, v110, v111
  v_exp_f32 v113, v113
  v_exp_f32 v114, v114
  v_exp_f32 v115, v115
  v_mfma_f32_32x32x16_bf16 v[72:87], v[152:155], v[128:131], v[72:87]
  s_waitcnt lgkmcnt(0)
  v_exp_f32 v116, v116
  v_exp_f32 v117, v117
  v_exp_f32 v118, v118
  v_exp_f32 v119, v119
  v_cvt_pk_bf16_f32 v132, v112, v113
  v_cvt_pk_bf16_f32 v133, v114, v115
  v_cvt_pk_bf16_f32 v134, v116, v117
  v_cvt_pk_bf16_f32 v135, v118, v119
  v_mfma_f32_32x32x16_bf16 v[104:119], v[136:139], v[194:197], v[40:55]
  ds_read_b128 v[136:139], v1 offset:57344
  v_exp_f32 v88, v88
  v_exp_f32 v89, v89
  v_exp_f32 v90, v90
  v_exp_f32 v91, v91
  v_mfma_f32_32x32x16_bf16 v[72:87], v[156:159], v[132:135], v[72:87]
  ds_read_b128 v[152:155], v161 offset:3072
  ds_read_b128 v[156:159], v161 offset:3584
  v_exp_f32 v92, v92
  v_exp_f32 v93, v93
  v_exp_f32 v94, v94
  v_exp_f32 v95, v95
  v_exp_f32 v96, v96
  v_cvt_pk_bf16_f32 v120, v88, v89
  v_cvt_pk_bf16_f32 v121, v90, v91
  v_cvt_pk_bf16_f32 v122, v92, v93
  v_cvt_pk_bf16_f32 v123, v94, v95
  v_exp_f32 v97, v97
  v_exp_f32 v98, v98
  v_exp_f32 v99, v99
  v_mfma_f32_32x32x16_bf16 v[56:71], v[144:147], v[120:123], v[56:71]
  v_exp_f32 v100, v100
  v_exp_f32 v101, v101
  v_exp_f32 v102, v102
  v_exp_f32 v103, v103
  v_cvt_pk_bf16_f32 v124, v96, v97
  v_cvt_pk_bf16_f32 v125, v98, v99
  v_cvt_pk_bf16_f32 v126, v100, v101
  v_cvt_pk_bf16_f32 v127, v102, v103
  v_mfma_f32_32x32x16_bf16 v[88:103], v[140:143], v[190:193], v[24:39]
  v_exp_f32 v104, v104
  v_exp_f32 v105, v105
  v_exp_f32 v106, v106
  v_exp_f32 v107, v107
  v_mfma_f32_32x32x16_bf16 v[56:71], v[148:151], v[124:127], v[56:71]
  s_add_u32 s17, s49, 8192
  buffer_load_dword v167, v166, s[4:7], s17 offen sc1
  v_exp_f32 v108, v108
  v_exp_f32 v109, v109
  v_exp_f32 v110, v110
  v_exp_f32 v111, v111
  v_exp_f32 v112, v112
  v_cvt_pk_bf16_f32 v128, v104, v105
  v_cvt_pk_bf16_f32 v129, v106, v107
  v_cvt_pk_bf16_f32 v130, v108, v109
  v_cvt_pk_bf16_f32 v131, v110, v111
  v_exp_f32 v113, v113
  v_exp_f32 v114, v114
  v_exp_f32 v115, v115
  v_mfma_f32_32x32x16_bf16 v[72:87], v[144:147], v[128:131], v[72:87]
  s_waitcnt lgkmcnt(0)
  v_exp_f32 v116, v116
  v_exp_f32 v117, v117
  v_exp_f32 v118, v118
  v_exp_f32 v119, v119
  v_cvt_pk_bf16_f32 v132, v112, v113
  v_cvt_pk_bf16_f32 v133, v114, v115
  v_cvt_pk_bf16_f32 v134, v116, v117
  v_cvt_pk_bf16_f32 v135, v118, v119
  v_mfma_f32_32x32x16_bf16 v[104:119], v[140:143], v[194:197], v[40:55]
  ds_read_b128 v[140:143], v1 offset:58368
  v_exp_f32 v88, v88
  v_exp_f32 v89, v89
  v_exp_f32 v90, v90
  v_exp_f32 v91, v91
  v_mfma_f32_32x32x16_bf16 v[72:87], v[148:151], v[132:135], v[72:87]
  ds_read_b128 v[144:147], v161 offset:4096
  ds_read_b128 v[148:151], v161 offset:4608
  v_exp_f32 v92, v92
  v_exp_f32 v93, v93
  v_exp_f32 v94, v94
  v_exp_f32 v95, v95
  v_exp_f32 v96, v96
  v_cvt_pk_bf16_f32 v120, v88, v89
  v_cvt_pk_bf16_f32 v121, v90, v91
  v_cvt_pk_bf16_f32 v122, v92, v93
  v_cvt_pk_bf16_f32 v123, v94, v95
  v_exp_f32 v97, v97
  v_exp_f32 v98, v98
  v_exp_f32 v99, v99
  v_mfma_f32_32x32x16_bf16 v[56:71], v[152:155], v[120:123], v[56:71]
  v_exp_f32 v100, v100
  v_exp_f32 v101, v101
  v_exp_f32 v102, v102
  v_exp_f32 v103, v103
  v_cvt_pk_bf16_f32 v124, v96, v97
  v_cvt_pk_bf16_f32 v125, v98, v99
  v_cvt_pk_bf16_f32 v126, v100, v101
  v_cvt_pk_bf16_f32 v127, v102, v103
  v_mfma_f32_32x32x16_bf16 v[88:103], v[136:139], v[190:193], v[24:39]
  v_exp_f32 v104, v104
  v_exp_f32 v105, v105
  v_exp_f32 v106, v106
  v_exp_f32 v107, v107
  v_mfma_f32_32x32x16_bf16 v[56:71], v[156:159], v[124:127], v[56:71]
  v_exp_f32 v108, v108
  v_exp_f32 v109, v109
  v_exp_f32 v110, v110
  v_exp_f32 v111, v111
  v_exp_f32 v112, v112
  v_cvt_pk_bf16_f32 v128, v104, v105
  v_cvt_pk_bf16_f32 v129, v106, v107
  v_cvt_pk_bf16_f32 v130, v108, v109
  v_cvt_pk_bf16_f32 v131, v110, v111
  v_exp_f32 v113, v113
  v_exp_f32 v114, v114
  v_exp_f32 v115, v115
  v_mfma_f32_32x32x16_bf16 v[72:87], v[152:155], v[128:131], v[72:87]
  s_waitcnt lgkmcnt(0)
  v_exp_f32 v116, v116
  v_exp_f32 v117, v117
  v_exp_f32 v118, v118
  v_exp_f32 v119, v119
  v_add_u32 v161, v162, v161
  v_cvt_pk_bf16_f32 v132, v112, v113
  v_cvt_pk_bf16_f32 v133, v114, v115
  v_cvt_pk_bf16_f32 v134, v116, v117
  v_cvt_pk_bf16_f32 v135, v118, v119
  v_mfma_f32_32x32x16_bf16 v[104:119], v[136:139], v[194:197], v[40:55]
  ds_read_b128 v[136:139], v1 offset:59392
  v_exp_f32 v88, v88
  v_exp_f32 v89, v89
  v_exp_f32 v90, v90
  v_exp_f32 v91, v91
  v_mfma_f32_32x32x16_bf16 v[72:87], v[156:159], v[132:135], v[72:87]
  ds_read_b128 v[152:155], v161 offset:1024
  ds_read_b128 v[156:159], v161 offset:1536
  v_exp_f32 v92, v92
  v_exp_f32 v93, v93
  v_exp_f32 v94, v94
  v_exp_f32 v95, v95
  v_exp_f32 v96, v96
  v_cvt_pk_bf16_f32 v120, v88, v89
  v_cvt_pk_bf16_f32 v121, v90, v91
  v_cvt_pk_bf16_f32 v122, v92, v93
  v_cvt_pk_bf16_f32 v123, v94, v95
  v_exp_f32 v97, v97
  v_exp_f32 v98, v98
  v_exp_f32 v99, v99
  v_mfma_f32_32x32x16_bf16 v[56:71], v[144:147], v[120:123], v[56:71]
  v_exp_f32 v100, v100
  v_exp_f32 v101, v101
  v_exp_f32 v102, v102
  v_exp_f32 v103, v103
  v_cvt_pk_bf16_f32 v124, v96, v97
  v_cvt_pk_bf16_f32 v125, v98, v99
  v_cvt_pk_bf16_f32 v126, v100, v101
  v_cvt_pk_bf16_f32 v127, v102, v103
  v_mfma_f32_32x32x16_bf16 v[88:103], v[140:143], v[190:193], v[24:39]
  v_exp_f32 v104, v104
  v_exp_f32 v105, v105
  v_exp_f32 v106, v106
  v_exp_f32 v107, v107
  v_mfma_f32_32x32x16_bf16 v[56:71], v[148:151], v[124:127], v[56:71]
  s_add_u32 s17, s49, 12288
  buffer_load_dword v167, v166, s[4:7], s17 offen sc1
  v_exp_f32 v108, v108
  v_exp_f32 v109, v109
  v_exp_f32 v110, v110
  v_exp_f32 v111, v111
  v_exp_f32 v112, v112
  v_cvt_pk_bf16_f32 v128, v104, v105
  v_cvt_pk_bf16_f32 v129, v106, v107
  v_cvt_pk_bf16_f32 v130, v108, v109
  v_cvt_pk_bf16_f32 v131, v110, v111
  v_exp_f32 v113, v113
  v_exp_f32 v114, v114
  v_exp_f32 v115, v115
  v_mfma_f32_32x32x16_bf16 v[72:87], v[144:147], v[128:131], v[72:87]
  s_waitcnt lgkmcnt(0)
  v_exp_f32 v116, v116
  v_exp_f32 v117, v117
  v_exp_f32 v118, v118
  v_exp_f32 v119, v119
  v_cvt_pk_bf16_f32 v132, v112, v113
  v_cvt_pk_bf16_f32 v133, v114, v115
  v_cvt_pk_bf16_f32 v134, v116, v117
  v_cvt_pk_bf16_f32 v135, v118, v119
  v_mfma_f32_32x32x16_bf16 v[104:119], v[140:143], v[194:197], v[40:55]
  ds_read_b128 v[140:143], v1 offset:60416
  v_exp_f32 v88, v88
  v_exp_f32 v89, v89
  v_exp_f32 v90, v90
  v_exp_f32 v91, v91
  v_mfma_f32_32x32x16_bf16 v[72:87], v[148:151], v[132:135], v[72:87]
  ds_read_b128 v[144:147], v161 offset:2048
  ds_read_b128 v[148:151], v161 offset:2560
  v_exp_f32 v92, v92
  v_exp_f32 v93, v93
  v_exp_f32 v94, v94
  v_exp_f32 v95, v95
  v_exp_f32 v96, v96
  v_cvt_pk_bf16_f32 v120, v88, v89
  v_cvt_pk_bf16_f32 v121, v90, v91
  v_cvt_pk_bf16_f32 v122, v92, v93
  v_cvt_pk_bf16_f32 v123, v94, v95
  v_exp_f32 v97, v97
  v_exp_f32 v98, v98
  v_exp_f32 v99, v99
  v_mfma_f32_32x32x16_bf16 v[56:71], v[152:155], v[120:123], v[56:71]
  v_exp_f32 v100, v100
  v_exp_f32 v101, v101
  v_exp_f32 v102, v102
  v_exp_f32 v103, v103
  v_cvt_pk_bf16_f32 v124, v96, v97
  v_cvt_pk_bf16_f32 v125, v98, v99
  v_cvt_pk_bf16_f32 v126, v100, v101
  v_cvt_pk_bf16_f32 v127, v102, v103
  v_mfma_f32_32x32x16_bf16 v[88:103], v[136:139], v[190:193], v[24:39]
  v_exp_f32 v104, v104
  v_exp_f32 v105, v105
  v_exp_f32 v106, v106
  v_exp_f32 v107, v107
  v_mfma_f32_32x32x16_bf16 v[56:71], v[156:159], v[124:127], v[56:71]
  v_exp_f32 v108, v108
  v_exp_f32 v109, v109
  v_exp_f32 v110, v110
  v_exp_f32 v111, v111
  v_exp_f32 v112, v112
  v_cvt_pk_bf16_f32 v128, v104, v105
  v_cvt_pk_bf16_f32 v129, v106, v107
  v_cvt_pk_bf16_f32 v130, v108, v109
  v_cvt_pk_bf16_f32 v131, v110, v111
  v_exp_f32 v113, v113
  v_exp_f32 v114, v114
  v_exp_f32 v115, v115
  v_mfma_f32_32x32x16_bf16 v[72:87], v[152:155], v[128:131], v[72:87]
  s_waitcnt lgkmcnt(0)
  v_exp_f32 v116, v116
  v_exp_f32 v117, v117
  v_exp_f32 v118, v118
  v_exp_f32 v119, v119
  v_cvt_pk_bf16_f32 v132, v112, v113
  v_cvt_pk_bf16_f32 v133, v114, v115
  v_cvt_pk_bf16_f32 v134, v116, v117
  v_cvt_pk_bf16_f32 v135, v118, v119
  v_mfma_f32_32x32x16_bf16 v[104:119], v[136:139], v[194:197], v[40:55]
  ds_read_b128 v[136:139], v1 offset:61440
  v_exp_f32 v88, v88
  v_exp_f32 v89, v89
  v_exp_f32 v90, v90
  v_exp_f32 v91, v91
  v_mfma_f32_32x32x16_bf16 v[72:87], v[156:159], v[132:135], v[72:87]
  ds_read_b128 v[152:155], v161 offset:3072
  ds_read_b128 v[156:159], v161 offset:3584
  v_exp_f32 v92, v92
  v_exp_f32 v93, v93
  v_exp_f32 v94, v94
  v_exp_f32 v95, v95
  v_exp_f32 v96, v96
  v_cvt_pk_bf16_f32 v120, v88, v89
  v_cvt_pk_bf16_f32 v121, v90, v91
  v_cvt_pk_bf16_f32 v122, v92, v93
  v_cvt_pk_bf16_f32 v123, v94, v95
  v_exp_f32 v97, v97
  v_exp_f32 v98, v98
  v_exp_f32 v99, v99
  v_mfma_f32_32x32x16_bf16 v[56:71], v[144:147], v[120:123], v[56:71]
  v_exp_f32 v100, v100
  v_exp_f32 v101, v101
  v_exp_f32 v102, v102
  v_exp_f32 v103, v103
  v_cvt_pk_bf16_f32 v124, v96, v97
  v_cvt_pk_bf16_f32 v125, v98, v99
  v_cvt_pk_bf16_f32 v126, v100, v101
  v_cvt_pk_bf16_f32 v127, v102, v103
  v_mfma_f32_32x32x16_bf16 v[88:103], v[140:143], v[190:193], v[24:39]
  v_exp_f32 v104, v104
  v_exp_f32 v105, v105
  v_exp_f32 v106, v106
  v_exp_f32 v107, v107
  v_mfma_f32_32x32x16_bf16 v[56:71], v[148:151], v[124:127], v[56:71]
  s_add_u32 s17, s49, 16384
  buffer_load_dword v167, v166, s[4:7], s17 offen sc1
  v_exp_f32 v108, v108
  v_exp_f32 v109, v109
  v_exp_f32 v110, v110
  v_exp_f32 v111, v111
  v_exp_f32 v112, v112
  v_cvt_pk_bf16_f32 v128, v104, v105
  v_cvt_pk_bf16_f32 v129, v106, v107
  v_cvt_pk_bf16_f32 v130, v108, v109
  v_cvt_pk_bf16_f32 v131, v110, v111
  v_exp_f32 v113, v113
  v_exp_f32 v114, v114
  v_exp_f32 v115, v115
  v_mfma_f32_32x32x16_bf16 v[72:87], v[144:147], v[128:131], v[72:87]
  s_waitcnt lgkmcnt(0)
  v_exp_f32 v116, v116
  v_exp_f32 v117, v117
  v_exp_f32 v118, v118
  v_exp_f32 v119, v119
  v_cvt_pk_bf16_f32 v132, v112, v113
  v_cvt_pk_bf16_f32 v133, v114, v115
  v_cvt_pk_bf16_f32 v134, v116, v117
  v_cvt_pk_bf16_f32 v135, v118, v119
  v_mfma_f32_32x32x16_bf16 v[104:119], v[140:143], v[194:197], v[40:55]
  ds_read_b128 v[140:143], v1 offset:62464
  v_exp_f32 v88, v88
  v_exp_f32 v89, v89
  v_exp_f32 v90, v90
  v_exp_f32 v91, v91
  v_mfma_f32_32x32x16_bf16 v[72:87], v[148:151], v[132:135], v[72:87]
  ds_read_b128 v[144:147], v161 offset:4096
  ds_read_b128 v[148:151], v161 offset:4608
  v_exp_f32 v92, v92
  v_exp_f32 v93, v93
  v_exp_f32 v94, v94
  v_exp_f32 v95, v95
  v_exp_f32 v96, v96
  v_cvt_pk_bf16_f32 v120, v88, v89
  v_cvt_pk_bf16_f32 v121, v90, v91
  v_cvt_pk_bf16_f32 v122, v92, v93
  v_cvt_pk_bf16_f32 v123, v94, v95
  v_exp_f32 v97, v97
  v_exp_f32 v98, v98
  v_exp_f32 v99, v99
  v_mfma_f32_32x32x16_bf16 v[56:71], v[152:155], v[120:123], v[56:71]
  v_exp_f32 v100, v100
  v_exp_f32 v101, v101
  v_exp_f32 v102, v102
  v_exp_f32 v103, v103
  v_cvt_pk_bf16_f32 v124, v96, v97
  v_cvt_pk_bf16_f32 v125, v98, v99
  v_cvt_pk_bf16_f32 v126, v100, v101
  v_cvt_pk_bf16_f32 v127, v102, v103
  v_mfma_f32_32x32x16_bf16 v[88:103], v[136:139], v[190:193], v[24:39]
  v_exp_f32 v104, v104
  v_exp_f32 v105, v105
  v_exp_f32 v106, v106
  v_exp_f32 v107, v107
  v_mfma_f32_32x32x16_bf16 v[56:71], v[156:159], v[124:127], v[56:71]
  v_exp_f32 v108, v108
  v_exp_f32 v109, v109
  v_exp_f32 v110, v110
  v_exp_f32 v111, v111
  v_exp_f32 v112, v112
  v_cvt_pk_bf16_f32 v128, v104, v105
  v_cvt_pk_bf16_f32 v129, v106, v107
  v_cvt_pk_bf16_f32 v130, v108, v109
  v_cvt_pk_bf16_f32 v131, v110, v111
  v_exp_f32 v113, v113
  v_exp_f32 v114, v114
  v_exp_f32 v115, v115
  v_mfma_f32_32x32x16_bf16 v[72:87], v[152:155], v[128:131], v[72:87]
  s_waitcnt lgkmcnt(0)
  v_exp_f32 v116, v116
  v_exp_f32 v117, v117
  v_exp_f32 v118, v118
  v_exp_f32 v119, v119
  v_add_u32 v161, v162, v161
  v_cvt_pk_bf16_f32 v132, v112, v113
  v_cvt_pk_bf16_f32 v133, v114, v115
  v_cvt_pk_bf16_f32 v134, v116, v117
  v_cvt_pk_bf16_f32 v135, v118, v119
  v_mfma_f32_32x32x16_bf16 v[104:119], v[136:139], v[194:197], v[40:55]
  ds_read_b128 v[136:139], v1 offset:63488
  v_exp_f32 v88, v88
  v_exp_f32 v89, v89
  v_exp_f32 v90, v90
  v_exp_f32 v91, v91
  v_mfma_f32_32x32x16_bf16 v[72:87], v[156:159], v[132:135], v[72:87]
  ds_read_b128 v[152:155], v161 offset:1024
  ds_read_b128 v[156:159], v161 offset:1536
  v_exp_f32 v92, v92
  v_exp_f32 v93, v93
  v_exp_f32 v94, v94
  v_exp_f32 v95, v95
  v_exp_f32 v96, v96
  v_cvt_pk_bf16_f32 v120, v88, v89
  v_cvt_pk_bf16_f32 v121, v90, v91
  v_cvt_pk_bf16_f32 v122, v92, v93
  v_cvt_pk_bf16_f32 v123, v94, v95
  v_exp_f32 v97, v97
  v_exp_f32 v98, v98
  v_exp_f32 v99, v99
  v_mfma_f32_32x32x16_bf16 v[56:71], v[144:147], v[120:123], v[56:71]
  v_exp_f32 v100, v100
  v_exp_f32 v101, v101
  v_exp_f32 v102, v102
  v_exp_f32 v103, v103
  v_cvt_pk_bf16_f32 v124, v96, v97
  v_cvt_pk_bf16_f32 v125, v98, v99
  v_cvt_pk_bf16_f32 v126, v100, v101
  v_cvt_pk_bf16_f32 v127, v102, v103
  v_mfma_f32_32x32x16_bf16 v[88:103], v[140:143], v[190:193], v[24:39]
  v_exp_f32 v104, v104
  v_exp_f32 v105, v105
  v_exp_f32 v106, v106
  v_exp_f32 v107, v107
  v_mfma_f32_32x32x16_bf16 v[56:71], v[148:151], v[124:127], v[56:71]
  v_exp_f32 v108, v108
  v_exp_f32 v109, v109
  v_exp_f32 v110, v110
  v_exp_f32 v111, v111
  v_exp_f32 v112, v112
  v_cvt_pk_bf16_f32 v128, v104, v105
  v_cvt_pk_bf16_f32 v129, v106, v107
  v_cvt_pk_bf16_f32 v130, v108, v109
  v_cvt_pk_bf16_f32 v131, v110, v111
  v_exp_f32 v113, v113
  v_exp_f32 v114, v114
  v_exp_f32 v115, v115
  v_mfma_f32_32x32x16_bf16 v[72:87], v[144:147], v[128:131], v[72:87]
  s_waitcnt lgkmcnt(0)
  v_exp_f32 v116, v116
  v_exp_f32 v117, v117
  v_exp_f32 v118, v118
  v_exp_f32 v119, v119
  v_cvt_pk_bf16_f32 v132, v112, v113
  v_cvt_pk_bf16_f32 v133, v114, v115
  v_cvt_pk_bf16_f32 v134, v116, v117
  v_cvt_pk_bf16_f32 v135, v118, v119
  v_mfma_f32_32x32x16_bf16 v[104:119], v[140:143], v[194:197], v[40:55]
  ds_read_b128 v[140:143], v1 offset:64512
  v_exp_f32 v88, v88
  v_exp_f32 v89, v89
  v_exp_f32 v90, v90
  v_exp_f32 v91, v91
  v_mfma_f32_32x32x16_bf16 v[72:87], v[148:151], v[132:135], v[72:87]
  ds_read_b128 v[144:147], v161 offset:2048
  ds_read_b128 v[148:151], v161 offset:2560
  v_exp_f32 v92, v92
  v_exp_f32 v93, v93
  v_exp_f32 v94, v94
  v_exp_f32 v95, v95
  v_exp_f32 v96, v96
  v_cvt_pk_bf16_f32 v120, v88, v89
  v_cvt_pk_bf16_f32 v121, v90, v91
  v_cvt_pk_bf16_f32 v122, v92, v93
  v_cvt_pk_bf16_f32 v123, v94, v95
  v_exp_f32 v97, v97
  v_exp_f32 v98, v98
  v_exp_f32 v99, v99
  v_mfma_f32_32x32x16_bf16 v[56:71], v[152:155], v[120:123], v[56:71]
  v_exp_f32 v100, v100
  v_exp_f32 v101, v101
  v_exp_f32 v102, v102
  v_exp_f32 v103, v103
  v_cvt_pk_bf16_f32 v124, v96, v97
  v_cvt_pk_bf16_f32 v125, v98, v99
  v_cvt_pk_bf16_f32 v126, v100, v101
  v_cvt_pk_bf16_f32 v127, v102, v103
  v_mfma_f32_32x32x16_bf16 v[88:103], v[136:139], v[190:193], v[24:39]
  v_exp_f32 v104, v104
  v_exp_f32 v105, v105
  v_exp_f32 v106, v106
  v_exp_f32 v107, v107
  v_mfma_f32_32x32x16_bf16 v[56:71], v[156:159], v[124:127], v[56:71]
  v_exp_f32 v108, v108
  v_exp_f32 v109, v109
  v_exp_f32 v110, v110
  v_exp_f32 v111, v111
  v_exp_f32 v112, v112
  v_cvt_pk_bf16_f32 v128, v104, v105
  v_cvt_pk_bf16_f32 v129, v106, v107
  v_cvt_pk_bf16_f32 v130, v108, v109
  v_cvt_pk_bf16_f32 v131, v110, v111
  v_exp_f32 v113, v113
  v_exp_f32 v114, v114
  v_exp_f32 v115, v115
  v_mfma_f32_32x32x16_bf16 v[72:87], v[152:155], v[128:131], v[72:87]
  s_waitcnt lgkmcnt(0)
  v_exp_f32 v116, v116
  v_exp_f32 v117, v117
  v_exp_f32 v118, v118
  v_exp_f32 v119, v119
  v_cvt_pk_bf16_f32 v132, v112, v113
  v_cvt_pk_bf16_f32 v133, v114, v115
  v_cvt_pk_bf16_f32 v134, v116, v117
  v_cvt_pk_bf16_f32 v135, v118, v119
  v_mfma_f32_32x32x16_bf16 v[104:119], v[136:139], v[194:197], v[40:55]
  v_exp_f32 v88, v88
  v_exp_f32 v89, v89
  v_exp_f32 v90, v90
  v_exp_f32 v91, v91
  v_mfma_f32_32x32x16_bf16 v[72:87], v[156:159], v[132:135], v[72:87]
  ds_read_b128 v[152:155], v161 offset:3072
  ds_read_b128 v[156:159], v161 offset:3584
  v_exp_f32 v92, v92
  v_exp_f32 v93, v93
  v_exp_f32 v94, v94
  v_exp_f32 v95, v95
  v_exp_f32 v96, v96
  v_cvt_pk_bf16_f32 v120, v88, v89
  v_cvt_pk_bf16_f32 v121, v90, v91
  v_cvt_pk_bf16_f32 v122, v92, v93
  v_cvt_pk_bf16_f32 v123, v94, v95
  v_exp_f32 v97, v97
  v_exp_f32 v98, v98
  v_exp_f32 v99, v99
  v_mfma_f32_32x32x16_bf16 v[56:71], v[144:147], v[120:123], v[56:71]
  v_exp_f32 v100, v100
  v_exp_f32 v101, v101
  v_exp_f32 v102, v102
  v_exp_f32 v103, v103
  v_cvt_pk_bf16_f32 v124, v96, v97
  v_cvt_pk_bf16_f32 v125, v98, v99
  v_cvt_pk_bf16_f32 v126, v100, v101
  v_cvt_pk_bf16_f32 v127, v102, v103
  v_mfma_f32_32x32x16_bf16 v[88:103], v[140:143], v[190:193], v[24:39]
  v_exp_f32 v104, v104
  v_exp_f32 v105, v105
  v_exp_f32 v106, v106
  v_exp_f32 v107, v107
  v_mfma_f32_32x32x16_bf16 v[56:71], v[148:151], v[124:127], v[56:71]
  v_exp_f32 v108, v108
  v_exp_f32 v109, v109
  v_exp_f32 v110, v110
  v_exp_f32 v111, v111
  v_exp_f32 v112, v112
  v_cvt_pk_bf16_f32 v128, v104, v105
  v_cvt_pk_bf16_f32 v129, v106, v107
  v_cvt_pk_bf16_f32 v130, v108, v109
  v_cvt_pk_bf16_f32 v131, v110, v111
  v_exp_f32 v113, v113
  v_exp_f32 v114, v114
  v_exp_f32 v115, v115
  v_mfma_f32_32x32x16_bf16 v[72:87], v[144:147], v[128:131], v[72:87]
  s_waitcnt lgkmcnt(0)
  v_exp_f32 v116, v116
  v_exp_f32 v117, v117
  v_exp_f32 v118, v118
  v_exp_f32 v119, v119
  v_cvt_pk_bf16_f32 v132, v112, v113
  v_cvt_pk_bf16_f32 v133, v114, v115
  v_cvt_pk_bf16_f32 v134, v116, v117
  v_cvt_pk_bf16_f32 v135, v118, v119
  v_mfma_f32_32x32x16_bf16 v[104:119], v[140:143], v[194:197], v[40:55]
  v_exp_f32 v88, v88
  v_exp_f32 v89, v89
  v_exp_f32 v90, v90
  v_exp_f32 v91, v91
  v_mfma_f32_32x32x16_bf16 v[72:87], v[148:151], v[132:135], v[72:87]
  v_exp_f32 v92, v92
  v_exp_f32 v93, v93
  v_exp_f32 v94, v94
  v_exp_f32 v95, v95
  v_exp_f32 v96, v96
  v_cvt_pk_bf16_f32 v120, v88, v89
  v_cvt_pk_bf16_f32 v121, v90, v91
  v_cvt_pk_bf16_f32 v122, v92, v93
  v_cvt_pk_bf16_f32 v123, v94, v95
  v_exp_f32 v97, v97
  v_exp_f32 v98, v98
  v_exp_f32 v99, v99
  v_mfma_f32_32x32x16_bf16 v[56:71], v[152:155], v[120:123], v[56:71]
  v_exp_f32 v100, v100
  v_exp_f32 v101, v101
  v_exp_f32 v102, v102
  v_exp_f32 v103, v103
  v_cvt_pk_bf16_f32 v124, v96, v97
  v_cvt_pk_bf16_f32 v125, v98, v99
  v_cvt_pk_bf16_f32 v126, v100, v101
  v_cvt_pk_bf16_f32 v127, v102, v103
  v_exp_f32 v104, v104
  v_exp_f32 v105, v105
  v_exp_f32 v106, v106
  v_exp_f32 v107, v107
  v_mfma_f32_32x32x16_bf16 v[56:71], v[156:159], v[124:127], v[56:71]
  v_exp_f32 v108, v108
  v_exp_f32 v109, v109
  v_exp_f32 v110, v110
  v_exp_f32 v111, v111
  v_exp_f32 v112, v112
  v_cvt_pk_bf16_f32 v128, v104, v105
  v_cvt_pk_bf16_f32 v129, v106, v107
  v_cvt_pk_bf16_f32 v130, v108, v109
  v_cvt_pk_bf16_f32 v131, v110, v111
  v_exp_f32 v113, v113
  v_exp_f32 v114, v114
  v_exp_f32 v115, v115
  v_mfma_f32_32x32x16_bf16 v[72:87], v[152:155], v[128:131], v[72:87]
  s_waitcnt lgkmcnt(0)
  v_exp_f32 v116, v116
  v_exp_f32 v117, v117
  v_exp_f32 v118, v118
  v_exp_f32 v119, v119
  v_add_u32 v161, v162, v161
  v_cvt_pk_bf16_f32 v132, v112, v113
  v_cvt_pk_bf16_f32 v133, v114, v115
  v_cvt_pk_bf16_f32 v134, v116, v117
  v_cvt_pk_bf16_f32 v135, v118, v119
L_att_done:
  s_nop 1
  v_mfma_f32_32x32x16_bf16 v[72:87], v[156:159], v[132:135], v[72:87]
  s_mov_b32 s34, 0xc00000
  s_lshl_b32 s18, s31, 15
  s_add_u32 s34, s34, s18
  s_lshl_b32 s18, s32, 11
  s_add_u32 s34, s34, s18
  v_rcp_f32 v164, v64
  s_nop 0
  v_mul_f32 v56, v164, v56
  v_mul_f32 v57, v164, v57
  v_mul_f32 v58, v164, v58
  v_mul_f32 v59, v164, v59
  v_mul_f32 v60, v164, v60
  v_mul_f32 v61, v164, v61
  v_mul_f32 v62, v164, v62
  v_mul_f32 v63, v164, v63
  v_cvt_pk_bf16_f32 v120, v56, v57
  v_cvt_pk_bf16_f32 v121, v58, v59
  v_cvt_pk_bf16_f32 v122, v60, v61
  v_cvt_pk_bf16_f32 v123, v62, v63
  s_cmp_lg_u32 s57, 0
  s_cbranch_scc1 L_ls1a
  buffer_store_dwordx4 v[120:123], v1, s[4:7], s34 offen offset:0 sc1
  s_branch L_ls1b
L_ls1a:
  buffer_store_dwordx4 v[120:123], v1, s[4:7], s34 offen offset:0
L_ls1b:
  v_rcp_f32 v164, v80
  s_nop 0
  v_mul_f32 v72, v164, v72
  v_mul_f32 v73, v164, v73
  v_mul_f32 v74, v164, v74
  v_mul_f32 v75, v164, v75
  v_mul_f32 v76, v164, v76
  v_mul_f32 v77, v164, v77
  v_mul_f32 v78, v164, v78
  v_mul_f32 v79, v164, v79
  v_cvt_pk_bf16_f32 v124, v72, v73
  v_cvt_pk_bf16_f32 v125, v74, v75
  v_cvt_pk_bf16_f32 v126, v76, v77
  v_cvt_pk_bf16_f32 v127, v78, v79
  s_cmp_lg_u32 s57, 0
  s_cbranch_scc1 L_ls2a
  buffer_store_dwordx4 v[124:127], v1, s[4:7], s34 offen offset:1024 sc1
  s_branch L_ls2b
L_ls2a:
  buffer_store_dwordx4 v[124:127], v1, s[4:7], s34 offen offset:1024
L_ls2b:
  s_mul_i32 s40, s3, 0x1000
  s_add_u32 s40, s40, 0x6b0000
  s_lshl_b32 s17, s13, 7
  s_add_u32 s40, s40, s17
  s_lshl_b32 s17, s14, 4
  s_add_u32 s40, s40, s17
  s_lshl_b32 s17, s12, 2
  s_add_u32 s40, s40, s17
  s_cmp_eq_u32 s57, 0
  s_cbranch_scc1 L_rb_5
  v_lshlrev_b32 v22, 6, v2
  s_mov_b32 exec_lo, 0xffffffff
  s_mov_b32 exec_hi, 0x0
  buffer_load_dword v199, v22, s[4:7], s34 offen offset:0 sc1
L_rb_5:
  s_waitcnt vmcnt(0)
  s_mov_b64 exec, 1
  s_cmp_lg_u32 s57, 0
  s_cbranch_scc1 L_ls3a
  buffer_store_dword v11, v21, s[4:7], s40 offen offset:0 sc1
  s_branch L_ls3b
L_ls3a:
  buffer_store_dword v11, v21, s[4:7], s40 offen offset:0
L_ls3b:
  s_mov_b64 exec, -1
  s_barrier
  s_mov_b32 s28, 0xc00000
  s_mul_i32 s20, s12, 8192
  s_add_u32 s20, s20, s28
  s_mul_i32 s26, s31, 32768
  s_add_u32 s26, s26, s20
  s_xor_b32 s21, s31, 1
  s_mul_i32 s27, s21, 32768
  s_add_u32 s27, s27, s20
  s_xor_b32 s17, s12, 1
  s_mul_i32 s17, s17, 12288
  s_add_u32 s17, s17, 98304
  v_add_u32 v184, s17, v1
  s_xor_b32 s17, s12, 2
  s_mul_i32 s17, s17, 12288
  s_add_u32 s17, s17, 102400
  v_add_u32 v185, s17, v1
  s_xor_b32 s17, s12, 3
  s_mul_i32 s17, s17, 12288
  s_add_u32 s17, s17, 106496
  v_add_u32 v186, s17, v1
  s_mul_i32 s17, s12, 12288
  s_add_u32 s17, s17, 98304
  v_add_u32 v187, s17, v1
  s_mov_b32 s34, 0xa00000
  s_lshl_b32 s18, s31, 15
  s_add_u32 s34, s34, s18
  s_lshl_b32 s18, s32, 11
  s_add_u32 s34, s34, s18
  s_mov_b32 s35, 0x740000
  s_lshl_b32 s18, s31, 12
  s_add_u32 s35, s35, s18
  s_lshr_b32 s18, s32, 1
  s_lshl_b32 s18, s18, 9
  s_add_u32 s35, s35, s18
  s_and_b32 s18, s32, 1
  s_lshl_b32 s18, s18, 3
  s_add_u32 s35, s35, s18
  s_mul_i32 s38, s3, 0x1000
  s_add_u32 s38, s38, 0x6b0000
  s_lshl_b32 s17, s13, 7
  s_add_u32 s38, s38, s17
  s_lshl_b32 s17, s12, 5
  s_add_u32 s38, s38, s17
  v_and_b32 v173, 28, v20
  s_mul_i32 s41, s3, 0x1000
  s_add_u32 s41, s41, 0x6b2000
  s_lshl_b32 s17, s15, 8
  s_add_u32 s41, s41, s17
  s_lshl_b32 s17, s16, 4
  s_add_u32 s41, s41, s17
  s_lshl_b32 s17, s12, 2
  s_add_u32 s41, s41, s17
L_poll_6:
  buffer_load_dword v172, v173, s[4:7], s38 offen offset:0 sc1
  s_waitcnt vmcnt(0)
  v_cmp_ne_u32 vcc, v11, v172
  s_nop 1
  s_cbranch_vccnz L_poll_6
L_poll_6_out:
  buffer_load_dwordx4 a[64:67], v1, s[4:7], s27 offen offset:0 sc1
  buffer_load_dwordx4 a[68:71], v1, s[4:7], s27 offen offset:1024 sc1
  buffer_load_dwordx4 a[72:75], v1, s[4:7], s27 offen offset:2048 sc1
  buffer_load_dwordx4 a[76:79], v1, s[4:7], s27 offen offset:3072 sc1
  buffer_load_dwordx4 a[80:83], v5, s[4:7], s27 offen offset:0 sc1
  buffer_load_dwordx4 a[84:87], v5, s[4:7], s27 offen offset:1024 sc1
  buffer_load_dwordx4 a[88:91], v5, s[4:7], s27 offen offset:2048 sc1
  buffer_load_dwordx4 a[92:95], v5, s[4:7], s27 offen offset:3072 sc1
  s_waitcnt vmcnt(7)
  v_mfma_f32_32x32x16_bf16 v[40:55], a[0:3], a[64:67], 0
  v_mfma_f32_32x32x16_bf16 v[72:87], a[32:35], a[64:67], 0
  buffer_load_dwordx4 a[96:99], v1, s[4:7], s26 offen offset:0 sc1
  buffer_load_dwordx4 a[100:103], v1, s[4:7], s26 offen offset:1024 sc1
  s_waitcnt vmcnt(8)
  v_mfma_f32_32x32x16_bf16 v[40:55], a[4:7], a[68:71], v[40:55]
  v_mfma_f32_32x32x16_bf16 v[72:87], a[36:39], a[68:71], v[72:87]
  buffer_load_dwordx4 a[104:107], v1, s[4:7], s26 offen offset:2048 sc1
  buffer_load_dwordx4 a[108:111], v1, s[4:7], s26 offen offset:3072 sc1
  s_waitcnt vmcnt(9)
  v_mfma_f32_32x32x16_bf16 v[40:55], a[8:11], a[72:75], v[40:55]
  v_mfma_f32_32x32x16_bf16 v[72:87], a[40:43], a[72:75], v[72:87]
  buffer_load_dwordx4 a[112:115], v5, s[4:7], s26 offen offset:0 sc1
  buffer_load_dwordx4 a[116:119], v5, s[4:7], s26 offen offset:1024 sc1
  s_waitcnt vmcnt(10)
  v_mfma_f32_32x32x16_bf16 v[40:55], a[12:15], a[76:79], v[40:55]
  v_mfma_f32_32x32x16_bf16 v[72:87], a[44:47], a[76:79], v[72:87]
  buffer_load_dwordx4 a[120:123], v5, s[4:7], s26 offen offset:2048 sc1
  buffer_load_dwordx4 a[124:127], v5, s[4:7], s26 offen offset:3072 sc1
  s_waitcnt vmcnt(11)
  v_mfma_f32_32x32x16_bf16 v[40:55], a[16:19], a[80:83], v[40:55]
  v_mfma_f32_32x32x16_bf16 v[72:87], a[48:51], a[80:83], v[72:87]
  s_waitcnt vmcnt(10)
  v_mfma_f32_32x32x16_bf16 v[40:55], a[20:23], a[84:87], v[40:55]
  v_mfma_f32_32x32x16_bf16 v[72:87], a[52:55], a[84:87], v[72:87]
  s_add_u32 m0, s48, 32768
  s_add_u32 s29, s47, 65536
  buffer_load_dwordx4 v1, s[4:7], s29 offen offset:0 sc1 lds
  s_waitcnt vmcnt(10)
  v_mfma_f32_32x32x16_bf16 v[40:55], a[24:27], a[88:91], v[40:55]
  v_mfma_f32_32x32x16_bf16 v[72:87], a[56:59], a[88:91], v[72:87]
  buffer_load_dwordx4 v1, s[4:7], s29 offen offset:1024 sc1 lds
  s_waitcnt vmcnt(10)
  v_mfma_f32_32x32x16_bf16 v[40:55], a[28:31], a[92:95], v[40:55]
  v_mfma_f32_32x32x16_bf16 v[72:87], a[60:63], a[92:95], v[72:87]
  buffer_load_dwordx4 v1, s[4:7], s29 offen offset:2048 sc1 lds
  s_waitcnt vmcnt(10)
  v_mfma_f32_32x32x16_bf16 v[56:71], a[32:35], a[96:99], 0
  v_mfma_f32_32x32x16_bf16 v[24:39], a[0:3], a[96:99], 0
  buffer_load_dwordx4 v1, s[4:7], s29 offen offset:3072 sc1 lds
  s_waitcnt vmcnt(10)
  v_mfma_f32_32x32x16_bf16 v[56:71], a[36:39], a[100:103], v[56:71]
  v_mfma_f32_32x32x16_bf16 v[24:39], a[4:7], a[100:103], v[24:39]
  s_add_u32 m0, s48, 36864
  s_add_u32 s29, s47, 69632
  buffer_load_dwordx4 v1, s[4:7], s29 offen offset:0 sc1 lds
  ds_write_b128 v184, v[40:43] offset:0
  ds_write_b128 v184, v[44:47] offset:1024
  ds_write_b128 v184, v[48:51] offset:2048
  ds_write_b128 v184, v[52:55] offset:3072
  ds_write_b128 v186, v[72:75] offset:0
  ds_write_b128 v186, v[76:79] offset:1024
  ds_write_b128 v186, v[80:83] offset:2048
  ds_write_b128 v186, v[84:87] offset:3072
  s_waitcnt vmcnt(10)
  v_mfma_f32_32x32x16_bf16 v[56:71], a[40:43], a[104:107], v[56:71]
  v_mfma_f32_32x32x16_bf16 v[24:39], a[8:11], a[104:107], v[24:39]
  buffer_load_dwordx4 v1, s[4:7], s29 offen offset:1024 sc1 lds
  s_waitcnt vmcnt(10)
  v_mfma_f32_32x32x16_bf16 v[56:71], a[44:47], a[108:111], v[56:71]
  v_mfma_f32_32x32x16_bf16 v[24:39], a[12:15], a[108:111], v[24:39]
  buffer_load_dwordx4 v1, s[4:7], s29 offen offset:2048 sc1 lds
  s_waitcnt vmcnt(10)
  v_mfma_f32_32x32x16_bf16 v[56:71], a[48:51], a[112:115], v[56:71]
  v_mfma_f32_32x32x16_bf16 v[24:39], a[16:19], a[112:115], v[24:39]
  buffer_load_dwordx4 v1, s[4:7], s29 offen offset:3072 sc1 lds
  s_waitcnt lgkmcnt(0)
  s_barrier
  ds_read_b128 v[88:91], v187 offset:0
  ds_read_b128 v[92:95], v187 offset:1024
  ds_read_b128 v[96:99], v187 offset:2048
  ds_read_b128 v[100:103], v187 offset:3072
  ds_read_b128 v[104:107], v187 offset:8192
  ds_read_b128 v[108:111], v187 offset:9216
  ds_read_b128 v[112:115], v187 offset:10240
  ds_read_b128 v[116:119], v187 offset:11264
  s_waitcnt vmcnt(10)
  v_mfma_f32_32x32x16_bf16 v[56:71], a[52:55], a[116:119], v[56:71]
  v_mfma_f32_32x32x16_bf16 v[24:39], a[20:23], a[116:119], v[24:39]
  s_mul_i32 s29, s16, 7168
  s_lshl_b32 s17, s12, 11
  s_add_u32 s29, s29, s17
  s_add_u32 m0, s17, 155648
  s_add_u32 s29, s29, 0x6c0000
  buffer_load_dwordx4 v1, s[4:7], s29 offen sc1 lds
  s_waitcnt lgkmcnt(0)
  v_add_f32 v88, v88, v104
  v_add_f32 v89, v89, v105
  v_add_f32 v90, v90, v106
  v_add_f32 v91, v91, v107
  v_add_f32 v92, v92, v108
  v_add_f32 v93, v93, v109
  v_add_f32 v94, v94, v110
  v_add_f32 v95, v95, v111
  v_add_f32 v96, v96, v112
  v_add_f32 v97, v97, v113
  s_waitcnt vmcnt(10)
  v_mfma_f32_32x32x16_bf16 v[56:71], a[56:59], a[120:123], v[56:71]
  v_mfma_f32_32x32x16_bf16 v[24:39], a[24:27], a[120:123], v[24:39]
  buffer_load_dwordx4 v1, s[4:7], s29 offen offset:1024 sc1 lds
  v_add_f32 v98, v98, v114
  v_add_f32 v99, v99, v115
  v_add_f32 v100, v100, v116
  v_add_f32 v101, v101, v117
  v_add_f32 v102, v102, v118
  v_add_f32 v103, v103, v119
  v_lshlrev_b32 v168, 16, v12
  v_and_b32 v169, 0xffff0000, v12
  v_add_f32 v88, v88, v168
  v_add_f32 v89, v89, v169
  s_waitcnt vmcnt(10)
  v_mfma_f32_32x32x16_bf16 v[56:71], a[60:63], a[124:127], v[56:71]
  v_mfma_f32_32x32x16_bf16 v[24:39], a[28:31], a[124:127], v[24:39]
  v_lshlrev_b32 v168, 16, v13
  v_and_b32 v169, 0xffff0000, v13
  v_add_f32 v90, v90, v168
  v_add_f32 v91, v91, v169
  v_lshlrev_b32 v168, 16, v14
  v_and_b32 v169, 0xffff0000, v14
  v_add_f32 v92, v92, v168
  v_add_f32 v93, v93, v169
  v_lshlrev_b32 v168, 16, v15
  v_and_b32 v169, 0xffff0000, v15
  s_waitcnt lgkmcnt(0)
  v_add_f32 v94, v94, v168
  v_add_f32 v95, v95, v169
  v_lshlrev_b32 v168, 16, v16
  v_and_b32 v169, 0xffff0000, v16
  v_add_f32 v96, v96, v168
  v_add_f32 v97, v97, v169
  v_lshlrev_b32 v168, 16, v17
  v_and_b32 v169, 0xffff0000, v17
  ds_write_b128 v185, v[56:59] offset:0
  ds_write_b128 v185, v[60:63] offset:1024
  ds_write_b128 v185, v[64:67] offset:2048
  ds_write_b128 v185, v[68:71] offset:3072
  v_add_f32 v98, v98, v168
  v_add_f32 v99, v99, v169
  v_lshlrev_b32 v168, 16, v18
  v_and_b32 v169, 0xffff0000, v18
  v_add_f32 v100, v100, v168
  v_add_f32 v101, v101, v169
  v_lshlrev_b32 v168, 16, v19
  v_and_b32 v169, 0xffff0000, v19
  v_add_f32 v102, v102, v168
  v_add_f32 v103, v103, v169
  v_add_f32 v24, v24, v88
  v_add_f32 v25, v25, v89
  v_add_f32 v26, v26, v90
  v_add_f32 v27, v27, v91
  v_add_f32 v28, v28, v92
  v_add_f32 v29, v29, v93
  v_add_f32 v30, v30, v94
  v_add_f32 v31, v31, v95
  v_add_f32 v32, v32, v96
  v_add_f32 v33, v33, v97
  v_add_f32 v34, v34, v98
  v_add_f32 v35, v35, v99
  v_add_f32 v36, v36, v100
  v_add_f32 v37, v37, v101
  v_add_f32 v38, v38, v102
  v_add_f32 v39, v39, v103
  s_waitcnt lgkmcnt(0)
  s_barrier
  ds_read_b128 v[120:123], v187 offset:4096
  ds_read_b128 v[124:127], v187 offset:5120
  ds_read_b128 v[128:131], v187 offset:6144
  ds_read_b128 v[132:135], v187 offset:7168
  s_waitcnt lgkmcnt(3)
  v_add_f32 v24, v24, v120
  v_add_f32 v25, v25, v121
  v_add_f32 v26, v26, v122
  v_add_f32 v27, v27, v123
  s_waitcnt lgkmcnt(2)
  v_add_f32 v28, v28, v124
  v_add_f32 v29, v29, v125
  v_add_f32 v30, v30, v126
  v_add_f32 v31, v31, v127
  s_waitcnt lgkmcnt(1)
  v_add_f32 v32, v32, v128
  v_add_f32 v33, v33, v129
  v_add_f32 v34, v34, v130
  v_add_f32 v35, v35, v131
  s_waitcnt lgkmcnt(0)
  v_add_f32 v36, v36, v132
  v_add_f32 v37, v37, v133
  v_add_f32 v38, v38, v134
  v_add_f32 v39, v39, v135
  v_cvt_pk_bf16_f32 v12, v24, v25
  v_cvt_pk_bf16_f32 v13, v26, v27
  v_cvt_pk_bf16_f32 v14, v28, v29
  v_cvt_pk_bf16_f32 v15, v30, v31
  s_cmp_lg_u32 s57, 0
  s_cbranch_scc1 L_ls4a
  buffer_store_dwordx4 v[12:15], v1, s[4:7], s34 offen offset:0 sc1
  s_branch L_ls4b
L_ls4a:
  buffer_store_dwordx4 v[12:15], v1, s[4:7], s34 offen offset:0
L_ls4b:
  v_cvt_pk_bf16_f32 v16, v32, v33
  v_cvt_pk_bf16_f32 v17, v34, v35
  v_cvt_pk_bf16_f32 v18, v36, v37
  v_cvt_pk_bf16_f32 v19, v38, v39
  s_cmp_lg_u32 s57, 0
  s_cbranch_scc1 L_ls5a
  buffer_store_dwordx4 v[16:19], v1, s[4:7], s34 offen offset:1024 sc1
  s_branch L_ls5b
L_ls5a:
  buffer_store_dwordx4 v[16:19], v1, s[4:7], s34 offen offset:1024
L_ls5b:
  v_mov_b32 v168, 0x3f803f80
  v_mov_b32 v180, 0
  v_mov_b32 v181, 0
  v_dot2_f32_bf16 v180, v12, v168, v180
  v_dot2_f32_bf16 v181, v12, v12, v181
  v_dot2_f32_bf16 v180, v13, v168, v180
  v_dot2_f32_bf16 v181, v13, v13, v181
  v_dot2_f32_bf16 v180, v14, v168, v180
  v_dot2_f32_bf16 v181, v14, v14, v181
  v_dot2_f32_bf16 v180, v15, v168, v180
  v_dot2_f32_bf16 v181, v15, v15, v181
  v_dot2_f32_bf16 v180, v16, v168, v180
  v_dot2_f32_bf16 v181, v16, v16, v181
  v_dot2_f32_bf16 v180, v17, v168, v180
  v_dot2_f32_bf16 v181, v17, v17, v181
  v_dot2_f32_bf16 v180, v18, v168, v180
  v_dot2_f32_bf16 v181, v18, v18, v181
  v_dot2_f32_bf16 v180, v19, v168, v180
  v_dot2_f32_bf16 v181, v19, v19, v181
  v_lshlrev_b32 v170, 4, v3
  s_nop 1
  v_mov_b32 v182, v180
  v_mov_b32 v183, v181
  s_nop 0
  v_permlane32_swap_b32 v180, v182
  v_permlane32_swap_b32 v181, v183
  v_add_f32 v180, v180, v182
  v_add_f32 v181, v181, v183
  s_mov_b32 exec_lo, 0xffffffff
  s_mov_b32 exec_hi, 0x0
  s_cmp_lg_u32 s57, 0
  s_cbranch_scc1 L_ls6a
  buffer_store_dwordx2 v[180:181], v170, s[4:7], s35 offen sc1
  s_branch L_ls6b
L_ls6a:
  buffer_store_dwordx2 v[180:181], v170, s[4:7], s35 offen
L_ls6b:
  s_mov_b64 exec, -1
  s_cmp_eq_u32 s57, 0
  s_cbranch_scc1 L_rb_7
  v_lshlrev_b32 v22, 6, v2
  s_mov_b32 exec_lo, 0xffffffff
  s_mov_b32 exec_hi, 0x0
  buffer_load_dword v199, v22, s[4:7], s34 offen offset:0 sc1
  s_mov_b32 exec_lo, 0xff
  s_mov_b32 exec_hi, 0x0
  buffer_load_dword v199, v22, s[4:7], s35 offen offset:0 sc1
L_rb_7:
  s_waitcnt vmcnt(0)
  s_mov_b64 exec, 1
  s_cmp_lg_u32 s57, 0
  s_cbranch_scc1 L_ls7a
  buffer_store_dword v11, v21, s[4:7], s41 offen offset:0 sc1
  s_branch L_ls7b
L_ls7a:
  buffer_store_dword v11, v21, s[4:7], s41 offen offset:0
L_ls7b:
  s_mov_b64 exec, -1
  s_mul_i32 s35, s12, 6144
  s_sub_u32 s34, s47, s48
  s_add_u32 s34, s34, s35
  s_add_u32 s34, s34, 131072
  s_lshl_b32 s28, s12, 11
  s_sub_u32 s33, s47, s48
  s_add_u32 s33, s33, s28
  s_add_u32 s33, s33, 155648
  s_lshl_b32 s30, s15, 2
  s_add_u32 s30, s30, s12
  s_mov_b32 s24, 0xa00000
  s_lshl_b32 s17, s30, 15
  s_add_u32 s24, s24, s17
  s_add_u32 s25, s24, 28672
  s_mov_b32 s26, 0x740000
  s_lshl_b32 s18, s30, 12
  s_add_u32 s26, s26, s18
  s_mov_b32 s27, 0xe00000
  s_mul_i32 s17, s30, 114688
  s_add_u32 s27, s27, s17
  s_mul_i32 s17, s16, 7168
  s_add_u32 s27, s27, s17
  v_mov_b32 v184, v1
  v_add_u32 v185, 65536, v1
  v_add_u32 v189, 131072, v1
  v_and_b32 v172, 0x380, v23
  v_add_u32 v173, 4096, v172
  s_mul_i32 s20, s12, 28672
  s_mul_i32 s53, s32, 114688
  s_add_u32 s53, s53, s20
  s_add_u32 s53, s53, 0x480000
  s_xor_b32 s21, s32, 1
  s_mul_i32 s54, s21, 114688
  s_add_u32 s54, s54, s20
  s_add_u32 s54, s54, 0x480000
  s_mul_i32 s38, s3, 0x1000
  s_add_u32 s38, s38, 0x6b2000
  s_lshl_b32 s17, s15, 8
  s_add_u32 s38, s38, s17
  s_lshr_b32 s17, s12, 1
  s_lshl_b32 s17, s17, 7
  s_add_u32 s38, s38, s17
  s_and_b32 s17, s12, 1
  s_lshl_b32 s17, s17, 2
  s_add_u32 s38, s38, s17
  v_and_b32 v170, 14, v2
  v_lshlrev_b32 v170, 3, v170
  v_and_b32 v171, 1, v2
  v_lshl_add_u32 v170, v171, 3, v170
  s_mul_i32 s42, s3, 0x2000
  s_add_u32 s42, s42, 0x6b8000
  s_lshl_b32 s17, s15, 9
  s_add_u32 s42, s42, s17
  s_lshl_b32 s17, s16, 4
  s_add_u32 s42, s42, s17
  s_lshl_b32 s17, s12, 2
  s_add_u32 s42, s42, s17
  s_barrier
L_poll_8:
  buffer_load_dword v168, v170, s[4:7], s38 offen offset:0 sc1
  s_waitcnt vmcnt(0)
  v_cmp_ne_u32 vcc, v11, v168
  s_nop 1
  s_cbranch_vccnz L_poll_8
L_poll_8_out:
  buffer_load_dwordx4 a[0:3], v1, s[4:7], s24 offen offset:0 sc1
  buffer_load_dwordx4 a[4:7], v1, s[4:7], s24 offen offset:1024 sc1
  buffer_load_dwordx4 a[8:11], v1, s[4:7], s24 offen offset:2048 sc1
  buffer_load_dwordx4 a[12:15], v1, s[4:7], s24 offen offset:3072 sc1
  buffer_load_dwordx4 a[16:19], v5, s[4:7], s24 offen offset:0 sc1
  buffer_load_dwordx4 a[20:23], v5, s[4:7], s24 offen offset:1024 sc1
  buffer_load_dwordx4 a[24:27], v5, s[4:7], s24 offen offset:2048 sc1
  buffer_load_dwordx4 a[28:31], v5, s[4:7], s24 offen offset:3072 sc1
  buffer_load_dwordx4 a[32:35], v6, s[4:7], s24 offen offset:0 sc1
  buffer_load_dwordx4 a[36:39], v6, s[4:7], s24 offen offset:1024 sc1
  ds_read_b128 v[88:91], v184 offset:0
  ds_read_b128 v[92:95], v185 offset:0
  ds_read_b128 v[96:99], v184 offset:32768
  ds_read_b128 v[100:103], v184 offset:1024
  ds_read_b128 v[104:107], v185 offset:1024
  ds_read_b128 v[108:111], v184 offset:33792
  s_waitcnt vmcnt(9)
  s_waitcnt lgkmcnt(4)
  v_mfma_f32_32x32x16_bf16 v[24:39], v[88:91], a[0:3], 0
  buffer_load_dwordx4 a[40:43], v6, s[4:7], s24 offen offset:2048 sc1
  ds_read_b128 v[112:115], v184 offset:2048
  v_mfma_f32_32x32x16_bf16 v[40:55], v[92:95], a[0:3], 0
  ds_read_b128 v[116:119], v185 offset:2048
  s_waitcnt lgkmcnt(4)
  v_mfma_f32_32x32x16_bf16 v[56:71], v[96:99], a[0:3], 0
  ds_read_b128 v[88:91], v184 offset:34816
  s_waitcnt vmcnt(9)
  v_mfma_f32_32x32x16_bf16 v[24:39], v[100:103], a[4:7], v[24:39]
  buffer_load_dwordx4 a[44:47], v6, s[4:7], s24 offen offset:3072 sc1
  ds_read_b128 v[92:95], v184 offset:3072
  s_waitcnt lgkmcnt(4)
  v_mfma_f32_32x32x16_bf16 v[40:55], v[104:107], a[4:7], v[40:55]
  ds_read_b128 v[96:99], v185 offset:3072
  v_mfma_f32_32x32x16_bf16 v[56:71], v[108:111], a[4:7], v[56:71]
  ds_read_b128 v[100:103], v184 offset:35840
  s_waitcnt vmcnt(9)
  s_waitcnt lgkmcnt(4)
  v_mfma_f32_32x32x16_bf16 v[24:39], v[112:115], a[8:11], v[24:39]
  buffer_load_dwordx4 a[48:51], v7, s[4:7], s24 offen offset:0 sc1
  ds_read_b128 v[104:107], v184 offset:4096
  v_mfma_f32_32x32x16_bf16 v[40:55], v[116:119], a[8:11], v[40:55]
  ds_read_b128 v[108:111], v185 offset:4096
  s_waitcnt lgkmcnt(4)
  v_mfma_f32_32x32x16_bf16 v[56:71], v[88:91], a[8:11], v[56:71]
  ds_read_b128 v[112:115], v184 offset:36864
  s_waitcnt vmcnt(9)
  v_mfma_f32_32x32x16_bf16 v[24:39], v[92:95], a[12:15], v[24:39]
  buffer_load_dwordx4 a[52:55], v7, s[4:7], s24 offen offset:1024 sc1
  ds_read_b128 v[116:119], v184 offset:5120
  s_waitcnt lgkmcnt(4)
  v_mfma_f32_32x32x16_bf16 v[40:55], v[96:99], a[12:15], v[40:55]
  ds_read_b128 v[88:91], v185 offset:5120
  v_mfma_f32_32x32x16_bf16 v[56:71], v[100:103], a[12:15], v[56:71]
  ds_read_b128 v[92:95], v184 offset:37888
  s_waitcnt vmcnt(9)
  s_waitcnt lgkmcnt(4)
  v_mfma_f32_32x32x16_bf16 v[24:39], v[104:107], a[16:19], v[24:39]
  buffer_load_dwordx4 a[56:59], v7, s[4:7], s24 offen offset:2048 sc1
  ds_read_b128 v[96:99], v184 offset:6144
  v_mfma_f32_32x32x16_bf16 v[40:55], v[108:111], a[16:19], v[40:55]
  ds_read_b128 v[100:103], v185 offset:6144
  s_waitcnt lgkmcnt(4)
  v_mfma_f32_32x32x16_bf16 v[56:71], v[112:115], a[16:19], v[56:71]
  ds_read_b128 v[104:107], v184 offset:38912
  s_waitcnt vmcnt(9)
  v_mfma_f32_32x32x16_bf16 v[24:39], v[116:119], a[20:23], v[24:39]
  buffer_load_dwordx4 a[60:63], v7, s[4:7], s24 offen offset:3072 sc1
  ds_read_b128 v[108:111], v184 offset:7168
  s_waitcnt lgkmcnt(4)
  v_mfma_f32_32x32x16_bf16 v[40:55], v[88:91], a[20:23], v[40:55]
  ds_read_b128 v[112:115], v185 offset:7168
  v_mfma_f32_32x32x16_bf16 v[56:71], v[92:95], a[20:23], v[56:71]
  ds_read_b128 v[116:119], v184 offset:39936
  s_waitcnt vmcnt(9)
  s_waitcnt lgkmcnt(4)
  v_mfma_f32_32x32x16_bf16 v[24:39], v[96:99], a[24:27], v[24:39]
  buffer_load_dwordx4 a[64:67], v8, s[4:7], s24 offen offset:0 sc1
  ds_read_b128 v[88:91], v184 offset:8192
  v_mfma_f32_32x32x16_bf16 v[40:55], v[100:103], a[24:27], v[40:55]
  ds_read_b128 v[92:95], v185 offset:8192
  s_waitcnt lgkmcnt(4)
  v_mfma_f32_32x32x16_bf16 v[56:71], v[104:107], a[24:27], v[56:71]
  ds_read_b128 v[96:99], v184 offset:40960
  s_add_u32 m0, s48, 98304
  s_add_u32 s29, s47, 98304
  buffer_load_dwordx4 v1, s[4:7], s29 offen offset:0 sc1 lds
  s_waitcnt vmcnt(10)
  v_mfma_f32_32x32x16_bf16 v[24:39], v[108:111], a[28:31], v[24:39]
  buffer_load_dwordx4 a[68:71], v8, s[4:7], s24 offen offset:1024 sc1
  ds_read_b128 v[100:103], v184 offset:9216
  s_waitcnt lgkmcnt(4)
  v_mfma_f32_32x32x16_bf16 v[40:55], v[112:115], a[28:31], v[40:55]
  ds_read_b128 v[104:107], v185 offset:9216
  v_mfma_f32_32x32x16_bf16 v[56:71], v[116:119], a[28:31], v[56:71]
  ds_read_b128 v[108:111], v184 offset:41984
  s_waitcnt vmcnt(10)
  s_waitcnt lgkmcnt(4)
  v_mfma_f32_32x32x16_bf16 v[24:39], v[88:91], a[32:35], v[24:39]
  buffer_load_dwordx4 a[72:75], v8, s[4:7], s24 offen offset:2048 sc1
  ds_read_b128 v[112:115], v184 offset:10240
  v_mfma_f32_32x32x16_bf16 v[40:55], v[92:95], a[32:35], v[40:55]
  ds_read_b128 v[116:119], v185 offset:10240
  buffer_load_dwordx4 v1, s[4:7], s29 offen offset:1024 sc1 lds
  s_waitcnt lgkmcnt(4)
  v_mfma_f32_32x32x16_bf16 v[56:71], v[96:99], a[32:35], v[56:71]
  ds_read_b128 v[88:91], v184 offset:43008
  s_waitcnt vmcnt(11)
  v_mfma_f32_32x32x16_bf16 v[24:39], v[100:103], a[36:39], v[24:39]
  buffer_load_dwordx4 a[76:79], v8, s[4:7], s24 offen offset:3072 sc1
  ds_read_b128 v[92:95], v184 offset:11264
  s_waitcnt lgkmcnt(4)
  v_mfma_f32_32x32x16_bf16 v[40:55], v[104:107], a[36:39], v[40:55]
  ds_read_b128 v[96:99], v185 offset:11264
  v_mfma_f32_32x32x16_bf16 v[56:71], v[108:111], a[36:39], v[56:71]
  ds_read_b128 v[100:103], v184 offset:44032
  s_waitcnt vmcnt(11)
  s_waitcnt lgkmcnt(4)
  v_mfma_f32_32x32x16_bf16 v[24:39], v[112:115], a[40:43], v[24:39]
  buffer_load_dwordx4 a[80:83], v9, s[4:7], s24 offen offset:0 sc1
  ds_read_b128 v[104:107], v184 offset:12288
  buffer_load_dwordx4 v1, s[4:7], s29 offen offset:2048 sc1 lds
  v_mfma_f32_32x32x16_bf16 v[40:55], v[116:119], a[40:43], v[40:55]
  ds_read_b128 v[108:111], v185 offset:12288
  s_waitcnt lgkmcnt(4)
  v_mfma_f32_32x32x16_bf16 v[56:71], v[88:91], a[40:43], v[56:71]
  ds_read_b128 v[112:115], v184 offset:45056
  s_waitcnt vmcnt(12)
  v_mfma_f32_32x32x16_bf16 v[24:39], v[92:95], a[44:47], v[24:39]
  buffer_load_dwordx4 a[84:87], v9, s[4:7], s24 offen offset:1024 sc1
  ds_read_b128 v[116:119], v184 offset:13312
  s_waitcnt lgkmcnt(4)
  v_mfma_f32_32x32x16_bf16 v[40:55], v[96:99], a[44:47], v[40:55]
  ds_read_b128 v[88:91], v185 offset:13312
  v_mfma_f32_32x32x16_bf16 v[56:71], v[100:103], a[44:47], v[56:71]
  ds_read_b128 v[92:95], v184 offset:46080
  buffer_load_dwordx4 v1, s[4:7], s29 offen offset:3072 sc1 lds
  s_waitcnt vmcnt(13)
  s_waitcnt lgkmcnt(4)
  v_mfma_f32_32x32x16_bf16 v[24:39], v[104:107], a[48:51], v[24:39]
  buffer_load_dwordx4 a[88:91], v9, s[4:7], s24 offen offset:2048 sc1
  ds_read_b128 v[96:99], v184 offset:14336
  v_mfma_f32_32x32x16_bf16 v[40:55], v[108:111], a[48:51], v[40:55]
  ds_read_b128 v[100:103], v185 offset:14336
  s_waitcnt lgkmcnt(4)
  v_mfma_f32_32x32x16_bf16 v[56:71], v[112:115], a[48:51], v[56:71]
  ds_read_b128 v[104:107], v184 offset:47104
  s_waitcnt vmcnt(13)
  v_mfma_f32_32x32x16_bf16 v[24:39], v[116:119], a[52:55], v[24:39]
  buffer_load_dwordx4 a[92:95], v9, s[4:7], s24 offen offset:3072 sc1
  ds_read_b128 v[108:111], v184 offset:15360
  s_waitcnt lgkmcnt(4)
  v_mfma_f32_32x32x16_bf16 v[40:55], v[88:91], a[52:55], v[40:55]
  ds_read_b128 v[112:115], v185 offset:15360
  s_add_u32 m0, s48, 102400
  s_add_u32 s29, s47, 102400
  buffer_load_dwordx4 v1, s[4:7], s29 offen offset:0 sc1 lds
  v_mfma_f32_32x32x16_bf16 v[56:71], v[92:95], a[52:55], v[56:71]
  ds_read_b128 v[116:119], v184 offset:48128
  s_waitcnt vmcnt(14)
  s_waitcnt lgkmcnt(4)
  v_mfma_f32_32x32x16_bf16 v[24:39], v[96:99], a[56:59], v[24:39]
  buffer_load_dwordx4 a[96:99], v10, s[4:7], s24 offen offset:0 sc1
  ds_read_b128 v[88:91], v184 offset:16384
  v_mfma_f32_32x32x16_bf16 v[40:55], v[100:103], a[56:59], v[40:55]
  ds_read_b128 v[92:95], v185 offset:16384
  s_waitcnt lgkmcnt(4)
  v_mfma_f32_32x32x16_bf16 v[56:71], v[104:107], a[56:59], v[56:71]
  ds_read_b128 v[96:99], v184 offset:49152
  s_waitcnt vmcnt(14)
  v_mfma_f32_32x32x16_bf16 v[24:39], v[108:111], a[60:63], v[24:39]
  buffer_load_dwordx4 a[100:103], v10, s[4:7], s24 offen offset:1024 sc1
  ds_read_b128 v[100:103], v184 offset:17408
  buffer_load_dwordx4 v1, s[4:7], s29 offen offset:1024 sc1 lds
  s_waitcnt lgkmcnt(4)
  v_mfma_f32_32x32x16_bf16 v[40:55], v[112:115], a[60:63], v[40:55]
  ds_read_b128 v[104:107], v185 offset:17408
  v_mfma_f32_32x32x16_bf16 v[56:71], v[116:119], a[60:63], v[56:71]
  ds_read_b128 v[108:111], v184 offset:50176
  s_waitcnt vmcnt(15)
  s_waitcnt lgkmcnt(4)
  v_mfma_f32_32x32x16_bf16 v[24:39], v[88:91], a[64:67], v[24:39]
  buffer_load_dwordx4 a[104:107], v10, s[4:7], s24 offen offset:2048 sc1
  ds_read_b128 v[112:115], v184 offset:18432
  v_mfma_f32_32x32x16_bf16 v[40:55], v[92:95], a[64:67], v[40:55]
  ds_read_b128 v[116:119], v185 offset:18432
  s_waitcnt lgkmcnt(4)
  v_mfma_f32_32x32x16_bf16 v[56:71], v[96:99], a[64:67], v[56:71]
  ds_read_b128 v[88:91], v184 offset:51200
  buffer_load_dwordx4 v1, s[4:7], s29 offen offset:2048 sc1 lds
  s_waitcnt vmcnt(15)
  v_mfma_f32_32x32x16_bf16 v[24:39], v[100:103], a[68:71], v[24:39]
  buffer_load_dwordx4 a[108:111], v10, s[4:7], s24 offen offset:3072 sc1
  ds_read_b128 v[92:95], v184 offset:19456
  s_waitcnt lgkmcnt(4)
  v_mfma_f32_32x32x16_bf16 v[40:55], v[104:107], a[68:71], v[40:55]
  ds_read_b128 v[96:99], v185 offset:19456
  v_mfma_f32_32x32x16_bf16 v[56:71], v[108:111], a[68:71], v[56:71]
  ds_read_b128 v[100:103], v184 offset:52224
  s_waitcnt vmcnt(15)
  s_waitcnt lgkmcnt(4)
  v_mfma_f32_32x32x16_bf16 v[24:39], v[112:115], a[72:75], v[24:39]
  buffer_load_dwordx4 a[112:115], v1, s[4:7], s25 offen offset:0 sc1
  ds_read_b128 v[104:107], v184 offset:20480
  v_mfma_f32_32x32x16_bf16 v[40:55], v[116:119], a[72:75], v[40:55]
  ds_read_b128 v[108:111], v185 offset:20480
  buffer_load_dwordx4 v1, s[4:7], s29 offen offset:3072 sc1 lds
  s_waitcnt lgkmcnt(4)
  v_mfma_f32_32x32x16_bf16 v[56:71], v[88:91], a[72:75], v[56:71]
  ds_read_b128 v[112:115], v184 offset:53248
  s_waitcnt vmcnt(15)
  v_mfma_f32_32x32x16_bf16 v[24:39], v[92:95], a[76:79], v[24:39]
  buffer_load_dwordx4 a[116:119], v1, s[4:7], s25 offen offset:1024 sc1
  ds_read_b128 v[116:119], v184 offset:21504
  s_waitcnt lgkmcnt(4)
  v_mfma_f32_32x32x16_bf16 v[40:55], v[96:99], a[76:79], v[40:55]
  ds_read_b128 v[88:91], v185 offset:21504
  v_mfma_f32_32x32x16_bf16 v[56:71], v[100:103], a[76:79], v[56:71]
  ds_read_b128 v[92:95], v184 offset:54272
  s_waitcnt vmcnt(15)
  s_waitcnt lgkmcnt(4)
  v_mfma_f32_32x32x16_bf16 v[24:39], v[104:107], a[80:83], v[24:39]
  buffer_load_dwordx4 a[120:123], v1, s[4:7], s25 offen offset:2048 sc1
  ds_read_b128 v[96:99], v184 offset:22528
  s_add_u32 m0, s35, 131072
  s_nop 0
  buffer_load_dwordx4 v1, s[4:7], s34 offen offset:0 sc1 lds
  v_mfma_f32_32x32x16_bf16 v[40:55], v[108:111], a[80:83], v[40:55]
  ds_read_b128 v[100:103], v185 offset:22528
  s_waitcnt lgkmcnt(4)
  v_mfma_f32_32x32x16_bf16 v[56:71], v[112:115], a[80:83], v[56:71]
  ds_read_b128 v[104:107], v184 offset:55296
  s_waitcnt vmcnt(15)
  v_mfma_f32_32x32x16_bf16 v[24:39], v[116:119], a[84:87], v[24:39]
  buffer_load_dwordx4 a[124:127], v1, s[4:7], s25 offen offset:3072 sc1
  v_lshlrev_b32 v168, 4, v3
  v_lshl_add_u32 v168, v4, 11, v168
  buffer_load_dwordx4 v[136:139], v168, s[4:7], s26 offen offset:0 sc1
  buffer_load_dwordx4 v[140:143], v168, s[4:7], s26 offen offset:512 sc1
  buffer_load_dwordx4 v[144:147], v168, s[4:7], s26 offen offset:1024 sc1
  buffer_load_dwordx4 v[148:151], v168, s[4:7], s26 offen offset:1536 sc1
  ds_read_b128 v[108:111], v184 offset:23552
  s_waitcnt lgkmcnt(4)
  v_mfma_f32_32x32x16_bf16 v[40:55], v[88:91], a[84:87], v[40:55]
  ds_read_b128 v[112:115], v185 offset:23552
  v_mfma_f32_32x32x16_bf16 v[56:71], v[92:95], a[84:87], v[56:71]
  ds_read_b128 v[116:119], v184 offset:56320
  buffer_load_dwordx4 v1, s[4:7], s34 offen offset:1024 sc1 lds
  s_waitcnt vmcnt(19)
  s_waitcnt lgkmcnt(4)
  v_mfma_f32_32x32x16_bf16 v[24:39], v[96:99], a[88:91], v[24:39]
  ds_read_b128 v[88:91], v184 offset:24576
  v_mfma_f32_32x32x16_bf16 v[40:55], v[100:103], a[88:91], v[40:55]
  ds_read_b128 v[92:95], v185 offset:24576
  s_waitcnt lgkmcnt(4)
  v_mfma_f32_32x32x16_bf16 v[56:71], v[104:107], a[88:91], v[56:71]
  ds_read_b128 v[96:99], v184 offset:57344
  s_waitcnt vmcnt(18)
  v_mfma_f32_32x32x16_bf16 v[24:39], v[108:111], a[92:95], v[24:39]
  ds_read_b128 v[100:103], v184 offset:25600
  s_waitcnt lgkmcnt(4)
  v_mfma_f32_32x32x16_bf16 v[40:55], v[112:115], a[92:95], v[40:55]
  ds_read_b128 v[104:107], v185 offset:25600
  buffer_load_dwordx4 v1, s[4:7], s34 offen offset:2048 sc1 lds
  v_mfma_f32_32x32x16_bf16 v[56:71], v[116:119], a[92:95], v[56:71]
  ds_read_b128 v[108:111], v184 offset:58368
  s_waitcnt vmcnt(17)
  s_waitcnt lgkmcnt(4)
  v_mfma_f32_32x32x16_bf16 v[24:39], v[88:91], a[96:99], v[24:39]
  ds_read_b128 v[112:115], v184 offset:26624
  v_mfma_f32_32x32x16_bf16 v[40:55], v[92:95], a[96:99], v[40:55]
  ds_read_b128 v[116:119], v185 offset:26624
  s_waitcnt lgkmcnt(4)
  v_mfma_f32_32x32x16_bf16 v[56:71], v[96:99], a[96:99], v[56:71]
  ds_read_b128 v[88:91], v184 offset:59392
  s_waitcnt vmcnt(16)
  v_mfma_f32_32x32x16_bf16 v[24:39], v[100:103], a[100:103], v[24:39]
  ds_read_b128 v[92:95], v184 offset:27648
  buffer_load_dwordx4 v1, s[4:7], s34 offen offset:3072 sc1 lds
  s_waitcnt lgkmcnt(4)
  v_mfma_f32_32x32x16_bf16 v[40:55], v[104:107], a[100:103], v[40:55]
  ds_read_b128 v[96:99], v185 offset:27648
  v_mfma_f32_32x32x16_bf16 v[56:71], v[108:111], a[100:103], v[56:71]
  ds_read_b128 v[100:103], v184 offset:60416
  s_waitcnt vmcnt(15)
  s_waitcnt lgkmcnt(4)
  v_mfma_f32_32x32x16_bf16 v[24:39], v[112:115], a[104:107], v[24:39]
  ds_read_b128 v[104:107], v184 offset:28672
  v_mfma_f32_32x32x16_bf16 v[40:55], v[116:119], a[104:107], v[40:55]
  ds_read_b128 v[108:111], v185 offset:28672
  s_waitcnt lgkmcnt(4)
  v_mfma_f32_32x32x16_bf16 v[56:71], v[88:91], a[104:107], v[56:71]
  ds_read_b128 v[112:115], v184 offset:61440
  s_add_u32 m0, s35, 135168
  s_add_u32 s34, s34, 4096
  buffer_load_dwordx4 v1, s[4:7], s34 offen offset:0 sc1 lds
  s_waitcnt vmcnt(14)
  v_mfma_f32_32x32x16_bf16 v[24:39], v[92:95], a[108:111], v[24:39]
  ds_read_b128 v[116:119], v184 offset:29696
  s_waitcnt lgkmcnt(4)
  v_mfma_f32_32x32x16_bf16 v[40:55], v[96:99], a[108:111], v[40:55]
  ds_read_b128 v[88:91], v185 offset:29696
  v_mfma_f32_32x32x16_bf16 v[56:71], v[100:103], a[108:111], v[56:71]
  ds_read_b128 v[92:95], v184 offset:62464
  s_waitcnt vmcnt(13)
  s_waitcnt lgkmcnt(4)
  v_mfma_f32_32x32x16_bf16 v[24:39], v[104:107], a[112:115], v[24:39]
  ds_read_b128 v[96:99], v184 offset:30720
  v_mfma_f32_32x32x16_bf16 v[40:55], v[108:111], a[112:115], v[40:55]
  ds_read_b128 v[100:103], v185 offset:30720
  buffer_load_dwordx4 v1, s[4:7], s34 offen offset:1024 sc1 lds
  s_waitcnt lgkmcnt(4)
  v_mfma_f32_32x32x16_bf16 v[56:71], v[112:115], a[112:115], v[56:71]
  ds_read_b128 v[104:107], v184 offset:63488
  s_waitcnt vmcnt(12)
  v_mfma_f32_32x32x16_bf16 v[24:39], v[116:119], a[116:119], v[24:39]
  ds_read_b128 v[108:111], v184 offset:31744
  s_waitcnt lgkmcnt(4)
  v_mfma_f32_32x32x16_bf16 v[40:55], v[88:91], a[116:119], v[40:55]
  ds_read_b128 v[112:115], v185 offset:31744
  v_mfma_f32_32x32x16_bf16 v[56:71], v[92:95], a[116:119], v[56:71]
  ds_read_b128 v[116:119], v184 offset:64512
  s_waitcnt vmcnt(11)
  s_waitcnt lgkmcnt(4)
  v_mfma_f32_32x32x16_bf16 v[24:39], v[96:99], a[120:123], v[24:39]
  ds_read_b128 v[88:91], v189 offset:24576
  v_mfma_f32_32x32x16_bf16 v[40:55], v[100:103], a[120:123], v[40:55]
  ds_read_b128 v[92:95], v189 offset:25600
  s_waitcnt lgkmcnt(4)
  v_mfma_f32_32x32x16_bf16 v[56:71], v[104:107], a[120:123], v[56:71]
  ds_read_b128 v[96:99], v189 offset:26624
  s_waitcnt vmcnt(9)
  v_mfma_f32_32x32x16_bf16 v[24:39], v[108:111], a[124:127], v[24:39]
  s_waitcnt vmcnt(0)
  s_barrier
  ds_read_b128 v[100:103], v185 offset:32768
  s_waitcnt vmcnt(5)
  v_add_f32 v136, v136, v144
  v_add_f32 v137, v137, v145
  v_add_f32 v138, v138, v146
  v_add_f32 v139, v139, v147
  v_add_f32 v140, v140, v148
  v_add_f32 v141, v141, v149
  v_add_f32 v142, v142, v150
  v_add_f32 v143, v143, v151
  v_add_f32 v136, v136, v140
  v_add_f32 v137, v137, v141
  v_add_f32 v138, v138, v142
  v_add_f32 v139, v139, v143
  v_add_f32 v136, v136, v138
  v_add_f32 v137, v137, v139
  v_mov_b32 v138, v136
  v_mov_b32 v139, v137
  s_nop 0
  v_permlane32_swap_b32 v136, v138
  v_permlane32_swap_b32 v137, v139
  v_add_f32 v136, v136, v138
  v_add_f32 v137, v137, v139
  v_mul_f32 v186, 0xbb000000, v136
  v_mul_f32 v137, 0x3b000000, v137
  v_fma_f32 v137, -v186, v186, v137
  v_max_f32 v137, 0, v137
  v_add_f32 v137, 0x3727c5ac, v137
  v_rsq_f32 v188, v137
  s_nop 0
  v_mul_f32 v187, 0xbfb8aa3b, v188
  v_mov_b32 v188, v137
  v_log_f32 v198, v137
  v_cvt_pk_bf16_f32 v124, v186, v186
  v_and_b32 v124, 0xffff0000, v124
  v_sub_f32 v127, v186, v124
  v_cvt_pk_bf16_f32 v125, v127, v127
  v_and_b32 v125, 0xffff0000, v125
  v_sub_f32 v127, v127, v125
  v_cvt_pk_bf16_f32 v126, v127, v127
  v_and_b32 v126, 0xffff0000, v126
  v_lshrrev_b32 v127, 16, v124
  v_or_b32 v120, v127, v125
  v_or_b32 v121, v127, v126
  v_mov_b32 v122, v120
  v_mov_b32 v123, 0
  s_waitcnt lgkmcnt(4)
  v_mfma_f32_32x32x16_bf16 v[40:55], v[112:115], a[124:127], v[40:55]
  ds_read_b128 v[104:107], v185 offset:33792
  v_mfma_f32_32x32x16_bf16 v[56:71], v[116:119], a[124:127], v[56:71]
  ds_read_b128 v[108:111], v185 offset:34816
  s_waitcnt lgkmcnt(4)
  v_mfma_f32_32x32x16_bf16 v[24:39], v[88:91], v[120:123], v[24:39]
  ds_read_b128 v[112:115], v185 offset:35840
  v_mfma_f32_32x32x16_bf16 v[40:55], v[92:95], v[120:123], v[40:55]
  ds_read_b128 v[116:119], v185 offset:36864
  s_waitcnt lgkmcnt(4)
  v_mfma_f32_32x32x16_bf16 v[56:71], v[96:99], v[120:123], v[56:71]
  ds_read_b128 v[88:91], v185 offset:37888
  v_mfma_f32_32x32x16_bf16 v[72:87], v[100:103], a[0:3], 0
  ds_read_b128 v[92:95], v185 offset:38912
  s_waitcnt lgkmcnt(4)
  v_mfma_f32_32x32x16_bf16 v[72:87], v[104:107], a[4:7], v[72:87]
  ds_read_b128 v[96:99], v185 offset:39936
  s_barrier
  v_mfma_f32_32x32x16_bf16 v[72:87], v[108:111], a[8:11], v[72:87]
  ds_read_b128 v[100:103], v185 offset:40960
  v_fma_f32 v176, v187, v24, v198
  v_fma_f32 v177, v187, v25, v198
  v_fma_f32 v178, v187, v26, v198
  v_fma_f32 v179, v187, v27, v198
  s_waitcnt lgkmcnt(4)
  v_mfma_f32_32x32x16_bf16 v[72:87], v[112:115], a[12:15], v[72:87]
  ds_read_b128 v[104:107], v185 offset:41984
  s_mov_b32 m0, s28
  s_nop 0
  buffer_load_dwordx4 v1, s[4:7], s33 offen sc1 lds
  v_mfma_f32_32x32x16_bf16 v[72:87], v[116:119], a[16:19], v[72:87]
  ds_read_b128 v[108:111], v185 offset:43008
  v_fma_f32 v180, v187, v28, v198
  v_fma_f32 v181, v187, v29, v198
  v_fma_f32 v182, v187, v30, v198
  v_fma_f32 v183, v187, v31, v198
  s_waitcnt lgkmcnt(4)
  v_mfma_f32_32x32x16_bf16 v[72:87], v[88:91], a[20:23], v[72:87]
  ds_read_b128 v[112:115], v185 offset:44032
  v_exp_f32 v176, v176
  v_mul_f32 v24, v24, v32
  v_mfma_f32_32x32x16_bf16 v[72:87], v[92:95], a[24:27], v[72:87]
  ds_read_b128 v[116:119], v185 offset:45056
  buffer_load_dwordx4 v1, s[4:7], s33 offen offset:1024 sc1 lds
  v_exp_f32 v177, v177
  s_waitcnt lgkmcnt(4)
  v_mfma_f32_32x32x16_bf16 v[72:87], v[96:99], a[28:31], v[72:87]
  ds_read_b128 v[88:91], v185 offset:46080
  v_mul_f32 v25, v25, v33
  v_add_f32 v176, v188, v176
  v_exp_f32 v178, v178
  v_mfma_f32_32x32x16_bf16 v[72:87], v[100:103], a[32:35], v[72:87]
  ds_read_b128 v[92:95], v185 offset:47104
  v_mul_f32 v26, v26, v34
  v_add_f32 v177, v188, v177
  v_exp_f32 v179, v179
  s_waitcnt lgkmcnt(4)
  v_mfma_f32_32x32x16_bf16 v[72:87], v[104:107], a[36:39], v[72:87]
  ds_read_b128 v[96:99], v185 offset:48128
  s_add_u32 m0, s48, 65536
  s_add_u32 s29, s47, 163840
  buffer_load_dwordx4 v1, s[4:7], s29 offen offset:0 sc1 lds
  v_mfma_f32_32x32x16_bf16 v[72:87], v[108:111], a[40:43], v[72:87]
  ds_read_b128 v[100:103], v185 offset:49152
  v_mul_f32 v27, v27, v35
  v_add_f32 v178, v188, v178
  v_exp_f32 v180, v180
  s_waitcnt lgkmcnt(4)
  v_mfma_f32_32x32x16_bf16 v[72:87], v[112:115], a[44:47], v[72:87]
  ds_read_b128 v[104:107], v185 offset:50176
  v_mul_f32 v28, v28, v36
  v_add_f32 v179, v188, v179
  v_exp_f32 v181, v181
  v_mfma_f32_32x32x16_bf16 v[72:87], v[116:119], a[48:51], v[72:87]
  ds_read_b128 v[108:111], v185 offset:51200
  buffer_load_dwordx4 v1, s[4:7], s29 offen offset:1024 sc1 lds
  v_mul_f32 v29, v29, v37
  v_add_f32 v180, v188, v180
  s_waitcnt lgkmcnt(4)
  v_mfma_f32_32x32x16_bf16 v[72:87], v[88:91], a[52:55], v[72:87]
  ds_read_b128 v[112:115], v185 offset:52224
  v_exp_f32 v182, v182
  v_mul_f32 v30, v30, v38
  v_add_f32 v181, v188, v181
  v_mfma_f32_32x32x16_bf16 v[72:87], v[92:95], a[56:59], v[72:87]
  ds_read_b128 v[116:119], v185 offset:53248
  v_exp_f32 v183, v183
  v_mul_f32 v31, v31, v39
  v_add_f32 v182, v188, v182
  s_waitcnt lgkmcnt(4)
  v_mfma_f32_32x32x16_bf16 v[72:87], v[96:99], a[60:63], v[72:87]
  ds_read_b128 v[88:91], v185 offset:54272
  buffer_load_dwordx4 v1, s[4:7], s29 offen offset:2048 sc1 lds
  v_add_f32 v183, v188, v183
  v_mfma_f32_32x32x16_bf16 v[72:87], v[100:103], a[64:67], v[72:87]
  ds_read_b128 v[92:95], v185 offset:55296
  v_rcp_f32 v176, v176
  v_rcp_f32 v177, v177
  s_waitcnt lgkmcnt(4)
  v_mfma_f32_32x32x16_bf16 v[72:87], v[104:107], a[68:71], v[72:87]
  ds_read_b128 v[96:99], v185 offset:56320
  v_mul_f32 v24, v176, v24
  v_rcp_f32 v178, v178
  v_mul_f32 v25, v177, v25
  v_mfma_f32_32x32x16_bf16 v[72:87], v[108:111], a[72:75], v[72:87]
  ds_read_b128 v[100:103], v185 offset:57344
  buffer_load_dwordx4 v1, s[4:7], s29 offen offset:3072 sc1 lds
  v_rcp_f32 v179, v179
  s_waitcnt lgkmcnt(4)
  v_mfma_f32_32x32x16_bf16 v[72:87], v[112:115], a[76:79], v[72:87]
  ds_read_b128 v[104:107], v185 offset:58368
  v_mul_f32 v26, v178, v26
  v_rcp_f32 v180, v180
  v_mul_f32 v27, v179, v27
  v_mfma_f32_32x32x16_bf16 v[72:87], v[116:119], a[80:83], v[72:87]
  ds_read_b128 v[108:111], v185 offset:59392
  v_rcp_f32 v181, v181
  v_mul_f32 v28, v180, v28
  s_waitcnt lgkmcnt(4)
  v_mfma_f32_32x32x16_bf16 v[72:87], v[88:91], a[84:87], v[72:87]
  ds_read_b128 v[112:115], v185 offset:60416
  s_add_u32 m0, s48, 69632
  s_add_u32 s29, s47, 167936
  buffer_load_dwordx4 v1, s[4:7], s29 offen offset:0 sc1 lds
  v_mfma_f32_32x32x16_bf16 v[72:87], v[92:95], a[88:91], v[72:87]
  ds_read_b128 v[116:119], v185 offset:61440
  v_rcp_f32 v182, v182
  v_mul_f32 v29, v181, v29
  s_waitcnt lgkmcnt(4)
  v_mfma_f32_32x32x16_bf16 v[72:87], v[96:99], a[92:95], v[72:87]
  ds_read_b128 v[88:91], v185 offset:62464
  v_rcp_f32 v183, v183
  v_mul_f32 v30, v182, v30
  v_mul_f32 v31, v183, v31
  v_mfma_f32_32x32x16_bf16 v[72:87], v[100:103], a[96:99], v[72:87]
  ds_read_b128 v[92:95], v185 offset:63488
  buffer_load_dwordx4 v1, s[4:7], s29 offen offset:1024 sc1 lds
  v_cvt_pk_bf16_f32 v128, v24, v25
  v_cvt_pk_bf16_f32 v129, v26, v27
  s_waitcnt lgkmcnt(4)
  v_mfma_f32_32x32x16_bf16 v[72:87], v[104:107], a[100:103], v[72:87]
  ds_read_b128 v[96:99], v185 offset:64512
  v_cvt_pk_bf16_f32 v130, v28, v29
  v_cvt_pk_bf16_f32 v131, v30, v31
  buffer_store_dwordx4 v[128:131], v1, s[4:7], s27 offen offset:0 sc1
  v_mfma_f32_32x32x16_bf16 v[72:87], v[108:111], a[104:107], v[72:87]
  ds_read_b128 v[100:103], v189 offset:27648
  v_fma_f32 v176, v187, v40, v198
  v_fma_f32 v177, v187, v41, v198
  v_fma_f32 v178, v187, v42, v198
  v_fma_f32 v179, v187, v43, v198
  s_waitcnt lgkmcnt(4)
  v_mfma_f32_32x32x16_bf16 v[72:87], v[112:115], a[108:111], v[72:87]
  ds_read_b128 v[104:107], v189 offset:0
  buffer_load_dwordx4 v1, s[4:7], s29 offen offset:2048 sc1 lds
  v_fma_f32 v180, v187, v44, v198
  v_fma_f32 v181, v187, v45, v198
  v_mfma_f32_32x32x16_bf16 v[72:87], v[116:119], a[112:115], v[72:87]
  ds_read_b128 v[108:111], v189 offset:1024
  v_fma_f32 v182, v187, v46, v198
  v_fma_f32 v183, v187, v47, v198
  v_exp_f32 v176, v176
  s_waitcnt lgkmcnt(4)
  v_mfma_f32_32x32x16_bf16 v[72:87], v[88:91], a[116:119], v[72:87]
  ds_read_b128 v[112:115], v189 offset:2048
  v_mul_f32 v40, v40, v48
  v_exp_f32 v177, v177
  v_mul_f32 v41, v41, v49
  v_mfma_f32_32x32x16_bf16 v[72:87], v[92:95], a[120:123], v[72:87]
  ds_read_b128 v[116:119], v189 offset:3072
  buffer_load_dwordx4 v1, s[4:7], s29 offen offset:3072 sc1 lds
  v_add_f32 v176, v188, v176
  s_waitcnt lgkmcnt(4)
  v_mfma_f32_32x32x16_bf16 v[72:87], v[96:99], a[124:127], v[72:87]
  ds_read_b128 v[88:91], v189 offset:4096
  v_exp_f32 v178, v178
  v_mul_f32 v42, v42, v50
  v_add_f32 v177, v188, v177
  v_mfma_f32_32x32x16_bf16 v[72:87], v[100:103], v[120:123], v[72:87]
  ds_read_b128 v[92:95], v189 offset:5120
  v_exp_f32 v179, v179
  v_mul_f32 v43, v43, v51
  v_add_f32 v178, v188, v178
  s_waitcnt lgkmcnt(4)
  v_mfma_f32_32x32x16_bf16 v[24:39], v[104:107], a[0:3], 0
  ds_read_b128 v[96:99], v189 offset:6144
  s_add_u32 m0, s48, 32768
  s_add_u32 s29, s47, 196608
  buffer_load_dwordx4 v1, s[4:7], s29 offen offset:0 sc1 lds
  v_mfma_f32_32x32x16_bf16 v[24:39], v[108:111], a[4:7], v[24:39]
  ds_read_b128 v[100:103], v189 offset:7168
  v_exp_f32 v180, v180
  v_mul_f32 v44, v44, v52
  v_add_f32 v179, v188, v179
  s_waitcnt lgkmcnt(4)
  v_mfma_f32_32x32x16_bf16 v[24:39], v[112:115], a[8:11], v[24:39]
  ds_read_b128 v[104:107], v189 offset:8192
  v_exp_f32 v181, v181
  v_mul_f32 v45, v45, v53
  v_add_f32 v180, v188, v180
  v_mfma_f32_32x32x16_bf16 v[24:39], v[116:119], a[12:15], v[24:39]
  ds_read_b128 v[108:111], v189 offset:9216
  buffer_load_dwordx4 v1, s[4:7], s29 offen offset:1024 sc1 lds
  v_exp_f32 v182, v182
  s_waitcnt lgkmcnt(4)
  v_mfma_f32_32x32x16_bf16 v[24:39], v[88:91], a[16:19], v[24:39]
  ds_read_b128 v[112:115], v189 offset:10240
  v_mul_f32 v46, v46, v54
  v_add_f32 v181, v188, v181
  v_exp_f32 v183, v183
  v_mfma_f32_32x32x16_bf16 v[24:39], v[92:95], a[20:23], v[24:39]
  ds_read_b128 v[116:119], v189 offset:11264
  v_mul_f32 v47, v47, v55
  v_add_f32 v182, v188, v182
  v_add_f32 v183, v188, v183
  s_waitcnt lgkmcnt(4)
  v_mfma_f32_32x32x16_bf16 v[24:39], v[96:99], a[24:27], v[24:39]
  ds_read_b128 v[88:91], v189 offset:12288
  buffer_load_dwordx4 v1, s[4:7], s29 offen offset:2048 sc1 lds
  v_rcp_f32 v176, v176
  v_mfma_f32_32x32x16_bf16 v[24:39], v[100:103], a[28:31], v[24:39]
  ds_read_b128 v[92:95], v189 offset:13312
  v_rcp_f32 v177, v177
  v_mul_f32 v40, v176, v40
  s_waitcnt lgkmcnt(4)
  v_mfma_f32_32x32x16_bf16 v[24:39], v[104:107], a[32:35], v[24:39]
  ds_read_b128 v[96:99], v189 offset:14336
  v_rcp_f32 v178, v178
  v_mul_f32 v41, v177, v41
  v_mfma_f32_32x32x16_bf16 v[24:39], v[108:111], a[36:39], v[24:39]
  ds_read_b128 v[100:103], v189 offset:15360
  buffer_load_dwordx4 v1, s[4:7], s29 offen offset:3072 sc1 lds
  v_rcp_f32 v179, v179
  s_waitcnt lgkmcnt(4)
  v_mfma_f32_32x32x16_bf16 v[24:39], v[112:115], a[40:43], v[24:39]
  ds_read_b128 v[104:107], v189 offset:16384
  v_mul_f32 v42, v178, v42
  v_rcp_f32 v180, v180
  v_mul_f32 v43, v179, v43
  v_mfma_f32_32x32x16_bf16 v[24:39], v[116:119], a[44:47], v[24:39]
  ds_read_b128 v[108:111], v189 offset:17408
  v_rcp_f32 v181, v181
  v_mul_f32 v44, v180, v44
  s_waitcnt lgkmcnt(4)
  v_mfma_f32_32x32x16_bf16 v[24:39], v[88:91], a[48:51], v[24:39]
  ds_read_b128 v[112:115], v189 offset:18432
  s_add_u32 m0, s48, 36864
  s_add_u32 s29, s47, 200704
  buffer_load_dwordx4 v1, s[4:7], s29 offen offset:0 sc1 lds
  v_mfma_f32_32x32x16_bf16 v[24:39], v[92:95], a[52:55], v[24:39]
  ds_read_b128 v[116:119], v189 offset:19456
  v_rcp_f32 v182, v182
  v_mul_f32 v45, v181, v45
  s_waitcnt lgkmcnt(4)
  v_mfma_f32_32x32x16_bf16 v[24:39], v[96:99], a[56:59], v[24:39]
  ds_read_b128 v[88:91], v189 offset:20480
  v_rcp_f32 v183, v183
  v_mul_f32 v46, v182, v46
  v_mul_f32 v47, v183, v47
  v_mfma_f32_32x32x16_bf16 v[24:39], v[100:103], a[60:63], v[24:39]
  ds_read_b128 v[92:95], v189 offset:21504
  buffer_load_dwordx4 v1, s[4:7], s29 offen offset:1024 sc1 lds
  v_cvt_pk_bf16_f32 v132, v40, v41
  v_cvt_pk_bf16_f32 v133, v42, v43
  s_waitcnt lgkmcnt(4)
  v_mfma_f32_32x32x16_bf16 v[24:39], v[104:107], a[64:67], v[24:39]
  ds_read_b128 v[96:99], v189 offset:22528
  v_cvt_pk_bf16_f32 v134, v44, v45
  v_cvt_pk_bf16_f32 v135, v46, v47
  buffer_store_dwordx4 v[132:135], v1, s[4:7], s27 offen offset:1024 sc1
  v_mfma_f32_32x32x16_bf16 v[24:39], v[108:111], a[68:71], v[24:39]
  ds_read_b128 v[100:103], v189 offset:23552
  v_fma_f32 v176, v187, v56, v198
  v_fma_f32 v177, v187, v57, v198
  v_fma_f32 v178, v187, v58, v198
  v_fma_f32 v179, v187, v59, v198
  s_waitcnt lgkmcnt(4)
  v_mfma_f32_32x32x16_bf16 v[24:39], v[112:115], a[72:75], v[24:39]
  s_waitcnt vmcnt(6)
  s_barrier
  ds_read_b128 v[104:107], v184 offset:0
  buffer_load_dwordx4 v1, s[4:7], s29 offen offset:2048 sc1 lds
  v_fma_f32 v180, v187, v60, v198
  v_fma_f32 v181, v187, v61, v198
  v_mfma_f32_32x32x16_bf16 v[24:39], v[116:119], a[76:79], v[24:39]
  ds_read_b128 v[108:111], v184 offset:1024
  v_fma_f32 v182, v187, v62, v198
  v_fma_f32 v183, v187, v63, v198
  v_exp_f32 v176, v176
  s_waitcnt lgkmcnt(4)
  v_mfma_f32_32x32x16_bf16 v[24:39], v[88:91], a[80:83], v[24:39]
  ds_read_b128 v[112:115], v184 offset:2048
  v_mul_f32 v56, v56, v64
  v_exp_f32 v177, v177
  v_mul_f32 v57, v57, v65
  v_mfma_f32_32x32x16_bf16 v[24:39], v[92:95], a[84:87], v[24:39]
  ds_read_b128 v[116:119], v184 offset:3072
  buffer_load_dwordx4 v1, s[4:7], s29 offen offset:3072 sc1 lds
  v_add_f32 v176, v188, v176
  s_waitcnt lgkmcnt(4)
  v_mfma_f32_32x32x16_bf16 v[24:39], v[96:99], a[88:91], v[24:39]
  ds_read_b128 v[88:91], v184 offset:4096
  v_exp_f32 v178, v178
  v_mul_f32 v58, v58, v66
  v_add_f32 v177, v188, v177
  v_mfma_f32_32x32x16_bf16 v[24:39], v[100:103], a[92:95], v[24:39]
  ds_read_b128 v[92:95], v184 offset:5120
  v_exp_f32 v179, v179
  v_mul_f32 v59, v59, v67
  v_add_f32 v178, v188, v178
  s_waitcnt lgkmcnt(4)
  v_mfma_f32_32x32x16_bf16 v[24:39], v[104:107], a[96:99], v[24:39]
  ds_read_b128 v[96:99], v184 offset:6144
  buffer_load_dwordx4 v[136:139], v10, s[4:7], s53 offen offset:2048 sc1
  v_exp_f32 v180, v180
  v_mfma_f32_32x32x16_bf16 v[24:39], v[108:111], a[100:103], v[24:39]
  ds_read_b128 v[100:103], v184 offset:7168
  v_mul_f32 v60, v60, v68
  v_add_f32 v179, v188, v179
  v_exp_f32 v181, v181
  s_waitcnt lgkmcnt(4)
  v_mfma_f32_32x32x16_bf16 v[24:39], v[112:115], a[104:107], v[24:39]
  ds_read_b128 v[104:107], v189 offset:28672
  v_mul_f32 v61, v61, v69
  v_add_f32 v180, v188, v180
  v_exp_f32 v182, v182
  v_mfma_f32_32x32x16_bf16 v[24:39], v[116:119], a[108:111], v[24:39]
  ds_read_b128 v[108:111], v185 offset:0
  buffer_load_dwordx4 v[140:143], v10, s[4:7], s54 offen offset:2048 sc1
  v_mul_f32 v62, v62, v70
  v_add_f32 v181, v188, v181
  s_waitcnt lgkmcnt(4)
  v_mfma_f32_32x32x16_bf16 v[24:39], v[88:91], a[112:115], v[24:39]
  ds_read_b128 v[112:115], v185 offset:1024
  v_exp_f32 v183, v183
  v_mul_f32 v63, v63, v71
  v_add_f32 v182, v188, v182
  v_mfma_f32_32x32x16_bf16 v[24:39], v[92:95], a[116:119], v[24:39]
  ds_read_b128 v[116:119], v185 offset:2048
  v_add_f32 v183, v188, v183
  v_rcp_f32 v176, v176
  s_waitcnt lgkmcnt(4)
  v_mfma_f32_32x32x16_bf16 v[24:39], v[96:99], a[120:123], v[24:39]
  ds_read_b128 v[88:91], v185 offset:3072
  buffer_load_dwordx4 v[144:147], v5, s[4:7], s53 offen offset:2048 sc1
  v_rcp_f32 v177, v177
  v_mfma_f32_32x32x16_bf16 v[24:39], v[100:103], a[124:127], v[24:39]
  ds_read_b128 v[92:95], v185 offset:4096
  v_mul_f32 v56, v176, v56
  v_rcp_f32 v178, v178
  v_mul_f32 v57, v177, v57
  s_waitcnt lgkmcnt(4)
  v_mfma_f32_32x32x16_bf16 v[24:39], v[104:107], v[120:123], v[24:39]
  ds_read_b128 v[96:99], v185 offset:5120
  v_rcp_f32 v179, v179
  v_mul_f32 v58, v178, v58
  v_mfma_f32_32x32x16_bf16 v[40:55], v[108:111], a[0:3], 0
  ds_read_b128 v[100:103], v185 offset:6144
  buffer_load_dwordx4 v[148:151], v5, s[4:7], s54 offen offset:2048 sc1
  v_rcp_f32 v180, v180
  s_waitcnt lgkmcnt(4)
  v_mfma_f32_32x32x16_bf16 v[40:55], v[112:115], a[4:7], v[40:55]
  ds_read_b128 v[104:107], v185 offset:7168
  v_mul_f32 v59, v179, v59
  v_rcp_f32 v181, v181
  v_mul_f32 v60, v180, v60
  v_mfma_f32_32x32x16_bf16 v[40:55], v[116:119], a[8:11], v[40:55]
  ds_read_b128 v[108:111], v185 offset:8192
  v_rcp_f32 v182, v182
  v_mul_f32 v61, v181, v61
  s_waitcnt lgkmcnt(4)
  v_mfma_f32_32x32x16_bf16 v[40:55], v[88:91], a[12:15], v[40:55]
  ds_read_b128 v[112:115], v185 offset:9216
  buffer_load_dwordx4 v[152:155], v7, s[4:7], s53 offen offset:1024 sc1
  v_rcp_f32 v183, v183
  v_mfma_f32_32x32x16_bf16 v[40:55], v[92:95], a[16:19], v[40:55]
  ds_read_b128 v[116:119], v185 offset:10240
  v_mul_f32 v62, v182, v62
  v_mul_f32 v63, v183, v63
  v_cvt_pk_bf16_f32 v128, v56, v57
  v_cvt_pk_bf16_f32 v129, v58, v59
  s_waitcnt lgkmcnt(4)
  v_mfma_f32_32x32x16_bf16 v[40:55], v[96:99], a[20:23], v[40:55]
  ds_read_b128 v[88:91], v185 offset:11264
  v_cvt_pk_bf16_f32 v130, v60, v61
  v_cvt_pk_bf16_f32 v131, v62, v63
  buffer_store_dwordx4 v[128:131], v1, s[4:7], s27 offen offset:2048 sc1
  v_mfma_f32_32x32x16_bf16 v[40:55], v[100:103], a[24:27], v[40:55]
  ds_read_b128 v[92:95], v185 offset:12288
  buffer_load_dwordx4 v[156:159], v7, s[4:7], s54 offen offset:1024 sc1
  v_fma_f32 v176, v187, v72, v198
  v_fma_f32 v177, v187, v73, v198
  s_waitcnt lgkmcnt(4)
  v_mfma_f32_32x32x16_bf16 v[40:55], v[104:107], a[28:31], v[40:55]
  ds_read_b128 v[96:99], v185 offset:13312
  v_fma_f32 v178, v187, v74, v198
  v_fma_f32 v179, v187, v75, v198
  v_fma_f32 v180, v187, v76, v198
  v_fma_f32 v181, v187, v77, v198
  v_mfma_f32_32x32x16_bf16 v[40:55], v[108:111], a[32:35], v[40:55]
  ds_read_b128 v[100:103], v185 offset:14336
  v_fma_f32 v182, v187, v78, v198
  v_fma_f32 v183, v187, v79, v198
  v_exp_f32 v176, v176
  s_waitcnt lgkmcnt(4)
  v_mfma_f32_32x32x16_bf16 v[40:55], v[112:115], a[36:39], v[40:55]
  ds_read_b128 v[104:107], v185 offset:15360
  buffer_load_dwordx4 v[160:163], v9, s[4:7], s53 offen offset:0 sc1
  v_mul_f32 v72, v72, v80
  v_mfma_f32_32x32x16_bf16 v[40:55], v[116:119], a[40:43], v[40:55]
  ds_read_b128 v[108:111], v185 offset:16384
  v_exp_f32 v177, v177
  v_mul_f32 v73, v73, v81
  v_add_f32 v176, v188, v176
  s_waitcnt lgkmcnt(4)
  v_mfma_f32_32x32x16_bf16 v[40:55], v[88:91], a[44:47], v[40:55]
  ds_read_b128 v[112:115], v185 offset:17408
  v_exp_f32 v178, v178
  v_mul_f32 v74, v74, v82
  v_add_f32 v177, v188, v177
  v_mfma_f32_32x32x16_bf16 v[40:55], v[92:95], a[48:51], v[40:55]
  ds_read_b128 v[116:119], v185 offset:18432
  buffer_load_dwordx4 v[164:167], v9, s[4:7], s54 offen offset:0 sc1
  v_exp_f32 v179, v179
  s_waitcnt lgkmcnt(4)
  v_mfma_f32_32x32x16_bf16 v[40:55], v[96:99], a[52:55], v[40:55]
  ds_read_b128 v[88:91], v185 offset:19456
  v_mul_f32 v75, v75, v83
  v_add_f32 v178, v188, v178
  v_exp_f32 v180, v180
  v_mfma_f32_32x32x16_bf16 v[40:55], v[100:103], a[56:59], v[40:55]
  ds_read_b128 v[92:95], v185 offset:20480
  v_mul_f32 v76, v76, v84
  v_add_f32 v179, v188, v179
  v_exp_f32 v181, v181
  s_waitcnt lgkmcnt(4)
  v_mfma_f32_32x32x16_bf16 v[40:55], v[104:107], a[60:63], v[40:55]
  ds_read_b128 v[96:99], v185 offset:21504
  buffer_load_dwordx4 v[190:193], v10, s[4:7], s53 offen offset:3072 sc1
  v_mul_f32 v77, v77, v85
  v_add_f32 v180, v188, v180
  v_mfma_f32_32x32x16_bf16 v[40:55], v[108:111], a[64:67], v[40:55]
  ds_read_b128 v[100:103], v185 offset:22528
  v_exp_f32 v182, v182
  v_mul_f32 v78, v78, v86
  v_add_f32 v181, v188, v181
  s_waitcnt lgkmcnt(4)
  v_mfma_f32_32x32x16_bf16 v[40:55], v[112:115], a[68:71], v[40:55]
  ds_read_b128 v[104:107], v185 offset:23552
  v_exp_f32 v183, v183
  v_mul_f32 v79, v79, v87
  v_add_f32 v182, v188, v182
  v_mfma_f32_32x32x16_bf16 v[40:55], v[116:119], a[72:75], v[40:55]
  ds_read_b128 v[108:111], v185 offset:24576
  buffer_load_dwordx4 v[194:197], v10, s[4:7], s54 offen offset:3072 sc1
  v_add_f32 v183, v188, v183
  s_waitcnt lgkmcnt(4)
  v_mfma_f32_32x32x16_bf16 v[40:55], v[88:91], a[76:79], v[40:55]
  ds_read_b128 v[112:115], v185 offset:25600
  v_rcp_f32 v176, v176
  v_rcp_f32 v177, v177
  v_mfma_f32_32x32x16_bf16 v[40:55], v[92:95], a[80:83], v[40:55]
  ds_read_b128 v[116:119], v185 offset:26624
  v_mul_f32 v72, v176, v72
  v_rcp_f32 v178, v178
  v_mul_f32 v73, v177, v73
  s_waitcnt lgkmcnt(4)
  v_mfma_f32_32x32x16_bf16 v[40:55], v[96:99], a[84:87], v[40:55]
  ds_read_b128 v[88:91], v185 offset:27648
  v_rcp_f32 v179, v179
  v_mul_f32 v74, v178, v74
  v_mfma_f32_32x32x16_bf16 v[40:55], v[100:103], a[88:91], v[40:55]
  ds_read_b128 v[92:95], v185 offset:28672
  v_rcp_f32 v180, v180
  v_mul_f32 v75, v179, v75
  s_waitcnt lgkmcnt(4)
  v_mfma_f32_32x32x16_bf16 v[40:55], v[104:107], a[92:95], v[40:55]
  ds_read_b128 v[96:99], v185 offset:29696
  v_rcp_f32 v181, v181
  v_mul_f32 v76, v180, v76
  v_mfma_f32_32x32x16_bf16 v[40:55], v[108:111], a[96:99], v[40:55]
  ds_read_b128 v[100:103], v185 offset:30720
  v_rcp_f32 v182, v182
  v_mul_f32 v77, v181, v77
  s_waitcnt lgkmcnt(4)
  v_mfma_f32_32x32x16_bf16 v[40:55], v[112:115], a[100:103], v[40:55]
  ds_read_b128 v[104:107], v185 offset:31744
  v_rcp_f32 v183, v183
  v_mul_f32 v78, v182, v78
  v_mul_f32 v79, v183, v79
  v_mfma_f32_32x32x16_bf16 v[40:55], v[116:119], a[104:107], v[40:55]
  ds_read_b128 v[108:111], v189 offset:29696
  v_cvt_pk_bf16_f32 v132, v72, v73
  v_cvt_pk_bf16_f32 v133, v74, v75
  v_cvt_pk_bf16_f32 v134, v76, v77
  v_cvt_pk_bf16_f32 v135, v78, v79
  s_waitcnt lgkmcnt(4)
  v_mfma_f32_32x32x16_bf16 v[40:55], v[88:91], a[108:111], v[40:55]
  s_waitcnt vmcnt(10)
  s_barrier
  ds_read_b128 v[112:115], v184 offset:32768
  buffer_store_dwordx4 v[132:135], v1, s[4:7], s27 offen offset:3072 sc1
  v_fma_f32 v176, v187, v24, v198
  v_fma_f32 v177, v187, v25, v198
  v_mfma_f32_32x32x16_bf16 v[40:55], v[92:95], a[112:115], v[40:55]
  ds_read_b128 v[116:119], v184 offset:33792
  v_fma_f32 v178, v187, v26, v198
  v_fma_f32 v179, v187, v27, v198
  v_fma_f32 v180, v187, v28, v198
  v_fma_f32 v181, v187, v29, v198
  s_waitcnt lgkmcnt(4)
  v_mfma_f32_32x32x16_bf16 v[40:55], v[96:99], a[116:119], v[40:55]
  ds_read_b128 v[88:91], v184 offset:34816
  v_fma_f32 v182, v187, v30, v198
  v_fma_f32 v183, v187, v31, v198
  v_exp_f32 v176, v176
  v_mfma_f32_32x32x16_bf16 v[40:55], v[100:103], a[120:123], v[40:55]
  ds_read_b128 v[92:95], v184 offset:35840
  v_mul_f32 v24, v24, v32
  v_exp_f32 v177, v177
  v_mul_f32 v25, v25, v33
  s_waitcnt lgkmcnt(4)
  v_mfma_f32_32x32x16_bf16 v[40:55], v[104:107], a[124:127], v[40:55]
  ds_read_b128 v[96:99], v184 offset:36864
  v_add_f32 v176, v188, v176
  v_exp_f32 v178, v178
  v_mul_f32 v26, v26, v34
  v_mfma_f32_32x32x16_bf16 v[40:55], v[108:111], v[120:123], v[40:55]
  ds_read_b128 v[100:103], v184 offset:37888
  v_add_f32 v177, v188, v177
  v_exp_f32 v179, v179
  v_mul_f32 v27, v27, v35
  s_waitcnt lgkmcnt(4)
  v_mfma_f32_32x32x16_bf16 v[56:71], v[112:115], a[0:3], 0
  ds_read_b128 v[104:107], v184 offset:38912
  v_add_f32 v178, v188, v178
  v_exp_f32 v180, v180
  v_mul_f32 v28, v28, v36
  v_mfma_f32_32x32x16_bf16 v[56:71], v[116:119], a[4:7], v[56:71]
  ds_read_b128 v[108:111], v184 offset:39936
  v_add_f32 v179, v188, v179
  v_exp_f32 v181, v181
  v_mul_f32 v29, v29, v37
  s_waitcnt lgkmcnt(4)
  v_mfma_f32_32x32x16_bf16 v[56:71], v[88:91], a[8:11], v[56:71]
  ds_read_b128 v[112:115], v184 offset:40960
  v_add_f32 v180, v188, v180
  v_exp_f32 v182, v182
  v_mul_f32 v30, v30, v38
  v_mfma_f32_32x32x16_bf16 v[56:71], v[92:95], a[12:15], v[56:71]
  ds_read_b128 v[116:119], v184 offset:41984
  v_add_f32 v181, v188, v181
  v_exp_f32 v183, v183
  v_mul_f32 v31, v31, v39
  s_waitcnt lgkmcnt(4)
  v_mfma_f32_32x32x16_bf16 v[56:71], v[96:99], a[16:19], v[56:71]
  ds_read_b128 v[88:91], v184 offset:43008
  v_add_f32 v182, v188, v182
  v_add_f32 v183, v188, v183
  v_rcp_f32 v176, v176
  v_mfma_f32_32x32x16_bf16 v[56:71], v[100:103], a[20:23], v[56:71]
  ds_read_b128 v[92:95], v184 offset:44032
  v_rcp_f32 v177, v177
  v_mul_f32 v24, v176, v24
  s_waitcnt lgkmcnt(4)
  v_mfma_f32_32x32x16_bf16 v[56:71], v[104:107], a[24:27], v[56:71]
  ds_read_b128 v[96:99], v184 offset:45056
  v_rcp_f32 v178, v178
  v_mul_f32 v25, v177, v25
  v_mfma_f32_32x32x16_bf16 v[56:71], v[108:111], a[28:31], v[56:71]
  ds_read_b128 v[100:103], v184 offset:46080
  v_rcp_f32 v179, v179
  v_mul_f32 v26, v178, v26
  s_waitcnt lgkmcnt(4)
  v_mfma_f32_32x32x16_bf16 v[56:71], v[112:115], a[32:35], v[56:71]
  ds_read_b128 v[104:107], v184 offset:47104
  v_rcp_f32 v180, v180
  v_mul_f32 v27, v179, v27
  v_mfma_f32_32x32x16_bf16 v[56:71], v[116:119], a[36:39], v[56:71]
  ds_read_b128 v[108:111], v184 offset:48128
  v_rcp_f32 v181, v181
  v_mul_f32 v28, v180, v28
  s_waitcnt lgkmcnt(4)
  v_mfma_f32_32x32x16_bf16 v[56:71], v[88:91], a[40:43], v[56:71]
  ds_read_b128 v[112:115], v184 offset:49152
  v_rcp_f32 v182, v182
  v_mul_f32 v29, v181, v29
  v_mfma_f32_32x32x16_bf16 v[56:71], v[92:95], a[44:47], v[56:71]
  ds_read_b128 v[116:119], v184 offset:50176
  v_rcp_f32 v183, v183
  v_mul_f32 v30, v182, v30
  v_mul_f32 v31, v183, v31
  s_waitcnt lgkmcnt(4)
  v_mfma_f32_32x32x16_bf16 v[56:71], v[96:99], a[48:51], v[56:71]
  ds_read_b128 v[88:91], v184 offset:51200
  v_cvt_pk_bf16_f32 v128, v24, v25
  v_cvt_pk_bf16_f32 v129, v26, v27
  v_cvt_pk_bf16_f32 v130, v28, v29
  v_cvt_pk_bf16_f32 v131, v30, v31
  v_mfma_f32_32x32x16_bf16 v[56:71], v[100:103], a[52:55], v[56:71]
  ds_read_b128 v[92:95], v184 offset:52224
  buffer_store_dwordx4 v[128:131], v5, s[4:7], s27 offen offset:0 sc1
  v_fma_f32 v176, v187, v40, v198
  v_fma_f32 v177, v187, v41, v198
  s_waitcnt lgkmcnt(4)
  v_mfma_f32_32x32x16_bf16 v[56:71], v[104:107], a[56:59], v[56:71]
  ds_read_b128 v[96:99], v184 offset:53248
  v_fma_f32 v178, v187, v42, v198
  v_fma_f32 v179, v187, v43, v198
  v_fma_f32 v180, v187, v44, v198
  v_fma_f32 v181, v187, v45, v198
  v_mfma_f32_32x32x16_bf16 v[56:71], v[108:111], a[60:63], v[56:71]
  ds_read_b128 v[100:103], v184 offset:54272
  v_fma_f32 v182, v187, v46, v198
  v_fma_f32 v183, v187, v47, v198
  v_exp_f32 v176, v176
  s_waitcnt lgkmcnt(4)
  v_mfma_f32_32x32x16_bf16 v[56:71], v[112:115], a[64:67], v[56:71]
  ds_read_b128 v[104:107], v184 offset:55296
  v_mul_f32 v40, v40, v48
  v_exp_f32 v177, v177
  v_mul_f32 v41, v41, v49
  v_mfma_f32_32x32x16_bf16 v[56:71], v[116:119], a[68:71], v[56:71]
  ds_read_b128 v[108:111], v184 offset:56320
  v_add_f32 v176, v188, v176
  v_exp_f32 v178, v178
  v_mul_f32 v42, v42, v50
  s_waitcnt lgkmcnt(4)
  v_mfma_f32_32x32x16_bf16 v[56:71], v[88:91], a[72:75], v[56:71]
  ds_read_b128 v[112:115], v184 offset:57344
  v_add_f32 v177, v188, v177
  v_exp_f32 v179, v179
  v_mul_f32 v43, v43, v51
  v_mfma_f32_32x32x16_bf16 v[56:71], v[92:95], a[76:79], v[56:71]
  ds_read_b128 v[116:119], v184 offset:58368
  v_add_f32 v178, v188, v178
  v_exp_f32 v180, v180
  v_mul_f32 v44, v44, v52
  s_waitcnt lgkmcnt(4)
  v_mfma_f32_32x32x16_bf16 v[56:71], v[96:99], a[80:83], v[56:71]
  ds_read_b128 v[88:91], v184 offset:59392
  v_add_f32 v179, v188, v179
  v_exp_f32 v181, v181
  v_mul_f32 v45, v45, v53
  v_mfma_f32_32x32x16_bf16 v[56:71], v[100:103], a[84:87], v[56:71]
  ds_read_b128 v[92:95], v184 offset:60416
  v_add_f32 v180, v188, v180
  v_exp_f32 v182, v182
  v_mul_f32 v46, v46, v54
  s_waitcnt lgkmcnt(4)
  v_mfma_f32_32x32x16_bf16 v[56:71], v[104:107], a[88:91], v[56:71]
  ds_read_b128 v[96:99], v184 offset:61440
  v_add_f32 v181, v188, v181
  v_exp_f32 v183, v183
  v_mul_f32 v47, v47, v55
  v_mfma_f32_32x32x16_bf16 v[56:71], v[108:111], a[92:95], v[56:71]
  ds_read_b128 v[100:103], v184 offset:62464
  v_add_f32 v182, v188, v182
  v_add_f32 v183, v188, v183
  v_rcp_f32 v176, v176
  s_waitcnt lgkmcnt(4)
  v_mfma_f32_32x32x16_bf16 v[56:71], v[112:115], a[96:99], v[56:71]
  ds_read_b128 v[104:107], v184 offset:63488
  v_rcp_f32 v177, v177
  v_mul_f32 v40, v176, v40
  v_mfma_f32_32x32x16_bf16 v[56:71], v[116:119], a[100:103], v[56:71]
  ds_read_b128 v[108:111], v184 offset:64512
  v_rcp_f32 v178, v178
  v_mul_f32 v41, v177, v41
  s_waitcnt lgkmcnt(4)
  v_mfma_f32_32x32x16_bf16 v[56:71], v[88:91], a[104:107], v[56:71]
  ds_read_b128 v[112:115], v189 offset:30720
  v_rcp_f32 v179, v179
  v_mul_f32 v42, v178, v42
  v_mfma_f32_32x32x16_bf16 v[56:71], v[92:95], a[108:111], v[56:71]
  v_rcp_f32 v180, v180
  v_mul_f32 v43, v179, v43
  s_waitcnt lgkmcnt(3)
  v_mfma_f32_32x32x16_bf16 v[56:71], v[96:99], a[112:115], v[56:71]
  v_rcp_f32 v181, v181
  v_mul_f32 v44, v180, v44
  v_mfma_f32_32x32x16_bf16 v[56:71], v[100:103], a[116:119], v[56:71]
  v_rcp_f32 v182, v182
  v_mul_f32 v45, v181, v45
  s_waitcnt lgkmcnt(1)
  v_mfma_f32_32x32x16_bf16 v[56:71], v[104:107], a[120:123], v[56:71]
  v_rcp_f32 v183, v183
  v_mul_f32 v46, v182, v46
  v_mul_f32 v47, v183, v47
  v_mfma_f32_32x32x16_bf16 v[56:71], v[108:111], a[124:127], v[56:71]
  v_cvt_pk_bf16_f32 v132, v40, v41
  v_cvt_pk_bf16_f32 v133, v42, v43
  v_cvt_pk_bf16_f32 v134, v44, v45
  v_cvt_pk_bf16_f32 v135, v46, v47
  s_waitcnt lgkmcnt(0)
  v_mfma_f32_32x32x16_bf16 v[56:71], v[112:115], v[120:123], v[56:71]
  s_waitcnt vmcnt(0)
  s_mov_b64 exec, 1
  s_cmp_lg_u32 s57, 0
  s_cbranch_scc1 L_ls8a
  buffer_store_dword v11, v21, s[4:7], s42 offen offset:256 sc1
  s_branch L_ls8b
L_ls8a:
  buffer_store_dword v11, v21, s[4:7], s42 offen offset:256
L_ls8b:
  s_mov_b64 exec, -1
  buffer_store_dwordx4 v[132:135], v5, s[4:7], s27 offen offset:1024 sc1
  s_nop 4
  v_fma_f32 v176, v187, v56, v198
  v_fma_f32 v177, v187, v57, v198
  v_fma_f32 v178, v187, v58, v198
  v_fma_f32 v179, v187, v59, v198
  v_fma_f32 v180, v187, v60, v198
  v_fma_f32 v181, v187, v61, v198
  v_fma_f32 v182, v187, v62, v198
  v_fma_f32 v183, v187, v63, v198
  v_exp_f32 v176, v176
  v_mul_f32 v56, v56, v64
  v_exp_f32 v177, v177
  v_mul_f32 v57, v57, v65
  v_add_f32 v176, v188, v176
  v_exp_f32 v178, v178
  v_mul_f32 v58, v58, v66
  v_add_f32 v177, v188, v177
  v_exp_f32 v179, v179
  v_mul_f32 v59, v59, v67
  v_add_f32 v178, v188, v178
  v_exp_f32 v180, v180
  v_mul_f32 v60, v60, v68
  v_add_f32 v179, v188, v179
  v_exp_f32 v181, v181
  v_mul_f32 v61, v61, v69
  v_add_f32 v180, v188, v180
  v_exp_f32 v182, v182
  v_mul_f32 v62, v62, v70
  v_add_f32 v181, v188, v181
  v_exp_f32 v183, v183
  v_mul_f32 v63, v63, v71
  v_add_f32 v182, v188, v182
  v_add_f32 v183, v188, v183
  v_rcp_f32 v176, v176
  v_rcp_f32 v177, v177
  v_mul_f32 v56, v176, v56
  v_rcp_f32 v178, v178
  v_mul_f32 v57, v177, v57
  v_rcp_f32 v179, v179
  v_mul_f32 v58, v178, v58
  v_rcp_f32 v180, v180
  v_mul_f32 v59, v179, v59
  v_rcp_f32 v181, v181
  v_mul_f32 v60, v180, v60
  v_rcp_f32 v182, v182
  v_mul_f32 v61, v181, v61
  v_rcp_f32 v183, v183
  v_mul_f32 v62, v182, v62
  v_mul_f32 v63, v183, v63
  v_cvt_pk_bf16_f32 v128, v56, v57
  v_cvt_pk_bf16_f32 v129, v58, v59
  v_cvt_pk_bf16_f32 v130, v60, v61
  v_cvt_pk_bf16_f32 v131, v62, v63
  s_cmp_lg_u32 s57, 0
  s_cbranch_scc1 L_ls9a
  buffer_store_dwordx4 v[128:131], v5, s[4:7], s27 offen offset:2048 sc1
  s_branch L_ls9b
L_ls9a:
  buffer_store_dwordx4 v[128:131], v5, s[4:7], s27 offen offset:2048
L_ls9b:
  s_add_u32 s17, s27, 6144
  s_cmp_eq_u32 s57, 0
  s_cbranch_scc1 L_rb_9
  v_lshlrev_b32 v22, 6, v2
  s_mov_b32 exec_lo, 0xffff
  s_mov_b32 exec_hi, 0x0
  buffer_load_dword v199, v22, s[4:7], s17 offen offset:0 sc1
L_rb_9:
  s_waitcnt vmcnt(0)
  s_mov_b64 exec, 1
  s_cmp_lg_u32 s57, 0
  s_cbranch_scc1 L_ls10a
  buffer_store_dword v11, v21, s[4:7], s42 offen offset:0 sc1
  s_branch L_ls10b
L_ls10a:
  buffer_store_dword v11, v21, s[4:7], s42 offen offset:0
L_ls10b:
  s_mov_b64 exec, -1
  s_mov_b32 s28, 0xe00000
  s_mul_i32 s20, s12, 28672
  s_add_u32 s20, s20, s28
  s_mul_i32 s26, s31, 114688
  s_add_u32 s26, s26, s20
  s_xor_b32 s21, s31, 1
  s_mul_i32 s27, s21, 114688
  s_add_u32 s27, s27, s20
  s_xor_b32 s17, s12, 1
  s_mul_i32 s17, s17, 12288
  s_add_u32 s17, s17, 98304
  v_add_u32 v184, s17, v1
  s_xor_b32 s17, s12, 2
  s_mul_i32 s17, s17, 12288
  s_add_u32 s17, s17, 102400
  v_add_u32 v185, s17, v1
  s_xor_b32 s17, s12, 3
  s_mul_i32 s17, s17, 12288
  s_add_u32 s17, s17, 106496
  v_add_u32 v186, s17, v1
  s_mul_i32 s17, s12, 12288
  s_add_u32 s17, s17, 98304
  v_add_u32 v187, s17, v1
  s_mov_b32 s34, 0x800000
  s_lshl_b32 s18, s31, 15
  s_add_u32 s34, s34, s18
  s_lshl_b32 s18, s32, 11
  s_add_u32 s34, s34, s18
  s_mov_b32 s35, 0x700000
  s_lshl_b32 s18, s31, 12
  s_add_u32 s35, s35, s18
  s_lshr_b32 s18, s32, 1
  s_lshl_b32 s18, s18, 9
  s_add_u32 s35, s35, s18
  s_and_b32 s18, s32, 1
  s_lshl_b32 s18, s18, 3
  s_add_u32 s35, s35, s18
  s_mul_i32 s38, s3, 0x2000
  s_add_u32 s38, s38, 0x6b8000
  s_lshl_b32 s17, s15, 9
  s_add_u32 s38, s38, s17
  s_lshl_b32 s17, s12, 6
  s_add_u32 s38, s38, s17
  s_and_b32 s17, s13, 1
  s_lshl_b32 s17, s17, 3
  s_add_u32 s38, s38, s17
  v_and_b32 v174, 6, v2
  v_lshlrev_b32 v174, 3, v174
  v_and_b32 v175, 1, v2
  v_lshl_add_u32 v174, v175, 2, v174
  s_mul_i32 s39, s3, 0x1000
  s_add_u32 s39, s39, 0x6b7000
  s_lshl_b32 s17, s13, 7
  s_add_u32 s39, s39, s17
  s_lshl_b32 s17, s14, 4
  s_add_u32 s39, s39, s17
  s_lshl_b32 s17, s12, 2
  s_add_u32 s39, s39, s17
L_poll_10:
  buffer_load_dword v172, v174, s[4:7], s38 offen offset:256 sc1
  s_waitcnt vmcnt(0)
  v_cmp_ne_u32 vcc, v11, v172
  s_nop 1
  s_cbranch_vccnz L_poll_10
L_poll_10_out:
  buffer_load_dwordx4 a[0:3], v1, s[4:7], s27 offen offset:0 sc1
  buffer_load_dwordx4 a[4:7], v5, s[4:7], s27 offen offset:3072 sc1
  buffer_load_dwordx4 a[8:11], v7, s[4:7], s27 offen offset:2048 sc1
  buffer_load_dwordx4 a[12:15], v9, s[4:7], s27 offen offset:1024 sc1
  buffer_load_dwordx4 a[16:19], v1, s[4:7], s27 offen offset:1024 sc1
  buffer_load_dwordx4 a[20:23], v6, s[4:7], s27 offen offset:0 sc1
  buffer_load_dwordx4 a[24:27], v7, s[4:7], s27 offen offset:3072 sc1
  buffer_load_dwordx4 a[28:31], v9, s[4:7], s27 offen offset:2048 sc1
  buffer_load_dwordx4 a[32:35], v1, s[4:7], s27 offen offset:2048 sc1
  buffer_load_dwordx4 a[36:39], v6, s[4:7], s27 offen offset:1024 sc1
  s_waitcnt vmcnt(9)
  v_mfma_f32_32x32x16_bf16 v[40:55], a[128:131], a[0:3], 0
  v_mfma_f32_32x32x16_bf16 v[72:87], a[132:135], a[0:3], 0
  buffer_load_dwordx4 a[40:43], v8, s[4:7], s27 offen offset:0 sc1
  buffer_load_dwordx4 a[44:47], v9, s[4:7], s27 offen offset:3072 sc1
  s_waitcnt vmcnt(10)
  v_mfma_f32_32x32x16_bf16 v[40:55], a[136:139], a[4:7], v[40:55]
  v_mfma_f32_32x32x16_bf16 v[72:87], a[140:143], a[4:7], v[72:87]
  buffer_load_dwordx4 a[48:51], v1, s[4:7], s27 offen offset:3072 sc1
  buffer_load_dwordx4 a[52:55], v6, s[4:7], s27 offen offset:2048 sc1
  s_waitcnt vmcnt(11)
  v_mfma_f32_32x32x16_bf16 v[40:55], a[144:147], a[8:11], v[40:55]
  v_mfma_f32_32x32x16_bf16 v[72:87], a[148:151], a[8:11], v[72:87]
  buffer_load_dwordx4 a[56:59], v8, s[4:7], s27 offen offset:1024 sc1
  buffer_load_dwordx4 a[60:63], v10, s[4:7], s27 offen offset:0 sc1
  buffer_load_dword v173, v174, s[4:7], s38 offen sc1
  s_waitcnt vmcnt(13)
  v_mfma_f32_32x32x16_bf16 v[40:55], a[152:155], a[12:15], v[40:55]
  v_mfma_f32_32x32x16_bf16 v[72:87], a[156:159], a[12:15], v[72:87]
  buffer_load_dwordx4 a[64:67], v1, s[4:7], s26 offen offset:0 sc1
  buffer_load_dwordx4 a[68:71], v5, s[4:7], s26 offen offset:3072 sc1
  s_waitcnt vmcnt(14)
  v_mfma_f32_32x32x16_bf16 v[40:55], a[160:163], a[16:19], v[40:55]
  v_mfma_f32_32x32x16_bf16 v[72:87], a[164:167], a[16:19], v[72:87]
  buffer_load_dwordx4 a[72:75], v7, s[4:7], s26 offen offset:2048 sc1
  buffer_load_dwordx4 a[76:79], v9, s[4:7], s26 offen offset:1024 sc1
  s_waitcnt vmcnt(15)
  v_mfma_f32_32x32x16_bf16 v[40:55], a[168:171], a[20:23], v[40:55]
  v_mfma_f32_32x32x16_bf16 v[72:87], a[172:175], a[20:23], v[72:87]
  buffer_load_dwordx4 a[80:83], v1, s[4:7], s26 offen offset:1024 sc1
  buffer_load_dwordx4 a[84:87], v6, s[4:7], s26 offen offset:0 sc1
  s_waitcnt vmcnt(16)
  v_mfma_f32_32x32x16_bf16 v[40:55], a[176:179], a[24:27], v[40:55]
  v_mfma_f32_32x32x16_bf16 v[72:87], a[180:183], a[24:27], v[72:87]
  buffer_load_dwordx4 a[88:91], v7, s[4:7], s26 offen offset:3072 sc1
  buffer_load_dwordx4 a[92:95], v9, s[4:7], s26 offen offset:2048 sc1
  s_waitcnt vmcnt(17)
  v_mfma_f32_32x32x16_bf16 v[40:55], a[184:187], a[28:31], v[40:55]
  v_mfma_f32_32x32x16_bf16 v[72:87], a[188:191], a[28:31], v[72:87]
  buffer_load_dwordx4 a[96:99], v1, s[4:7], s26 offen offset:2048 sc1
  buffer_load_dwordx4 a[100:103], v6, s[4:7], s26 offen offset:1024 sc1
  s_waitcnt vmcnt(18)
  v_mfma_f32_32x32x16_bf16 v[40:55], a[192:195], a[32:35], v[40:55]
  v_mfma_f32_32x32x16_bf16 v[72:87], a[196:199], a[32:35], v[72:87]
  buffer_load_dwordx4 a[104:107], v8, s[4:7], s26 offen offset:0 sc1
  s_waitcnt vmcnt(18)
  v_mfma_f32_32x32x16_bf16 v[40:55], a[200:203], a[36:39], v[40:55]
  v_mfma_f32_32x32x16_bf16 v[72:87], a[204:207], a[36:39], v[72:87]
  buffer_load_dwordx4 a[108:111], v9, s[4:7], s26 offen offset:3072 sc1
  s_waitcnt vmcnt(18)
  v_mfma_f32_32x32x16_bf16 v[40:55], a[208:211], a[40:43], v[40:55]
  v_mfma_f32_32x32x16_bf16 v[72:87], a[212:215], a[40:43], v[72:87]
  buffer_load_dwordx4 a[112:115], v1, s[4:7], s26 offen offset:3072 sc1
  s_waitcnt vmcnt(18)
  v_mfma_f32_32x32x16_bf16 v[40:55], a[216:219], a[44:47], v[40:55]
  v_mfma_f32_32x32x16_bf16 v[72:87], a[220:223], a[44:47], v[72:87]
  buffer_load_dwordx4 a[116:119], v6, s[4:7], s26 offen offset:2048 sc1
  s_waitcnt vmcnt(18)
  v_mfma_f32_32x32x16_bf16 v[40:55], a[224:227], a[48:51], v[40:55]
  v_mfma_f32_32x32x16_bf16 v[72:87], a[228:231], a[48:51], v[72:87]
  buffer_load_dwordx4 a[120:123], v8, s[4:7], s26 offen offset:1024 sc1
  s_waitcnt vmcnt(18)
  v_mfma_f32_32x32x16_bf16 v[40:55], a[232:235], a[52:55], v[40:55]
  v_mfma_f32_32x32x16_bf16 v[72:87], a[236:239], a[52:55], v[72:87]
  buffer_load_dwordx4 a[124:127], v10, s[4:7], s26 offen offset:0 sc1
  s_waitcnt vmcnt(18)
  v_mfma_f32_32x32x16_bf16 v[40:55], a[240:243], a[56:59], v[40:55]
  v_mfma_f32_32x32x16_bf16 v[72:87], a[244:247], a[56:59], v[72:87]
  s_waitcnt vmcnt(17)
  v_mfma_f32_32x32x16_bf16 v[40:55], a[248:251], a[60:63], v[40:55]
  v_mfma_f32_32x32x16_bf16 v[72:87], a[252:255], a[60:63], v[72:87]
  s_waitcnt vmcnt(16)
  v_cmp_ne_u32 vcc, v11, v173
  s_nop 1
  s_cbranch_vccz L_ffn2_go
L_poll_11:
  buffer_load_dword v172, v174, s[4:7], s38 offen offset:0 sc1
  s_waitcnt vmcnt(0)
  v_cmp_ne_u32 vcc, v11, v172
  s_nop 1
  s_cbranch_vccnz L_poll_11
L_poll_11_out:
L_ffn2_go:
  buffer_load_dwordx4 a[0:3], v5, s[4:7], s27 offen offset:0 sc1
  buffer_load_dwordx4 a[4:7], v6, s[4:7], s27 offen offset:3072 sc1
  s_waitcnt vmcnt(17)
  v_mfma_f32_32x32x16_bf16 v[56:71], a[132:135], a[64:67], 0
  v_mfma_f32_32x32x16_bf16 v[24:39], a[128:131], a[64:67], 0
  buffer_load_dwordx4 a[8:11], v8, s[4:7], s27 offen offset:2048 sc1
  s_waitcnt vmcnt(17)
  v_mfma_f32_32x32x16_bf16 v[56:71], a[140:143], a[68:71], v[56:71]
  v_mfma_f32_32x32x16_bf16 v[24:39], a[136:139], a[68:71], v[24:39]
  buffer_load_dwordx4 a[12:15], v10, s[4:7], s27 offen offset:1024 sc1
  s_waitcnt vmcnt(17)
  v_mfma_f32_32x32x16_bf16 v[56:71], a[148:151], a[72:75], v[56:71]
  v_mfma_f32_32x32x16_bf16 v[24:39], a[144:147], a[72:75], v[24:39]
  buffer_load_dwordx4 a[16:19], v5, s[4:7], s27 offen offset:1024 sc1
  s_waitcnt vmcnt(17)
  v_mfma_f32_32x32x16_bf16 v[56:71], a[156:159], a[76:79], v[56:71]
  v_mfma_f32_32x32x16_bf16 v[24:39], a[152:155], a[76:79], v[24:39]
  buffer_load_dwordx4 a[20:23], v7, s[4:7], s27 offen offset:0 sc1
  s_waitcnt vmcnt(17)
  v_mfma_f32_32x32x16_bf16 v[56:71], a[164:167], a[80:83], v[56:71]
  v_mfma_f32_32x32x16_bf16 v[24:39], a[160:163], a[80:83], v[24:39]
  buffer_load_dwordx4 a[24:27], v8, s[4:7], s27 offen offset:3072 sc1
  s_waitcnt vmcnt(17)
  v_mfma_f32_32x32x16_bf16 v[56:71], a[172:175], a[84:87], v[56:71]
  v_mfma_f32_32x32x16_bf16 v[24:39], a[168:171], a[84:87], v[24:39]
  buffer_load_dwordx4 a[28:31], v10, s[4:7], s27 offen offset:2048 sc1
  s_waitcnt vmcnt(17)
  v_mfma_f32_32x32x16_bf16 v[56:71], a[180:183], a[88:91], v[56:71]
  v_mfma_f32_32x32x16_bf16 v[24:39], a[176:179], a[88:91], v[24:39]
  buffer_load_dwordx4 a[32:35], v5, s[4:7], s27 offen offset:2048 sc1
  s_waitcnt vmcnt(17)
  v_mfma_f32_32x32x16_bf16 v[56:71], a[188:191], a[92:95], v[56:71]
  v_mfma_f32_32x32x16_bf16 v[24:39], a[184:187], a[92:95], v[24:39]
  buffer_load_dwordx4 a[36:39], v7, s[4:7], s27 offen offset:1024 sc1
  s_waitcnt vmcnt(17)
  v_mfma_f32_32x32x16_bf16 v[56:71], a[196:199], a[96:99], v[56:71]
  v_mfma_f32_32x32x16_bf16 v[24:39], a[192:195], a[96:99], v[24:39]
  buffer_load_dwordx4 a[40:43], v9, s[4:7], s27 offen offset:0 sc1
  s_waitcnt vmcnt(17)
  v_mfma_f32_32x32x16_bf16 v[56:71], a[204:207], a[100:103], v[56:71]
  v_mfma_f32_32x32x16_bf16 v[24:39], a[200:203], a[100:103], v[24:39]
  buffer_load_dwordx4 a[44:47], v10, s[4:7], s27 offen offset:3072 sc1
  s_waitcnt vmcnt(17)
  v_mfma_f32_32x32x16_bf16 v[56:71], a[212:215], a[104:107], v[56:71]
  v_mfma_f32_32x32x16_bf16 v[24:39], a[208:211], a[104:107], v[24:39]
  buffer_load_dwordx4 a[48:51], v5, s[4:7], s26 offen offset:0 sc1
  s_waitcnt vmcnt(17)
  v_mfma_f32_32x32x16_bf16 v[56:71], a[220:223], a[108:111], v[56:71]
  v_mfma_f32_32x32x16_bf16 v[24:39], a[216:219], a[108:111], v[24:39]
  buffer_load_dwordx4 a[52:55], v6, s[4:7], s26 offen offset:3072 sc1
  s_waitcnt vmcnt(17)
  v_mfma_f32_32x32x16_bf16 v[56:71], a[228:231], a[112:115], v[56:71]
  v_mfma_f32_32x32x16_bf16 v[24:39], a[224:227], a[112:115], v[24:39]
  buffer_load_dwordx4 a[56:59], v8, s[4:7], s26 offen offset:2048 sc1
  s_waitcnt vmcnt(17)
  v_mfma_f32_32x32x16_bf16 v[56:71], a[236:239], a[116:119], v[56:71]
  v_mfma_f32_32x32x16_bf16 v[24:39], a[232:235], a[116:119], v[24:39]
  buffer_load_dwordx4 a[60:63], v10, s[4:7], s26 offen offset:1024 sc1
  s_waitcnt vmcnt(17)
  v_mfma_f32_32x32x16_bf16 v[56:71], a[244:247], a[120:123], v[56:71]
  v_mfma_f32_32x32x16_bf16 v[24:39], a[240:243], a[120:123], v[24:39]
  buffer_load_dwordx4 a[64:67], v5, s[4:7], s26 offen offset:1024 sc1
  s_waitcnt vmcnt(17)
  v_mfma_f32_32x32x16_bf16 v[56:71], a[252:255], a[124:127], v[56:71]
  v_mfma_f32_32x32x16_bf16 v[24:39], a[248:251], a[124:127], v[24:39]
  buffer_load_dwordx4 a[68:71], v7, s[4:7], s26 offen offset:0 sc1
  s_cmp_eq_u32 s3, 1
  s_cbranch_scc1 L_g64_last
  s_waitcnt vmcnt(17)
  v_mfma_f32_32x32x16_bf16 v[40:55], v[200:203], a[0:3], v[40:55]
  v_mfma_f32_32x32x16_bf16 v[72:87], v[204:207], a[0:3], v[72:87]
  buffer_load_dwordx4 a[72:75], v8, s[4:7], s26 offen offset:3072 sc1
  buffer_load_dwordx4 a[128:131], v1, s[4:7], s52 offen offset:0 sc1
  s_waitcnt vmcnt(18)
  v_mfma_f32_32x32x16_bf16 v[40:55], v[208:211], a[4:7], v[40:55]
  v_mfma_f32_32x32x16_bf16 v[72:87], v[212:215], a[4:7], v[72:87]
  buffer_load_dwordx4 a[76:79], v10, s[4:7], s26 offen offset:2048 sc1
  buffer_load_dwordx4 a[132:135], v1, s[4:7], s52 offen offset:1024 sc1
  s_waitcnt vmcnt(19)
  v_mfma_f32_32x32x16_bf16 v[40:55], v[216:219], a[8:11], v[40:55]
  v_mfma_f32_32x32x16_bf16 v[72:87], v[220:223], a[8:11], v[72:87]
  buffer_load_dwordx4 a[80:83], v5, s[4:7], s26 offen offset:2048 sc1
  buffer_load_dwordx4 a[136:139], v1, s[4:7], s52 offen offset:2048 sc1
  s_waitcnt vmcnt(20)
  v_mfma_f32_32x32x16_bf16 v[40:55], v[224:227], a[12:15], v[40:55]
  v_mfma_f32_32x32x16_bf16 v[72:87], v[228:231], a[12:15], v[72:87]
  buffer_load_dwordx4 a[84:87], v7, s[4:7], s26 offen offset:1024 sc1
  buffer_load_dwordx4 a[140:143], v1, s[4:7], s52 offen offset:3072 sc1
  s_waitcnt vmcnt(21)
  v_mfma_f32_32x32x16_bf16 v[40:55], v[232:235], a[16:19], v[40:55]
  v_mfma_f32_32x32x16_bf16 v[72:87], v[236:239], a[16:19], v[72:87]
  buffer_load_dwordx4 a[88:91], v9, s[4:7], s26 offen offset:0 sc1
  buffer_load_dwordx4 a[144:147], v5, s[4:7], s52 offen offset:0 sc1
  s_waitcnt vmcnt(22)
  v_mfma_f32_32x32x16_bf16 v[40:55], v[240:243], a[20:23], v[40:55]
  v_mfma_f32_32x32x16_bf16 v[72:87], v[244:247], a[20:23], v[72:87]
  buffer_load_dwordx4 a[92:95], v10, s[4:7], s26 offen offset:3072 sc1
  buffer_load_dwordx4 a[148:151], v5, s[4:7], s52 offen offset:1024 sc1
  s_waitcnt vmcnt(23)
  v_mfma_f32_32x32x16_bf16 v[40:55], v[248:251], a[24:27], v[40:55]
  v_mfma_f32_32x32x16_bf16 v[72:87], v[252:255], a[24:27], v[72:87]
  buffer_load_dwordx4 a[152:155], v5, s[4:7], s52 offen offset:2048 sc1
  s_waitcnt vmcnt(23)
  v_mfma_f32_32x32x16_bf16 v[40:55], v[136:139], a[28:31], v[40:55]
  v_mfma_f32_32x32x16_bf16 v[72:87], v[140:143], a[28:31], v[72:87]
  buffer_load_dwordx4 a[156:159], v5, s[4:7], s52 offen offset:3072 sc1
  s_waitcnt vmcnt(23)
  v_mfma_f32_32x32x16_bf16 v[40:55], v[144:147], a[32:35], v[40:55]
  v_mfma_f32_32x32x16_bf16 v[72:87], v[148:151], a[32:35], v[72:87]
  buffer_load_dwordx4 a[160:163], v1, s[4:7], s50 offen offset:0 sc1
  s_waitcnt vmcnt(23)
  v_mfma_f32_32x32x16_bf16 v[40:55], v[152:155], a[36:39], v[40:55]
  v_mfma_f32_32x32x16_bf16 v[72:87], v[156:159], a[36:39], v[72:87]
  buffer_load_dwordx4 a[192:195], v1, s[4:7], s51 offen offset:0 sc1
  s_waitcnt vmcnt(23)
  v_mfma_f32_32x32x16_bf16 v[40:55], v[160:163], a[40:43], v[40:55]
  v_mfma_f32_32x32x16_bf16 v[72:87], v[164:167], a[40:43], v[72:87]
  buffer_load_dwordx4 a[164:167], v1, s[4:7], s50 offen offset:1024 sc1
  s_waitcnt vmcnt(23)
  v_mfma_f32_32x32x16_bf16 v[40:55], v[190:193], a[44:47], v[40:55]
  v_mfma_f32_32x32x16_bf16 v[72:87], v[194:197], a[44:47], v[72:87]
  buffer_load_dwordx4 a[196:199], v1, s[4:7], s51 offen offset:1024 sc1
  s_waitcnt vmcnt(23)
  v_mfma_f32_32x32x16_bf16 v[56:71], v[204:207], a[48:51], v[56:71]
  v_mfma_f32_32x32x16_bf16 v[24:39], v[200:203], a[48:51], v[24:39]
  buffer_load_dwordx4 a[168:171], v1, s[4:7], s50 offen offset:2048 sc1
  s_waitcnt vmcnt(23)
  v_mfma_f32_32x32x16_bf16 v[56:71], v[212:215], a[52:55], v[56:71]
  v_mfma_f32_32x32x16_bf16 v[24:39], v[208:211], a[52:55], v[24:39]
  buffer_load_dwordx4 a[200:203], v1, s[4:7], s51 offen offset:2048 sc1
  s_nop 1
  ds_write_b128 v184, v[40:43] offset:0
  ds_write_b128 v184, v[44:47] offset:1024
  ds_write_b128 v184, v[48:51] offset:2048
  ds_write_b128 v184, v[52:55] offset:3072
  ds_write_b128 v186, v[72:75] offset:0
  ds_write_b128 v186, v[76:79] offset:1024
  ds_write_b128 v186, v[80:83] offset:2048
  ds_write_b128 v186, v[84:87] offset:3072
  s_waitcnt vmcnt(23)
  v_mfma_f32_32x32x16_bf16 v[56:71], v[220:223], a[56:59], v[56:71]
  v_mfma_f32_32x32x16_bf16 v[24:39], v[216:219], a[56:59], v[24:39]
  buffer_load_dwordx4 a[172:175], v1, s[4:7], s50 offen offset:3072 sc1
  s_waitcnt vmcnt(23)
  v_mfma_f32_32x32x16_bf16 v[56:71], v[228:231], a[60:63], v[56:71]
  v_mfma_f32_32x32x16_bf16 v[24:39], v[224:227], a[60:63], v[24:39]
  buffer_load_dwordx4 a[204:207], v1, s[4:7], s51 offen offset:3072 sc1
  s_waitcnt vmcnt(23)
  v_mfma_f32_32x32x16_bf16 v[56:71], v[236:239], a[64:67], v[56:71]
  v_mfma_f32_32x32x16_bf16 v[24:39], v[232:235], a[64:67], v[24:39]
  buffer_load_dwordx4 a[176:179], v5, s[4:7], s50 offen offset:0 sc1
  s_waitcnt vmcnt(23)
  v_mfma_f32_32x32x16_bf16 v[56:71], v[244:247], a[68:71], v[56:71]
  v_mfma_f32_32x32x16_bf16 v[24:39], v[240:243], a[68:71], v[24:39]
  buffer_load_dwordx4 a[208:211], v5, s[4:7], s51 offen offset:0 sc1
  s_waitcnt vmcnt(23)
  v_mfma_f32_32x32x16_bf16 v[56:71], v[252:255], a[72:75], v[56:71]
  v_mfma_f32_32x32x16_bf16 v[24:39], v[248:251], a[72:75], v[24:39]
  buffer_load_dwordx4 a[180:183], v5, s[4:7], s50 offen offset:1024 sc1
  s_waitcnt lgkmcnt(0)
  s_barrier
  ds_read_b128 v[88:91], v187 offset:0
  ds_read_b128 v[92:95], v187 offset:1024
  ds_read_b128 v[96:99], v187 offset:2048
  ds_read_b128 v[100:103], v187 offset:3072
  ds_read_b128 v[104:107], v187 offset:8192
  ds_read_b128 v[108:111], v187 offset:9216
  ds_read_b128 v[112:115], v187 offset:10240
  ds_read_b128 v[116:119], v187 offset:11264
  s_waitcnt vmcnt(22)
  v_mfma_f32_32x32x16_bf16 v[56:71], v[140:143], a[76:79], v[56:71]
  v_mfma_f32_32x32x16_bf16 v[24:39], v[136:139], a[76:79], v[24:39]
  buffer_load_dwordx4 a[212:215], v5, s[4:7], s51 offen offset:1024 sc1
  s_waitcnt lgkmcnt(0)
  v_add_f32 v88, v88, v104
  v_add_f32 v89, v89, v105
  v_add_f32 v90, v90, v106
  v_add_f32 v91, v91, v107
  v_add_f32 v92, v92, v108
  v_add_f32 v93, v93, v109
  v_add_f32 v94, v94, v110
  v_add_f32 v95, v95, v111
  v_add_f32 v96, v96, v112
  v_add_f32 v97, v97, v113
  s_waitcnt vmcnt(21)
  v_mfma_f32_32x32x16_bf16 v[56:71], v[148:151], a[80:83], v[56:71]
  v_mfma_f32_32x32x16_bf16 v[24:39], v[144:147], a[80:83], v[24:39]
  buffer_load_dwordx4 a[184:187], v5, s[4:7], s50 offen offset:2048 sc1
  v_add_f32 v98, v98, v114
  v_add_f32 v99, v99, v115
  v_add_f32 v100, v100, v116
  v_add_f32 v101, v101, v117
  v_add_f32 v102, v102, v118
  v_add_f32 v103, v103, v119
  v_lshlrev_b32 v168, 16, v12
  v_and_b32 v169, 0xffff0000, v12
  v_add_f32 v88, v88, v168
  v_add_f32 v89, v89, v169
  s_waitcnt vmcnt(20)
  v_mfma_f32_32x32x16_bf16 v[56:71], v[156:159], a[84:87], v[56:71]
  v_mfma_f32_32x32x16_bf16 v[24:39], v[152:155], a[84:87], v[24:39]
  buffer_load_dwordx4 a[216:219], v5, s[4:7], s51 offen offset:2048 sc1
  v_lshlrev_b32 v168, 16, v13
  v_and_b32 v169, 0xffff0000, v13
  v_add_f32 v90, v90, v168
  v_add_f32 v91, v91, v169
  v_lshlrev_b32 v168, 16, v14
  v_and_b32 v169, 0xffff0000, v14
  v_add_f32 v92, v92, v168
  v_add_f32 v93, v93, v169
  v_lshlrev_b32 v168, 16, v15
  v_and_b32 v169, 0xffff0000, v15
  s_waitcnt vmcnt(19)
  v_mfma_f32_32x32x16_bf16 v[56:71], v[164:167], a[88:91], v[56:71]
  v_mfma_f32_32x32x16_bf16 v[24:39], v[160:163], a[88:91], v[24:39]
  buffer_load_dwordx4 a[188:191], v5, s[4:7], s50 offen offset:3072 sc1
  v_add_f32 v94, v94, v168
  v_add_f32 v95, v95, v169
  v_lshlrev_b32 v168, 16, v16
  v_and_b32 v169, 0xffff0000, v16
  v_add_f32 v96, v96, v168
  v_add_f32 v97, v97, v169
  v_lshlrev_b32 v168, 16, v17
  v_and_b32 v169, 0xffff0000, v17
  v_add_f32 v98, v98, v168
  v_add_f32 v99, v99, v169
  s_waitcnt vmcnt(18)
  v_mfma_f32_32x32x16_bf16 v[56:71], v[194:197], a[92:95], v[56:71]
  v_mfma_f32_32x32x16_bf16 v[24:39], v[190:193], a[92:95], v[24:39]
  buffer_load_dwordx4 a[220:223], v5, s[4:7], s51 offen offset:3072 sc1
  v_lshlrev_b32 v168, 16, v18
  v_and_b32 v169, 0xffff0000, v18
  v_add_f32 v100, v100, v168
  v_add_f32 v101, v101, v169
  v_lshlrev_b32 v168, 16, v19
  v_and_b32 v169, 0xffff0000, v19
  v_add_f32 v102, v102, v168
  v_add_f32 v103, v103, v169
  s_branch L_g64_join
L_g64_last:
  s_waitcnt vmcnt(17)
  v_mfma_f32_32x32x16_bf16 v[40:55], v[200:203], a[0:3], v[40:55]
  v_mfma_f32_32x32x16_bf16 v[72:87], v[204:207], a[0:3], v[72:87]
  buffer_load_dwordx4 a[72:75], v8, s[4:7], s26 offen offset:3072 sc1
  s_waitcnt vmcnt(17)
  v_mfma_f32_32x32x16_bf16 v[40:55], v[208:211], a[4:7], v[40:55]
  v_mfma_f32_32x32x16_bf16 v[72:87], v[212:215], a[4:7], v[72:87]
  buffer_load_dwordx4 a[76:79], v10, s[4:7], s26 offen offset:2048 sc1
  s_waitcnt vmcnt(17)
  v_mfma_f32_32x32x16_bf16 v[40:55], v[216:219], a[8:11], v[40:55]
  v_mfma_f32_32x32x16_bf16 v[72:87], v[220:223], a[8:11], v[72:87]
  buffer_load_dwordx4 a[80:83], v5, s[4:7], s26 offen offset:2048 sc1
  s_waitcnt vmcnt(17)
  v_mfma_f32_32x32x16_bf16 v[40:55], v[224:227], a[12:15], v[40:55]
  v_mfma_f32_32x32x16_bf16 v[72:87], v[228:231], a[12:15], v[72:87]
  buffer_load_dwordx4 a[84:87], v7, s[4:7], s26 offen offset:1024 sc1
  s_waitcnt vmcnt(17)
  v_mfma_f32_32x32x16_bf16 v[40:55], v[232:235], a[16:19], v[40:55]
  v_mfma_f32_32x32x16_bf16 v[72:87], v[236:239], a[16:19], v[72:87]
  buffer_load_dwordx4 a[88:91], v9, s[4:7], s26 offen offset:0 sc1
  s_waitcnt vmcnt(17)
  v_mfma_f32_32x32x16_bf16 v[40:55], v[240:243], a[20:23], v[40:55]
  v_mfma_f32_32x32x16_bf16 v[72:87], v[244:247], a[20:23], v[72:87]
  buffer_load_dwordx4 a[92:95], v10, s[4:7], s26 offen offset:3072 sc1
  s_waitcnt vmcnt(17)
  v_mfma_f32_32x32x16_bf16 v[40:55], v[248:251], a[24:27], v[40:55]
  v_mfma_f32_32x32x16_bf16 v[72:87], v[252:255], a[24:27], v[72:87]
  s_waitcnt vmcnt(16)
  v_mfma_f32_32x32x16_bf16 v[40:55], v[136:139], a[28:31], v[40:55]
  v_mfma_f32_32x32x16_bf16 v[72:87], v[140:143], a[28:31], v[72:87]
  s_waitcnt vmcnt(15)
  v_mfma_f32_32x32x16_bf16 v[40:55], v[144:147], a[32:35], v[40:55]
  v_mfma_f32_32x32x16_bf16 v[72:87], v[148:151], a[32:35], v[72:87]
  s_waitcnt vmcnt(14)
  v_mfma_f32_32x32x16_bf16 v[40:55], v[152:155], a[36:39], v[40:55]
  v_mfma_f32_32x32x16_bf16 v[72:87], v[156:159], a[36:39], v[72:87]
  s_waitcnt vmcnt(13)
  v_mfma_f32_32x32x16_bf16 v[40:55], v[160:163], a[40:43], v[40:55]
  v_mfma_f32_32x32x16_bf16 v[72:87], v[164:167], a[40:43], v[72:87]
  s_waitcnt vmcnt(12)
  v_mfma_f32_32x32x16_bf16 v[40:55], v[190:193], a[44:47], v[40:55]
  v_mfma_f32_32x32x16_bf16 v[72:87], v[194:197], a[44:47], v[72:87]
  s_waitcnt vmcnt(11)
  v_mfma_f32_32x32x16_bf16 v[56:71], v[204:207], a[48:51], v[56:71]
  v_mfma_f32_32x32x16_bf16 v[24:39], v[200:203], a[48:51], v[24:39]
  s_waitcnt vmcnt(10)
  v_mfma_f32_32x32x16_bf16 v[56:71], v[212:215], a[52:55], v[56:71]
  v_mfma_f32_32x32x16_bf16 v[24:39], v[208:211], a[52:55], v[24:39]
  s_nop 4
  ds_write_b128 v184, v[40:43] offset:0
  ds_write_b128 v184, v[44:47] offset:1024
  ds_write_b128 v184, v[48:51] offset:2048
  ds_write_b128 v184, v[52:55] offset:3072
  ds_write_b128 v186, v[72:75] offset:0
  ds_write_b128 v186, v[76:79] offset:1024
  ds_write_b128 v186, v[80:83] offset:2048
  ds_write_b128 v186, v[84:87] offset:3072
  s_waitcnt vmcnt(9)
  v_mfma_f32_32x32x16_bf16 v[56:71], v[220:223], a[56:59], v[56:71]
  v_mfma_f32_32x32x16_bf16 v[24:39], v[216:219], a[56:59], v[24:39]
  s_waitcnt vmcnt(8)
  v_mfma_f32_32x32x16_bf16 v[56:71], v[228:231], a[60:63], v[56:71]
  v_mfma_f32_32x32x16_bf16 v[24:39], v[224:227], a[60:63], v[24:39]
  s_waitcnt vmcnt(7)
  v_mfma_f32_32x32x16_bf16 v[56:71], v[236:239], a[64:67], v[56:71]
  v_mfma_f32_32x32x16_bf16 v[24:39], v[232:235], a[64:67], v[24:39]
  s_waitcnt vmcnt(6)
  v_mfma_f32_32x32x16_bf16 v[56:71], v[244:247], a[68:71], v[56:71]
  v_mfma_f32_32x32x16_bf16 v[24:39], v[240:243], a[68:71], v[24:39]
  s_waitcnt vmcnt(5)
  v_mfma_f32_32x32x16_bf16 v[56:71], v[252:255], a[72:75], v[56:71]
  v_mfma_f32_32x32x16_bf16 v[24:39], v[248:251], a[72:75], v[24:39]
  s_waitcnt lgkmcnt(0)
  s_barrier
  ds_read_b128 v[88:91], v187 offset:0
  ds_read_b128 v[92:95], v187 offset:1024
  ds_read_b128 v[96:99], v187 offset:2048
  ds_read_b128 v[100:103], v187 offset:3072
  ds_read_b128 v[104:107], v187 offset:8192
  ds_read_b128 v[108:111], v187 offset:9216
  ds_read_b128 v[112:115], v187 offset:10240
  ds_read_b128 v[116:119], v187 offset:11264
  s_waitcnt vmcnt(4)
  v_mfma_f32_32x32x16_bf16 v[56:71], v[140:143], a[76:79], v[56:71]
  v_mfma_f32_32x32x16_bf16 v[24:39], v[136:139], a[76:79], v[24:39]
  s_waitcnt lgkmcnt(0)
  v_add_f32 v88, v88, v104
  v_add_f32 v89, v89, v105
  v_add_f32 v90, v90, v106
  v_add_f32 v91, v91, v107
  v_add_f32 v92, v92, v108
  v_add_f32 v93, v93, v109
  v_add_f32 v94, v94, v110
  v_add_f32 v95, v95, v111
  v_add_f32 v96, v96, v112
  v_add_f32 v97, v97, v113
  s_waitcnt vmcnt(3)
  v_mfma_f32_32x32x16_bf16 v[56:71], v[148:151], a[80:83], v[56:71]
  v_mfma_f32_32x32x16_bf16 v[24:39], v[144:147], a[80:83], v[24:39]
  v_add_f32 v98, v98, v114
  v_add_f32 v99, v99, v115
  v_add_f32 v100, v100, v116
  v_add_f32 v101, v101, v117
  v_add_f32 v102, v102, v118
  v_add_f32 v103, v103, v119
  v_lshlrev_b32 v168, 16, v12
  v_and_b32 v169, 0xffff0000, v12
  v_add_f32 v88, v88, v168
  v_add_f32 v89, v89, v169
  s_waitcnt vmcnt(2)
  v_mfma_f32_32x32x16_bf16 v[56:71], v[156:159], a[84:87], v[56:71]
  v_mfma_f32_32x32x16_bf16 v[24:39], v[152:155], a[84:87], v[24:39]
  v_lshlrev_b32 v168, 16, v13
  v_and_b32 v169, 0xffff0000, v13
  v_add_f32 v90, v90, v168
  v_add_f32 v91, v91, v169
  v_lshlrev_b32 v168, 16, v14
  v_and_b32 v169, 0xffff0000, v14
  v_add_f32 v92, v92, v168
  v_add_f32 v93, v93, v169
  v_lshlrev_b32 v168, 16, v15
  v_and_b32 v169, 0xffff0000, v15
  s_waitcnt vmcnt(1)
  v_mfma_f32_32x32x16_bf16 v[56:71], v[164:167], a[88:91], v[56:71]
  v_mfma_f32_32x32x16_bf16 v[24:39], v[160:163], a[88:91], v[24:39]
  v_add_f32 v94, v94, v168
  v_add_f32 v95, v95, v169
  v_lshlrev_b32 v168, 16, v16
  v_and_b32 v169, 0xffff0000, v16
  v_add_f32 v96, v96, v168
  v_add_f32 v97, v97, v169
  v_lshlrev_b32 v168, 16, v17
  v_and_b32 v169, 0xffff0000, v17
  v_add_f32 v98, v98, v168
  v_add_f32 v99, v99, v169
  s_waitcnt vmcnt(0)
  v_mfma_f32_32x32x16_bf16 v[56:71], v[194:197], a[92:95], v[56:71]
  v_mfma_f32_32x32x16_bf16 v[24:39], v[190:193], a[92:95], v[24:39]
  v_lshlrev_b32 v168, 16, v18
  v_and_b32 v169, 0xffff0000, v18
  v_add_f32 v100, v100, v168
  v_add_f32 v101, v101, v169
  v_lshlrev_b32 v168, 16, v19
  v_and_b32 v169, 0xffff0000, v19
  v_add_f32 v102, v102, v168
  v_add_f32 v103, v103, v169
L_g64_join:
  s_waitcnt lgkmcnt(0)
  s_nop 1
  ds_write_b128 v185, v[56:59] offset:0
  ds_write_b128 v185, v[60:63] offset:1024
  ds_write_b128 v185, v[64:67] offset:2048
  ds_write_b128 v185, v[68:71] offset:3072
  v_add_f32 v24, v24, v88
  v_add_f32 v25, v25, v89
  v_add_f32 v26, v26, v90
  v_add_f32 v27, v27, v91
  v_add_f32 v28, v28, v92
  v_add_f32 v29, v29, v93
  v_add_f32 v30, v30, v94
  v_add_f32 v31, v31, v95
  v_add_f32 v32, v32, v96
  v_add_f32 v33, v33, v97
  v_add_f32 v34, v34, v98
  v_add_f32 v35, v35, v99
  v_add_f32 v36, v36, v100
  v_add_f32 v37, v37, v101
  v_add_f32 v38, v38, v102
  v_add_f32 v39, v39, v103
  s_waitcnt lgkmcnt(0)
  s_barrier
  ds_read_b128 v[120:123], v187 offset:4096
  ds_read_b128 v[124:127], v187 offset:5120
  ds_read_b128 v[128:131], v187 offset:6144
  ds_read_b128 v[132:135], v187 offset:7168
  s_waitcnt lgkmcnt(3)
  v_add_f32 v24, v24, v120
  v_add_f32 v25, v25, v121
  v_add_f32 v26, v26, v122
  v_add_f32 v27, v27, v123
  s_waitcnt lgkmcnt(2)
  v_add_f32 v28, v28, v124
  v_add_f32 v29, v29, v125
  v_add_f32 v30, v30, v126
  v_add_f32 v31, v31, v127
  s_waitcnt lgkmcnt(1)
  v_add_f32 v32, v32, v128
  v_add_f32 v33, v33, v129
  v_add_f32 v34, v34, v130
  v_add_f32 v35, v35, v131
  s_waitcnt lgkmcnt(0)
  v_add_f32 v36, v36, v132
  v_add_f32 v37, v37, v133
  v_add_f32 v38, v38, v134
  v_add_f32 v39, v39, v135
  v_cvt_pk_bf16_f32 v12, v24, v25
  v_cvt_pk_bf16_f32 v13, v26, v27
  v_cvt_pk_bf16_f32 v14, v28, v29
  v_cvt_pk_bf16_f32 v15, v30, v31
  v_cvt_pk_bf16_f32 v16, v32, v33
  v_cvt_pk_bf16_f32 v17, v34, v35
  v_cvt_pk_bf16_f32 v18, v36, v37
  v_cvt_pk_bf16_f32 v19, v38, v39
  s_cmp_eq_u32 s3, 1
  s_cbranch_scc1 L_final
  s_cmp_lg_u32 s57, 0
  s_cbranch_scc1 L_ls11a
  buffer_store_dwordx4 v[12:15], v1, s[4:7], s34 offen offset:0 sc1
  s_branch L_ls11b
L_ls11a:
  buffer_store_dwordx4 v[12:15], v1, s[4:7], s34 offen offset:0
L_ls11b:
  s_cmp_lg_u32 s57, 0
  s_cbranch_scc1 L_ls12a
  buffer_store_dwordx4 v[16:19], v1, s[4:7], s34 offen offset:1024 sc1
  s_branch L_ls12b
L_ls12a:
  buffer_store_dwordx4 v[16:19], v1, s[4:7], s34 offen offset:1024
L_ls12b:
  v_mov_b32 v168, 0x3f803f80
  v_mov_b32 v180, 0
  v_mov_b32 v181, 0
  v_dot2_f32_bf16 v180, v12, v168, v180
  v_dot2_f32_bf16 v181, v12, v12, v181
  v_dot2_f32_bf16 v180, v13, v168, v180
  v_dot2_f32_bf16 v181, v13, v13, v181
  v_dot2_f32_bf16 v180, v14, v168, v180
  v_dot2_f32_bf16 v181, v14, v14, v181
  v_dot2_f32_bf16 v180, v15, v168, v180
  v_dot2_f32_bf16 v181, v15, v15, v181
  v_dot2_f32_bf16 v180, v16, v168, v180
  v_dot2_f32_bf16 v181, v16, v16, v181
  v_dot2_f32_bf16 v180, v17, v168, v180
  v_dot2_f32_bf16 v181, v17, v17, v181
  v_dot2_f32_bf16 v180, v18, v168, v180
  v_dot2_f32_bf16 v181, v18, v18, v181
  v_dot2_f32_bf16 v180, v19, v168, v180
  v_dot2_f32_bf16 v181, v19, v19, v181
  v_lshlrev_b32 v170, 4, v3
  s_nop 1
  v_mov_b32 v182, v180
  v_mov_b32 v183, v181
  s_nop 0
  v_permlane32_swap_b32 v180, v182
  v_permlane32_swap_b32 v181, v183
  v_add_f32 v180, v180, v182
  v_add_f32 v181, v181, v183
  s_mov_b32 exec_lo, 0xffffffff
  s_mov_b32 exec_hi, 0x0
  s_cmp_lg_u32 s57, 0
  s_cbranch_scc1 L_ls13a
  buffer_store_dwordx2 v[180:181], v170, s[4:7], s35 offen sc1
  s_branch L_ls13b
L_ls13a:
  buffer_store_dwordx2 v[180:181], v170, s[4:7], s35 offen
L_ls13b:
  s_mov_b64 exec, -1
  s_cmp_eq_u32 s57, 0
  s_cbranch_scc1 L_rb_12
  v_lshlrev_b32 v22, 6, v2
  s_mov_b32 exec_lo, 0xffffffff
  s_mov_b32 exec_hi, 0x0
  buffer_load_dword v199, v22, s[4:7], s34 offen offset:0 sc1
  s_mov_b32 exec_lo, 0xff
  s_mov_b32 exec_hi, 0x0
  buffer_load_dword v199, v22, s[4:7], s35 offen offset:0 sc1
L_rb_12:
  s_waitcnt vmcnt(0)
  s_mov_b64 exec, 1
  s_cmp_lg_u32 s57, 0
  s_cbranch_scc1 L_ls14a
  buffer_store_dword v11, v21, s[4:7], s39 offen offset:0 sc1
  s_branch L_ls14b
L_ls14a:
  buffer_store_dword v11, v21, s[4:7], s39 offen offset:0
L_ls14b:
  s_mov_b64 exec, -1
  s_mov_b32 s3, 1
  s_branch L_layer
L_final:
  v_permlane32_swap_b32 v12, v14
  v_permlane32_swap_b32 v13, v15
  v_permlane32_swap_b32 v16, v18
  v_permlane32_swap_b32 v17, v19
  s_lshl_b32 s17, s31, 15
  s_lshl_b32 s18, s32, 6
  s_add_u32 s17, s17, s18
  v_lshlrev_b32 v170, 10, v3
  v_lshl_add_u32 v170, v4, 4, v170
  buffer_store_dwordx4 v[12:15], v170, s[8:11], s17 offen
  buffer_store_dwordx4 v[16:19], v170, s[8:11], s17 offen offset:32
L_exit_main:
  s_endpgm
L_code_end:
.section .rodata,"a"
.p2align 6
.amdhsa_kernel interleave_layers__grouped_kv_mqa__glu_gated_swiglu__prompt_kernel
  .amdhsa_next_free_vgpr 512
  .amdhsa_next_free_sgpr 102
  .amdhsa_accum_offset 256
  .amdhsa_group_segment_fixed_size 0
  .amdhsa_kernarg_size 96
  .amdhsa_user_sgpr_count 2
  .amdhsa_user_sgpr_kernarg_segment_ptr 1
  .amdhsa_system_sgpr_workgroup_id_x 1
.end_amdhsa_kernel
```
